```python
import torch

def _softmax(x, axis=-1):
    return torch.softmax(x, dim=axis)
def _gelu(x):
    return torch.nn.functional.gelu(x, approximate="tanh")
def _silu(x):
    return torch.nn.functional.silu(x)
def _sigmoid(x):
    return torch.sigmoid(x)
def _layernorm(x, axis=-1, eps=1e-5):
    m = x.mean(dim=axis, keepdim=True)
    v = x.var(dim=axis, keepdim=True, unbiased=False)
    return (x - m) / torch.sqrt(v + eps)
def _scatter_add(tgt, idx, src, axis=0):
    return tgt.clone().index_add_(axis, idx, src)
def _segment_sum(src, seg, n):
    out = torch.zeros((n,) + src.shape[1:], dtype=src.dtype)
    return out.index_add_(0, seg, src)
def _pad(x, pw):
    flat = tuple(v for pair in reversed(pw) for v in pair)
    return torch.nn.functional.pad(x, flat)

kernel_name = 'concat_heads__gqa_block_cached__gqa_block_cached__near_ridge'

def setup_inputs():

    _w = (lambda a: (lambda t: t.to(torch.bfloat16) if t.is_floating_point() else t)(torch.as_tensor(a)))
    def _A_setup():
        B, Sq, D = 16, 96, 512
        Hq, Hkv, Sk, Dh = 32, 32, 512, 128
        assert Hq % Hkv == 0, (Hq, Hkv)
        return {
            "x": _w((lambda *s: torch.randn(*s, dtype=torch.bfloat16) * 0.8)(B, Sq, D)),
            "k_cache": _w((lambda *s: torch.randn(*s, dtype=torch.bfloat16) * 0.8)(B, Hkv, Sk, Dh)),
            "v_cache": _w((lambda *s: torch.randn(*s, dtype=torch.bfloat16) * 0.05)(B, Hkv, Sk, Dh)),
            "wq": _w((lambda *s: torch.randn(*s, dtype=torch.bfloat16) * 0.8)(D, Hq * Dh) * (D ** -0.5)),
            "wo": _w((lambda *s: torch.randn(*s, dtype=torch.bfloat16) * 0.05)(Hq * Dh, D) * ((Hq * Dh) ** -0.5)),
        }
    _A_in = _A_setup()

    def _B_setup():
        B, Sq, D = 16, 96, 512
        Hq, Hkv, Sk, Dh = 32, 32, 512, 128
        assert Hq % Hkv == 0, (Hq, Hkv)
        return {
            "x": _w((lambda *s: torch.randn(*s, dtype=torch.bfloat16) * 0.8)(B, Sq, D)),
            "k_cache": _w((lambda *s: torch.randn(*s, dtype=torch.bfloat16) * 0.8)(B, Hkv, Sk, Dh)),
            "v_cache": _w((lambda *s: torch.randn(*s, dtype=torch.bfloat16) * 0.05)(B, Hkv, Sk, Dh)),
            "wq": _w((lambda *s: torch.randn(*s, dtype=torch.bfloat16) * 0.8)(D, Hq * Dh) * (D ** -0.5)),
            "wo": _w((lambda *s: torch.randn(*s, dtype=torch.bfloat16) * 0.05)(Hq * Dh, D) * ((Hq * Dh) ** -0.5)),
        }
    _B_in = _B_setup()

    return {
        "A_x": _A_in["x"],
        "A_k_cache": _A_in["k_cache"],
        "A_v_cache": _A_in["v_cache"],
        "A_wq": _A_in["wq"],
        "A_wo": _A_in["wo"],
        "B_x": _B_in["x"],
        "B_k_cache": _B_in["k_cache"],
        "B_v_cache": _B_in["v_cache"],
        "B_wq": _B_in["wq"],
        "B_wo": _B_in["wo"],
    }

def reference(A_x, A_k_cache, A_v_cache, A_wq, A_wo, B_x, B_k_cache, B_v_cache, B_wq, B_wo):
    def _A_ref(x, k_cache, v_cache, wq, wo):
        B, Sq, D = x.shape
        Hq, Dh = 32, 128
        Hkv = k_cache.shape[1]
        rep = Hq // Hkv
        q = (lambda x, *d: x.permute(*d))((x @ wq).reshape(B, Sq, Hq, Dh), 0, 2, 1, 3)
        k = (lambda x, n, axis: torch.repeat_interleave(x, n, dim=axis))(k_cache, rep, axis=1)
        v = (lambda x, n, axis: torch.repeat_interleave(x, n, dim=axis))(v_cache, rep, axis=1)
        scores = torch.einsum("bhqd,bhkd->bhqk", q, k) * (Dh ** -0.5)
        p = _softmax(scores, axis=-1)
        o = torch.einsum("bhqk,bhkd->bhqd", p, v)
        return (lambda x, *d: x.permute(*d))(o, 0, 2, 1, 3).reshape(B, Sq, Hq * Dh) @ wo

    def _B_ref(x, k_cache, v_cache, wq, wo):
        B, Sq, D = x.shape
        Hq, Dh = 32, 128
        Hkv = k_cache.shape[1]
        rep = Hq // Hkv
        q = (lambda x, *d: x.permute(*d))((x @ wq).reshape(B, Sq, Hq, Dh), 0, 2, 1, 3)
        k = (lambda x, n, axis: torch.repeat_interleave(x, n, dim=axis))(k_cache, rep, axis=1)
        v = (lambda x, n, axis: torch.repeat_interleave(x, n, dim=axis))(v_cache, rep, axis=1)
        scores = torch.einsum("bhqd,bhkd->bhqk", q, k) * (Dh ** -0.5)
        p = _softmax(scores, axis=-1)
        o = torch.einsum("bhqk,bhkd->bhqd", p, v)
        return (lambda x, *d: x.permute(*d))(o, 0, 2, 1, 3).reshape(B, Sq, Hq * Dh) @ wo

    a = _A_ref(A_x, A_k_cache, A_v_cache, A_wq, A_wo)
    b = _B_ref(B_x, B_k_cache, B_v_cache, B_wq, B_wo)
    return torch.concatenate([a, b], axis=-1)
```

```asm
; @launch grid=(256,1,1) block=(256,1,1) lds=163840
.amdgcn_target "amdgcn-amd-amdhsa--gfx950"
.text
.globl concat_heads__gqa_block_cached__gqa_block_cached__near_ridge_kernel
.p2align 8
.type concat_heads__gqa_block_cached__gqa_block_cached__near_ridge_kernel,@function
concat_heads__gqa_block_cached__gqa_block_cached__near_ridge_kernel:
    s_cmp_ge_u32 s2, 256
    s_cbranch_scc1 L_end
    s_load_dwordx8 s[48:55], s[0:1], 0
    s_load_dwordx2 s[56:57], s[0:1], 32
    s_load_dwordx8 s[60:67], s[0:1], 40
    s_load_dwordx2 s[68:69], s[0:1], 72
    s_load_dwordx2 s[70:71], s[0:1], 96
    s_getpc_b64 s[78:79]
L_pc:
    s_sub_u32 s78, s78, L_pc-concat_heads__gqa_block_cached__gqa_block_cached__near_ridge_kernel
    s_subb_u32 s79, s79, 0
    s_lshr_b32 s3, s2, 3
    s_lshl_b32 s3, s3, 11
    v_lshlrev_b32 v28, 7, v0
    v_add_u32 v28, s3, v28
    v_min_u32 v28, L_code_end-concat_heads__gqa_block_cached__gqa_block_cached__near_ridge_kernel-4, v28
    v_cmp_gt_u32 vcc, 16, v0
    s_and_saveexec_b64 s[80:81], vcc
    s_cbranch_execz L_nocpf
    global_load_dword v10, v28, s[78:79]
L_nocpf:
    s_mov_b64 exec, s[80:81]
    v_lshrrev_b32 v1, 6, v0
    v_and_b32 v0, 63, v0
    v_readfirstlane_b32 s32, v1
    s_and_b32 s3, s2, 7
    s_lshr_b32 s4, s2, 3
    s_lshr_b32 s5, s3, 2
    s_and_b32 s3, s3, 3
    s_lshl_b32 s3, s3, 1
    s_lshr_b32 s6, s4, 4
    s_add_u32 s3, s3, s6
    s_and_b32 s4, s4, 15
    s_mov_b32 s33, 0x3e0293ee
    s_mov_b32 s58, 0x3e0293ee
    s_mov_b32 s59, 0x3e0293ee
    s_mov_b32 s34, 0x41000000
    s_mul_i32 s36, s32, 4160
    s_mov_b32 s39, 0x30000
    s_waitcnt lgkmcnt(0)
    s_cmp_eq_u32 s5, 0
    s_cselect_b64 s[48:49], s[48:49], s[60:61]
    s_cselect_b64 s[50:51], s[50:51], s[62:63]
    s_cselect_b64 s[52:53], s[52:53], s[64:65]
    s_cselect_b64 s[54:55], s[54:55], s[66:67]
    s_cselect_b64 s[56:57], s[56:57], s[68:69]
    s_lshl_b32 s6, s4, 22
    s_lshl_b32 s7, s3, 19
    s_add_u32 s6, s6, s7
    s_add_u32 s8, s50, s6
    s_addc_u32 s9, s51, 0
    s_and_b32 s9, s9, 0xffff
    s_mov_b32 s10, 0x80000
    s_mov_b32 s11, 0x20000
    s_add_u32 s12, s52, s6
    s_addc_u32 s13, s53, 0
    s_and_b32 s13, s13, 0xffff
    s_mov_b32 s14, 0x80000
    s_mov_b32 s15, 0x20000
    s_lshl_b32 s6, s3, 10
    s_add_u32 s16, s54, s6
    s_addc_u32 s17, s55, 0
    s_and_b32 s17, s17, 0xffff
    s_sub_u32 s18, 0x400000, s6
    s_mov_b32 s47, s18
    s_mov_b32 s19, 0x20000
    s_add_u32 s20, s56, s7
    s_addc_u32 s21, s57, 0
    s_and_b32 s21, s21, 0xffff
    s_mov_b32 s22, 0x80000
    s_mov_b32 s23, 0x20000
    s_mul_i32 s6, s4, 98304
    s_add_u32 s24, s48, s6
    s_addc_u32 s25, s49, 0
    s_and_b32 s25, s25, 0xffff
    s_mov_b32 s26, 98304
    s_mov_b32 s27, 0x20000
    s_mul_i32 s6, s2, 98304
    s_add_u32 s28, s70, s6
    s_addc_u32 s29, s71, 0
    s_and_b32 s29, s29, 0xffff
    s_mov_b32 s30, 98304
    s_mov_b32 s31, 0x20000
    v_bfe_u32 v20, v0, 2, 2
    v_lshrrev_b32 v21, 5, v0
    v_bfe_u32 v22, v0, 4, 1
    v_and_b32 v23, 1, v0
    v_bfe_u32 v24, v0, 1, 1
    v_lshlrev_b32 v25, 2, v20
    v_lshl_add_u32 v26, v21, 1, v25
    v_mul_u32_u24 v26, 1040, v26
    v_lshl_add_u32 v26, v22, 5, v26
    v_lshl_add_u32 v26, v23, 4, v26
    v_lshl_add_u32 v26, v24, 3, v26
    v_and_b32 v27, 15, v0
    v_mul_u32_u24 v27, 1040, v27
    v_lshl_add_u32 v27, v22, 9, v27
    v_lshl_add_u32 v27, v21, 4, v27
    v_lshrrev_b32 v28, 4, v0
    v_and_b32 v29, 15, v0
    v_lshlrev_b32 v29, 4, v29
    v_lshl_add_u32 v5, v28, 12, v29
    s_and_b32 s72, s4, 3
    s_lshl_b32 s72, s72, 17
    s_bfe_u32 s73, s4, 0x10002
    s_lshl_b32 s73, s73, 7
    s_lshl_b32 s75, s4, 15
    s_mov_b32 s77, 0
    s_lshl_b32 s42, s32, 8
    s_add_u32 s42, s42, s72
    s_add_u32 s41, s42, 32768
    s_mov_b32 s40, -1
    s_cmp_eq_u32 s32, 3
    s_cbranch_scc0 L_att
L_wave3:
    v_lshlrev_b32 v2, 4, v0
    v_lshrrev_b32 v28, 3, v0
    v_and_b32 v29, 7, v0
    v_lshlrev_b32 v29, 4, v29
    v_lshl_add_u32 v3, v28, 17, v29
    v_add_u32 v4, 99840, v26
    v_add_u32 v1, 133120, v2
    v_mov_b32 v7, v27
    v_add_u32 v8, 83200, v27
    v_and_b32 v29, 31, v0
    v_lshlrev_b32 v29, 4, v29
    v_lshl_add_u32 v9, v21, 14, v29
    s_lshr_b32 s44, s72, 9
    s_lshl_b32 s3, s73, 5
    v_add_u32 v1, s3, v1
    s_mov_b32 s45, 0
    s_mov_b32 s99, 0
    s_mov_b32 s100, 4
L_tl1:
    s_add_u32 m0, s99, 0
    s_nop 0
    buffer_load_dwordx4 v9, s[24:27], s45 offen offset:0 nt lds
    s_add_u32 m0, s99, 16
    s_nop 0
    buffer_load_dwordx4 v9, s[24:27], s45 offen offset:1024 nt lds
    s_add_u32 m0, s99, 32
    s_nop 0
    buffer_load_dwordx4 v9, s[24:27], s45 offen offset:2048 nt lds
    s_add_u32 m0, s99, 48
    s_nop 0
    buffer_load_dwordx4 v9, s[24:27], s45 offen offset:3072 nt lds
    s_add_u32 s99, s99, 4160
    s_add_u32 s45, s45, 4096
    s_sub_u32 s100, s100, 1
    s_cmp_lg_u32 s100, 0
    s_cbranch_scc1 L_tl1
    s_mov_b32 s45, 32768
    s_mov_b32 s99, 16640
    s_mov_b32 s100, 4
L_tl2:
    s_add_u32 m0, s99, 0
    s_nop 0
    buffer_load_dwordx4 v9, s[24:27], s45 offen offset:0 nt lds
    s_add_u32 m0, s99, 16
    s_nop 0
    buffer_load_dwordx4 v9, s[24:27], s45 offen offset:1024 nt lds
    s_add_u32 m0, s99, 32
    s_nop 0
    buffer_load_dwordx4 v9, s[24:27], s45 offen offset:2048 nt lds
    s_add_u32 m0, s99, 48
    s_nop 0
    buffer_load_dwordx4 v9, s[24:27], s45 offen offset:3072 nt lds
    s_add_u32 s99, s99, 4160
    s_add_u32 s45, s45, 4096
    s_sub_u32 s100, s100, 1
    s_cmp_lg_u32 s100, 0
    s_cbranch_scc1 L_tl2
    s_mov_b32 s45, 65536
    s_mov_b32 s99, 33280
    s_mov_b32 s100, 4
L_tl3:
    s_add_u32 m0, s99, 0
    s_nop 0
    buffer_load_dwordx4 v9, s[24:27], s45 offen offset:0 nt lds
    s_add_u32 m0, s99, 16
    s_nop 0
    buffer_load_dwordx4 v9, s[24:27], s45 offen offset:1024 nt lds
    s_add_u32 m0, s99, 32
    s_nop 0
    buffer_load_dwordx4 v9, s[24:27], s45 offen offset:2048 nt lds
    s_add_u32 m0, s99, 48
    s_nop 0
    buffer_load_dwordx4 v9, s[24:27], s45 offen offset:3072 nt lds
    s_add_u32 s99, s99, 4160
    s_add_u32 s45, s45, 4096
    s_sub_u32 s100, s100, 1
    s_cmp_lg_u32 s100, 0
    s_cbranch_scc1 L_tl3
    s_add_u32 s45, s44, 0
    s_mov_b32 s99, 49920
    s_mov_b32 s100, 4
L_tl4:
    s_add_u32 m0, s99, 0
    s_add_u32 s46, s45, 0
    buffer_load_dwordx4 v3, s[16:19], s46 offen lds
    s_add_u32 m0, s99, 1040
    s_add_u32 s46, s45, 32768
    buffer_load_dwordx4 v3, s[16:19], s46 offen lds
    s_add_u32 m0, s99, 2080
    s_add_u32 s46, s45, 65536
    buffer_load_dwordx4 v3, s[16:19], s46 offen lds
    s_add_u32 m0, s99, 3120
    s_add_u32 s46, s45, 98304
    buffer_load_dwordx4 v3, s[16:19], s46 offen lds
    s_add_u32 s99, s99, 4160
    s_add_u32 s45, s45, 8192
    s_sub_u32 s100, s100, 1
    s_cmp_lg_u32 s100, 0
    s_cbranch_scc1 L_tl4
    s_add_u32 s45, s44, 1048576
    s_mov_b32 s99, 66560
    s_mov_b32 s100, 4
L_tl5:
    s_add_u32 m0, s99, 0
    s_add_u32 s46, s45, 0
    buffer_load_dwordx4 v3, s[16:19], s46 offen lds
    s_add_u32 m0, s99, 1040
    s_add_u32 s46, s45, 32768
    buffer_load_dwordx4 v3, s[16:19], s46 offen lds
    s_add_u32 m0, s99, 2080
    s_add_u32 s46, s45, 65536
    buffer_load_dwordx4 v3, s[16:19], s46 offen lds
    s_add_u32 m0, s99, 3120
    s_add_u32 s46, s45, 98304
    buffer_load_dwordx4 v3, s[16:19], s46 offen lds
    s_add_u32 s99, s99, 4160
    s_add_u32 s45, s45, 8192
    s_sub_u32 s100, s100, 1
    s_cmp_lg_u32 s100, 0
    s_cbranch_scc1 L_tl5
    s_mov_b32 s45, 512
    s_mov_b32 s99, 83200
    s_mov_b32 s100, 4
L_tl6:
    s_add_u32 m0, s99, 0
    s_nop 0
    buffer_load_dwordx4 v9, s[24:27], s45 offen offset:0 nt lds
    s_add_u32 m0, s99, 16
    s_nop 0
    buffer_load_dwordx4 v9, s[24:27], s45 offen offset:1024 nt lds
    s_add_u32 m0, s99, 32
    s_nop 0
    buffer_load_dwordx4 v9, s[24:27], s45 offen offset:2048 nt lds
    s_add_u32 m0, s99, 48
    s_nop 0
    buffer_load_dwordx4 v9, s[24:27], s45 offen offset:3072 nt lds
    s_add_u32 s99, s99, 4160
    s_add_u32 s45, s45, 4096
    s_sub_u32 s100, s100, 1
    s_cmp_lg_u32 s100, 0
    s_cbranch_scc1 L_tl6
    s_mov_b32 s45, 33280
    s_mov_b32 s99, 99840
    s_mov_b32 s100, 4
L_tl7:
    s_add_u32 m0, s99, 0
    s_nop 0
    buffer_load_dwordx4 v9, s[24:27], s45 offen offset:0 nt lds
    s_add_u32 m0, s99, 16
    s_nop 0
    buffer_load_dwordx4 v9, s[24:27], s45 offen offset:1024 nt lds
    s_add_u32 m0, s99, 32
    s_nop 0
    buffer_load_dwordx4 v9, s[24:27], s45 offen offset:2048 nt lds
    s_add_u32 m0, s99, 48
    s_nop 0
    buffer_load_dwordx4 v9, s[24:27], s45 offen offset:3072 nt lds
    s_add_u32 s99, s99, 4160
    s_add_u32 s45, s45, 4096
    s_sub_u32 s100, s100, 1
    s_cmp_lg_u32 s100, 0
    s_cbranch_scc1 L_tl7
    s_mov_b32 s45, 66048
    s_mov_b32 s99, 116480
    s_mov_b32 s100, 4
L_tl8:
    s_add_u32 m0, s99, 0
    s_nop 0
    buffer_load_dwordx4 v9, s[24:27], s45 offen offset:0 nt lds
    s_add_u32 m0, s99, 16
    s_nop 0
    buffer_load_dwordx4 v9, s[24:27], s45 offen offset:1024 nt lds
    s_add_u32 m0, s99, 32
    s_nop 0
    buffer_load_dwordx4 v9, s[24:27], s45 offen offset:2048 nt lds
    s_add_u32 m0, s99, 48
    s_nop 0
    buffer_load_dwordx4 v9, s[24:27], s45 offen offset:3072 nt lds
    s_add_u32 s99, s99, 4160
    s_add_u32 s45, s45, 4096
    s_sub_u32 s100, s100, 1
    s_cmp_lg_u32 s100, 0
    s_cbranch_scc1 L_tl8
    s_add_u32 s45, s44, 2097152
    s_mov_b32 s99, 133120
    s_mov_b32 s100, 4
L_tl9:
    s_add_u32 m0, s99, 0
    s_add_u32 s46, s45, 0
    buffer_load_dwordx4 v3, s[16:19], s46 offen lds
    s_add_u32 m0, s99, 1040
    s_add_u32 s46, s45, 32768
    buffer_load_dwordx4 v3, s[16:19], s46 offen lds
    s_add_u32 m0, s99, 2080
    s_add_u32 s46, s45, 65536
    buffer_load_dwordx4 v3, s[16:19], s46 offen lds
    s_add_u32 m0, s99, 3120
    s_add_u32 s46, s45, 98304
    buffer_load_dwordx4 v3, s[16:19], s46 offen lds
    s_add_u32 s99, s99, 4160
    s_add_u32 s45, s45, 8192
    s_sub_u32 s100, s100, 1
    s_cmp_lg_u32 s100, 0
    s_cbranch_scc1 L_tl9
    s_waitcnt vmcnt(63)
    s_barrier
    ds_read_b128 a[0:3], v7 offset:0
    ds_read_b128 a[4:7], v7 offset:32
    ds_read_b128 a[8:11], v7 offset:64
    ds_read_b128 a[12:15], v7 offset:96
    ds_read_b128 a[16:19], v7 offset:128
    ds_read_b128 a[20:23], v7 offset:160
    ds_read_b128 a[24:27], v7 offset:192
    ds_read_b128 a[28:31], v7 offset:224
    ds_read_b128 a[32:35], v7 offset:256
    ds_read_b128 a[36:39], v7 offset:288
    ds_read_b128 a[40:43], v7 offset:320
    ds_read_b128 a[44:47], v7 offset:352
    ds_read_b128 a[48:51], v7 offset:384
    ds_read_b128 a[52:55], v7 offset:416
    ds_read_b128 a[56:59], v7 offset:448
    ds_read_b128 a[60:63], v7 offset:480
    ds_read_b128 a[128:131], v7 offset:16640
    ds_read_b128 a[132:135], v7 offset:16672
    ds_read_b128 a[136:139], v7 offset:16704
    ds_read_b128 a[140:143], v7 offset:16736
    ds_read_b128 a[144:147], v7 offset:16768
    ds_read_b128 a[148:151], v7 offset:16800
    ds_read_b128 a[152:155], v7 offset:16832
    ds_read_b128 a[156:159], v7 offset:16864
    ds_read_b128 a[160:163], v7 offset:16896
    ds_read_b128 a[164:167], v7 offset:16928
    ds_read_b128 a[168:171], v7 offset:16960
    ds_read_b128 a[172:175], v7 offset:16992
    ds_read_b128 a[176:179], v7 offset:17024
    ds_read_b128 a[180:183], v7 offset:17056
    ds_read_b128 a[184:187], v7 offset:17088
    ds_read_b128 a[188:191], v7 offset:17120
    ds_read_b128 v[128:131], v7 offset:33280
    ds_read_b128 v[132:135], v7 offset:33312
    ds_read_b128 v[136:139], v7 offset:33344
    ds_read_b128 v[140:143], v7 offset:33376
    ds_read_b128 v[144:147], v7 offset:33408
    ds_read_b128 v[148:151], v7 offset:33440
    ds_read_b128 v[152:155], v7 offset:33472
    ds_read_b128 v[156:159], v7 offset:33504
    ds_read_b128 v[160:163], v7 offset:33536
    ds_read_b128 v[164:167], v7 offset:33568
    ds_read_b128 v[168:171], v7 offset:33600
    ds_read_b128 v[172:175], v7 offset:33632
    ds_read_b128 v[176:179], v7 offset:33664
    ds_read_b128 v[180:183], v7 offset:33696
    ds_read_b128 v[184:187], v7 offset:33728
    ds_read_b128 v[188:191], v7 offset:33760
    s_waitcnt lgkmcnt(0)
    s_waitcnt vmcnt(0)
    s_barrier
    s_add_u32 s45, s44, 3145728
    s_mov_b32 s99, 49920
    s_mov_b32 s100, 4
L_tl10:
    s_add_u32 m0, s99, 0
    s_add_u32 s46, s45, 0
    buffer_load_dwordx4 v3, s[16:19], s46 offen lds
    s_add_u32 m0, s99, 1040
    s_add_u32 s46, s45, 32768
    buffer_load_dwordx4 v3, s[16:19], s46 offen lds
    s_add_u32 m0, s99, 2080
    s_add_u32 s46, s45, 65536
    buffer_load_dwordx4 v3, s[16:19], s46 offen lds
    s_add_u32 m0, s99, 3120
    s_add_u32 s46, s45, 98304
    buffer_load_dwordx4 v3, s[16:19], s46 offen lds
    s_add_u32 s99, s99, 4160
    s_add_u32 s45, s45, 8192
    s_sub_u32 s100, s100, 1
    s_cmp_lg_u32 s100, 0
    s_cbranch_scc1 L_tl10
    s_add_u32 s45, s44, 128
    s_mov_b32 s99, 66560
    s_mov_b32 s100, 4
L_tl11:
    s_add_u32 m0, s99, 0
    s_add_u32 s46, s45, 0
    buffer_load_dwordx4 v3, s[16:19], s46 offen lds
    s_add_u32 m0, s99, 1040
    s_add_u32 s46, s45, 32768
    buffer_load_dwordx4 v3, s[16:19], s46 offen lds
    s_add_u32 m0, s99, 2080
    s_add_u32 s46, s45, 65536
    buffer_load_dwordx4 v3, s[16:19], s46 offen lds
    s_add_u32 m0, s99, 3120
    s_add_u32 s46, s45, 98304
    buffer_load_dwordx4 v3, s[16:19], s46 offen lds
    s_add_u32 s99, s99, 4160
    s_add_u32 s45, s45, 8192
    s_sub_u32 s100, s100, 1
    s_cmp_lg_u32 s100, 0
    s_cbranch_scc1 L_tl11
    s_add_u32 s45, s44, 1048704
    s_mov_b32 s99, 33280
    s_mov_b32 s100, 4
L_tl12:
    s_add_u32 m0, s99, 0
    s_add_u32 s46, s45, 0
    buffer_load_dwordx4 v3, s[16:19], s46 offen lds
    s_add_u32 m0, s99, 1040
    s_add_u32 s46, s45, 32768
    buffer_load_dwordx4 v3, s[16:19], s46 offen lds
    s_add_u32 m0, s99, 2080
    s_add_u32 s46, s45, 65536
    buffer_load_dwordx4 v3, s[16:19], s46 offen lds
    s_add_u32 m0, s99, 3120
    s_add_u32 s46, s45, 98304
    buffer_load_dwordx4 v3, s[16:19], s46 offen lds
    s_add_u32 s99, s99, 4160
    s_add_u32 s45, s45, 8192
    s_sub_u32 s100, s100, 1
    s_cmp_lg_u32 s100, 0
    s_cbranch_scc1 L_tl12
    s_xor_b32 s45, s72, s77
    s_mov_b32 s99, 0
    s_mov_b32 s100, 4
L_tl13:
    s_add_u32 m0, s99, 0
    s_nop 0
    buffer_load_dwordx4 v5, s[8:11], s45 offen offset:0 nt lds
    s_add_u32 m0, s99, 16
    s_nop 0
    buffer_load_dwordx4 v5, s[8:11], s45 offen offset:1024 nt lds
    s_add_u32 m0, s99, 32
    s_nop 0
    buffer_load_dwordx4 v5, s[8:11], s45 offen offset:2048 nt lds
    s_add_u32 m0, s99, 48
    s_nop 0
    buffer_load_dwordx4 v5, s[8:11], s45 offen offset:3072 nt lds
    s_add_u32 s99, s99, 4160
    s_add_u32 s45, s45, 256
    s_sub_u32 s100, s100, 1
    s_cmp_lg_u32 s100, 0
    s_cbranch_scc1 L_tl13
    s_add_u32 s45, s72, 16384
    s_xor_b32 s45, s45, s77
    s_mov_b32 s99, 16640
    s_mov_b32 s100, 4
L_tl14:
    s_add_u32 m0, s99, 0
    s_nop 0
    buffer_load_dwordx4 v5, s[8:11], s45 offen offset:0 nt lds
    s_add_u32 m0, s99, 16
    s_nop 0
    buffer_load_dwordx4 v5, s[8:11], s45 offen offset:1024 nt lds
    s_add_u32 m0, s99, 32
    s_nop 0
    buffer_load_dwordx4 v5, s[8:11], s45 offen offset:2048 nt lds
    s_add_u32 m0, s99, 48
    s_nop 0
    buffer_load_dwordx4 v5, s[8:11], s45 offen offset:3072 nt lds
    s_add_u32 s99, s99, 4160
    s_add_u32 s45, s45, 256
    s_sub_u32 s100, s100, 1
    s_cmp_lg_u32 s100, 0
    s_cbranch_scc1 L_tl14
    ds_read_b128 a[64:67], v8 offset:0
    ds_read_b128 a[68:71], v8 offset:32
    ds_read_b128 a[72:75], v8 offset:64
    ds_read_b128 a[76:79], v8 offset:96
    ds_read_b128 a[80:83], v8 offset:128
    ds_read_b128 a[84:87], v8 offset:160
    ds_read_b128 a[88:91], v8 offset:192
    ds_read_b128 a[92:95], v8 offset:224
    ds_read_b128 a[96:99], v8 offset:256
    ds_read_b128 a[100:103], v8 offset:288
    ds_read_b128 a[104:107], v8 offset:320
    ds_read_b128 a[108:111], v8 offset:352
    ds_read_b128 a[112:115], v8 offset:384
    ds_read_b128 a[116:119], v8 offset:416
    ds_read_b128 a[120:123], v8 offset:448
    ds_read_b128 a[124:127], v8 offset:480
    ds_read_b128 a[192:195], v8 offset:16640
    ds_read_b128 a[196:199], v8 offset:16672
    ds_read_b128 a[200:203], v8 offset:16704
    ds_read_b128 a[204:207], v8 offset:16736
    ds_read_b128 a[208:211], v8 offset:16768
    ds_read_b128 a[212:215], v8 offset:16800
    ds_read_b128 a[216:219], v8 offset:16832
    ds_read_b128 a[220:223], v8 offset:16864
    ds_read_b128 a[224:227], v8 offset:16896
    ds_read_b128 a[228:231], v8 offset:16928
    ds_read_b128 a[232:235], v8 offset:16960
    ds_read_b128 a[236:239], v8 offset:16992
    ds_read_b128 a[240:243], v8 offset:17024
    ds_read_b128 a[244:247], v8 offset:17056
    ds_read_b128 a[248:251], v8 offset:17088
    ds_read_b128 a[252:255], v8 offset:17120
    ds_read_b128 v[192:195], v8 offset:33280
    ds_read_b128 v[196:199], v8 offset:33312
    ds_read_b128 v[200:203], v8 offset:33344
    ds_read_b128 v[204:207], v8 offset:33376
    ds_read_b128 v[208:211], v8 offset:33408
    ds_read_b128 v[212:215], v8 offset:33440
    ds_read_b128 v[216:219], v8 offset:33472
    ds_read_b128 v[220:223], v8 offset:33504
    ds_read_b128 v[224:227], v8 offset:33536
    ds_read_b128 v[228:231], v8 offset:33568
    ds_read_b128 v[232:235], v8 offset:33600
    ds_read_b128 v[236:239], v8 offset:33632
    ds_read_b128 v[240:243], v8 offset:33664
    ds_read_b128 v[244:247], v8 offset:33696
    ds_read_b128 v[248:251], v8 offset:33728
    ds_read_b128 v[252:255], v8 offset:33760
    s_waitcnt lgkmcnt(0)
    s_waitcnt vmcnt(32)
    s_barrier
    s_load_dwordx2 s[84:85], s[0:1], 88
    s_memrealtime s[90:91]
    v_mov_b32 v13, 0
    v_mov_b32 v14, 252
    s_bfe_u32 s94, s2, 0x40003
    s_add_u32 s94, s94, 2
    s_waitcnt lgkmcnt(0)
    s_and_b32 s85, s85, 0xffff
    s_mov_b32 s86, 256
    s_mov_b32 s87, 0x20000
    s_or_b32 s90, s90, 1
    v_mov_b32 v12, s90
    v_mov_b32 v15, s90
    s_add_u32 s45, s44, 2097280
    s_mov_b32 s99, 83200
    s_mov_b32 s100, 4
L_tl15:
    s_add_u32 m0, s99, 0
    s_add_u32 s46, s45, 0
    buffer_load_dwordx4 v3, s[16:19], s46 offen lds
    s_add_u32 m0, s99, 1040
    s_add_u32 s46, s45, 32768
    buffer_load_dwordx4 v3, s[16:19], s46 offen lds
    s_add_u32 m0, s99, 2080
    s_add_u32 s46, s45, 65536
    buffer_load_dwordx4 v3, s[16:19], s46 offen lds
    s_add_u32 m0, s99, 3120
    s_add_u32 s46, s45, 98304
    buffer_load_dwordx4 v3, s[16:19], s46 offen lds
    s_add_u32 s99, s99, 4160
    s_add_u32 s45, s45, 8192
    s_sub_u32 s100, s100, 1
    s_cmp_lg_u32 s100, 0
    s_cbranch_scc1 L_tl15
    s_add_u32 s45, s44, 3145856
    s_mov_b32 s99, 133120
    s_mov_b32 s100, 4
L_tl16:
    s_add_u32 m0, s99, 0
    s_add_u32 s46, s45, 0
    buffer_load_dwordx4 v3, s[16:19], s46 offen lds
    s_add_u32 m0, s99, 1040
    s_add_u32 s46, s45, 32768
    buffer_load_dwordx4 v3, s[16:19], s46 offen lds
    s_add_u32 m0, s99, 2080
    s_add_u32 s46, s45, 65536
    buffer_load_dwordx4 v3, s[16:19], s46 offen lds
    s_add_u32 m0, s99, 3120
    s_add_u32 s46, s45, 98304
    buffer_load_dwordx4 v3, s[16:19], s46 offen lds
    s_add_u32 s99, s99, 4160
    s_add_u32 s45, s45, 8192
    s_sub_u32 s100, s100, 1
    s_cmp_lg_u32 s100, 0
    s_cbranch_scc1 L_tl16
    s_add_u32 s74, s44, 256
    s_and_b32 s74, s74, 1023
    s_xor_b32 s44, s74, s73
    s_mov_b32 s45, s44
    s_mov_b32 s99, 99840
    s_mov_b32 s100, 4
L_tl17:
    s_add_u32 m0, s99, 0
    s_add_u32 s46, s45, 0
    buffer_load_dwordx4 v3, s[16:19], s46 offen lds
    s_add_u32 m0, s99, 1040
    s_add_u32 s46, s45, 32768
    buffer_load_dwordx4 v3, s[16:19], s46 offen lds
    s_add_u32 m0, s99, 2080
    s_add_u32 s46, s45, 65536
    buffer_load_dwordx4 v3, s[16:19], s46 offen lds
    s_add_u32 m0, s99, 3120
    s_add_u32 s46, s45, 98304
    buffer_load_dwordx4 v3, s[16:19], s46 offen lds
    s_add_u32 s99, s99, 4160
    s_add_u32 s45, s45, 8192
    s_sub_u32 s100, s100, 1
    s_cmp_lg_u32 s100, 0
    s_cbranch_scc1 L_tl17
    s_add_u32 s45, s44, 1048576
    s_mov_b32 s99, 116480
    s_mov_b32 s100, 4
L_tl18:
    s_add_u32 m0, s99, 0
    s_add_u32 s46, s45, 0
    buffer_load_dwordx4 v3, s[16:19], s46 offen lds
    s_add_u32 m0, s99, 1040
    s_add_u32 s46, s45, 32768
    buffer_load_dwordx4 v3, s[16:19], s46 offen lds
    s_add_u32 m0, s99, 2080
    s_add_u32 s46, s45, 65536
    buffer_load_dwordx4 v3, s[16:19], s46 offen lds
    s_add_u32 m0, s99, 3120
    s_add_u32 s46, s45, 98304
    buffer_load_dwordx4 v3, s[16:19], s46 offen lds
    s_add_u32 s99, s99, 4160
    s_add_u32 s45, s45, 8192
    s_sub_u32 s100, s100, 1
    s_cmp_lg_u32 s100, 0
    s_cbranch_scc1 L_tl18
    s_waitcnt vmcnt(32)
    s_barrier
    s_waitcnt vmcnt(16)
    ds_read_b64_tr_b16 v[16:17], v4 offset:0
    ds_read_b64_tr_b16 v[18:19], v4 offset:1040
    ds_read_b64_tr_b16 v[20:21], v4 offset:128
    ds_read_b64_tr_b16 v[22:23], v4 offset:1168
    ds_read_b64_tr_b16 v[24:25], v4 offset:256
    ds_read_b64_tr_b16 v[26:27], v4 offset:1296
    s_waitcnt lgkmcnt(4)
    v_mfma_f32_32x32x16_bf16 v[32:47], v[16:19], a[0:3], 0
    v_mfma_f32_32x32x16_bf16 v[48:63], v[16:19], a[128:131], 0
    v_mfma_f32_32x32x16_bf16 v[64:79], v[16:19], v[128:131], 0
    ds_read_b64_tr_b16 v[28:29], v4 offset:384
    ds_read_b64_tr_b16 v[30:31], v4 offset:1424
    s_waitcnt lgkmcnt(4)
    v_mfma_f32_32x32x16_bf16 v[32:47], v[20:23], a[4:7], v[32:47]
    v_mfma_f32_32x32x16_bf16 v[48:63], v[20:23], a[132:135], v[48:63]
    v_mfma_f32_32x32x16_bf16 v[64:79], v[20:23], v[132:135], v[64:79]
    ds_read_b64_tr_b16 v[16:17], v4 offset:512
    ds_read_b64_tr_b16 v[18:19], v4 offset:1552
    s_waitcnt lgkmcnt(4)
    v_mfma_f32_32x32x16_bf16 v[32:47], v[24:27], a[8:11], v[32:47]
    v_mfma_f32_32x32x16_bf16 v[48:63], v[24:27], a[136:139], v[48:63]
    v_mfma_f32_32x32x16_bf16 v[64:79], v[24:27], v[136:139], v[64:79]
    ds_read_b64_tr_b16 v[20:21], v4 offset:640
    ds_read_b64_tr_b16 v[22:23], v4 offset:1680
    s_waitcnt lgkmcnt(4)
    v_mfma_f32_32x32x16_bf16 v[32:47], v[28:31], a[12:15], v[32:47]
    v_mfma_f32_32x32x16_bf16 v[48:63], v[28:31], a[140:143], v[48:63]
    v_mfma_f32_32x32x16_bf16 v[64:79], v[28:31], v[140:143], v[64:79]
    ds_read_b64_tr_b16 v[24:25], v4 offset:768
    ds_read_b64_tr_b16 v[26:27], v4 offset:1808
    s_waitcnt lgkmcnt(4)
    v_mfma_f32_32x32x16_bf16 v[32:47], v[16:19], a[16:19], v[32:47]
    v_mfma_f32_32x32x16_bf16 v[48:63], v[16:19], a[144:147], v[48:63]
    v_mfma_f32_32x32x16_bf16 v[64:79], v[16:19], v[144:147], v[64:79]
    ds_read_b64_tr_b16 v[28:29], v4 offset:896
    ds_read_b64_tr_b16 v[30:31], v4 offset:1936
    s_waitcnt lgkmcnt(4)
    v_mfma_f32_32x32x16_bf16 v[32:47], v[20:23], a[20:23], v[32:47]
    v_mfma_f32_32x32x16_bf16 v[48:63], v[20:23], a[148:151], v[48:63]
    v_mfma_f32_32x32x16_bf16 v[64:79], v[20:23], v[148:151], v[64:79]
    ds_read_b64_tr_b16 v[16:17], v4 offset:64
    ds_read_b64_tr_b16 v[18:19], v4 offset:1104
    s_waitcnt lgkmcnt(4)
    v_mfma_f32_32x32x16_bf16 v[32:47], v[24:27], a[24:27], v[32:47]
    v_mfma_f32_32x32x16_bf16 v[48:63], v[24:27], a[152:155], v[48:63]
    v_mfma_f32_32x32x16_bf16 v[64:79], v[24:27], v[152:155], v[64:79]
    ds_read_b64_tr_b16 v[20:21], v4 offset:192
    ds_read_b64_tr_b16 v[22:23], v4 offset:1232
    s_waitcnt lgkmcnt(4)
    v_mfma_f32_32x32x16_bf16 v[32:47], v[28:31], a[28:31], v[32:47]
    v_mfma_f32_32x32x16_bf16 v[48:63], v[28:31], a[156:159], v[48:63]
    v_mfma_f32_32x32x16_bf16 v[64:79], v[28:31], v[156:159], v[64:79]
    ds_read_b64_tr_b16 v[24:25], v4 offset:320
    ds_read_b64_tr_b16 v[26:27], v4 offset:1360
    s_waitcnt lgkmcnt(4)
    v_mfma_f32_32x32x16_bf16 v[80:95], v[16:19], a[0:3], 0
    v_mfma_f32_32x32x16_bf16 v[96:111], v[16:19], a[128:131], 0
    v_mfma_f32_32x32x16_bf16 v[112:127], v[16:19], v[128:131], 0
    ds_read_b64_tr_b16 v[28:29], v4 offset:448
    ds_read_b64_tr_b16 v[30:31], v4 offset:1488
    s_waitcnt lgkmcnt(4)
    v_mfma_f32_32x32x16_bf16 v[80:95], v[20:23], a[4:7], v[80:95]
    v_mfma_f32_32x32x16_bf16 v[96:111], v[20:23], a[132:135], v[96:111]
    v_mfma_f32_32x32x16_bf16 v[112:127], v[20:23], v[132:135], v[112:127]
    ds_read_b64_tr_b16 v[16:17], v4 offset:576
    ds_read_b64_tr_b16 v[18:19], v4 offset:1616
    s_waitcnt lgkmcnt(4)
    v_mfma_f32_32x32x16_bf16 v[80:95], v[24:27], a[8:11], v[80:95]
    v_mfma_f32_32x32x16_bf16 v[96:111], v[24:27], a[136:139], v[96:111]
    v_mfma_f32_32x32x16_bf16 v[112:127], v[24:27], v[136:139], v[112:127]
    ds_read_b64_tr_b16 v[20:21], v4 offset:704
    ds_read_b64_tr_b16 v[22:23], v4 offset:1744
    s_waitcnt lgkmcnt(4)
    v_mfma_f32_32x32x16_bf16 v[80:95], v[28:31], a[12:15], v[80:95]
    v_mfma_f32_32x32x16_bf16 v[96:111], v[28:31], a[140:143], v[96:111]
    v_mfma_f32_32x32x16_bf16 v[112:127], v[28:31], v[140:143], v[112:127]
    ds_read_b64_tr_b16 v[24:25], v4 offset:832
    ds_read_b64_tr_b16 v[26:27], v4 offset:1872
    s_waitcnt lgkmcnt(4)
    v_mfma_f32_32x32x16_bf16 v[80:95], v[16:19], a[16:19], v[80:95]
    v_mfma_f32_32x32x16_bf16 v[96:111], v[16:19], a[144:147], v[96:111]
    v_mfma_f32_32x32x16_bf16 v[112:127], v[16:19], v[144:147], v[112:127]
    ds_read_b64_tr_b16 v[28:29], v4 offset:960
    ds_read_b64_tr_b16 v[30:31], v4 offset:2000
    s_waitcnt lgkmcnt(4)
    v_mfma_f32_32x32x16_bf16 v[80:95], v[20:23], a[20:23], v[80:95]
    v_mfma_f32_32x32x16_bf16 v[96:111], v[20:23], a[148:151], v[96:111]
    v_mfma_f32_32x32x16_bf16 v[112:127], v[20:23], v[148:151], v[112:127]
    s_waitcnt lgkmcnt(2)
    v_mfma_f32_32x32x16_bf16 v[80:95], v[24:27], a[24:27], v[80:95]
    v_mfma_f32_32x32x16_bf16 v[96:111], v[24:27], a[152:155], v[96:111]
    v_mfma_f32_32x32x16_bf16 v[112:127], v[24:27], v[152:155], v[112:127]
    s_waitcnt lgkmcnt(0)
    v_mfma_f32_32x32x16_bf16 v[80:95], v[28:31], a[28:31], v[80:95]
    v_mfma_f32_32x32x16_bf16 v[96:111], v[28:31], a[156:159], v[96:111]
    v_mfma_f32_32x32x16_bf16 v[112:127], v[28:31], v[156:159], v[112:127]
    s_add_u32 s43, s72, 0x64000
    s_and_b32 s43, s43, 0x7ffff
    s_mov_b32 s35, 6
    s_waitcnt vmcnt(0)
    s_waitcnt lgkmcnt(0)
    s_nop 1
L_w3_loop:
    s_waitcnt vmcnt(40)
    s_barrier
    s_cmp_le_i32 s40, 20
    s_cselect_b32 s18, s47, 0
    s_mov_b32 m0, 99840
    s_add_u32 s46, s44, 2097152
    buffer_load_dwordx4 v3, s[16:19], s46 offen lds
    s_mov_b32 m0, 100880
    s_add_u32 s46, s44, 2129920
    buffer_load_dwordx4 v3, s[16:19], s46 offen lds
    s_mov_b32 m0, 101920
    s_add_u32 s46, s44, 2162688
    buffer_load_dwordx4 v3, s[16:19], s46 offen lds
    s_mov_b32 m0, 102960
    s_add_u32 s46, s44, 2195456
    buffer_load_dwordx4 v3, s[16:19], s46 offen lds
    s_mov_b32 m0, 104000
    s_add_u32 s46, s44, 2105344
    buffer_load_dwordx4 v3, s[16:19], s46 offen lds
    s_mov_b32 m0, 105040
    s_add_u32 s46, s44, 2138112
    buffer_load_dwordx4 v3, s[16:19], s46 offen lds
    s_mov_b32 m0, 106080
    s_add_u32 s46, s44, 2170880
    buffer_load_dwordx4 v3, s[16:19], s46 offen lds
    s_mov_b32 m0, 107120
    s_add_u32 s46, s44, 2203648
    buffer_load_dwordx4 v3, s[16:19], s46 offen lds
    s_nop 0
    s_waitcnt vmcnt(32)
    ds_read_b64_tr_b16 v[16:17], v4 offset:16640
    ds_read_b64_tr_b16 v[18:19], v4 offset:17680
    ds_read_b64_tr_b16 v[20:21], v4 offset:16768
    ds_read_b64_tr_b16 v[22:23], v4 offset:17808
    ds_read_b64_tr_b16 v[24:25], v4 offset:16896
    ds_read_b64_tr_b16 v[26:27], v4 offset:17936
    s_waitcnt lgkmcnt(4)
    v_mfma_f32_32x32x16_bf16 v[32:47], v[16:19], a[32:35], v[32:47]
    s_mov_b32 m0, 108160
    s_add_u32 s46, s44, 2113536
    buffer_load_dwordx4 v3, s[16:19], s46 offen lds
    s_mov_b32 m0, 109200
    v_mfma_f32_32x32x16_bf16 v[48:63], v[16:19], a[160:163], v[48:63]
    s_add_u32 s46, s44, 2146304
    buffer_load_dwordx4 v3, s[16:19], s46 offen lds
    s_mov_b32 m0, 110240
    s_add_u32 s46, s44, 2179072
    v_mfma_f32_32x32x16_bf16 v[64:79], v[16:19], v[160:163], v[64:79]
    ds_read_b64_tr_b16 v[28:29], v4 offset:17024
    ds_read_b64_tr_b16 v[30:31], v4 offset:18064
    buffer_load_dwordx4 v3, s[16:19], s46 offen lds
    s_mov_b32 m0, 111280
    s_add_u32 s46, s44, 2211840
    s_waitcnt lgkmcnt(4)
    v_mfma_f32_32x32x16_bf16 v[32:47], v[20:23], a[36:39], v[32:47]
    buffer_load_dwordx4 v3, s[16:19], s46 offen lds
    s_mov_b32 m0, 112320
    s_add_u32 s46, s44, 2121728
    v_mfma_f32_32x32x16_bf16 v[48:63], v[20:23], a[164:167], v[48:63]
    buffer_load_dwordx4 v3, s[16:19], s46 offen lds
    s_mov_b32 m0, 113360
    s_add_u32 s46, s44, 2154496
    v_mfma_f32_32x32x16_bf16 v[64:79], v[20:23], v[164:167], v[64:79]
    ds_read_b64_tr_b16 v[16:17], v4 offset:17152
    ds_read_b64_tr_b16 v[18:19], v4 offset:18192
    buffer_load_dwordx4 v3, s[16:19], s46 offen lds
    s_mov_b32 m0, 114400
    s_add_u32 s46, s44, 2187264
    s_waitcnt lgkmcnt(4)
    v_mfma_f32_32x32x16_bf16 v[32:47], v[24:27], a[40:43], v[32:47]
    buffer_load_dwordx4 v3, s[16:19], s46 offen lds
    s_mov_b32 m0, 115440
    s_add_u32 s46, s44, 2220032
    v_mfma_f32_32x32x16_bf16 v[48:63], v[24:27], a[168:171], v[48:63]
    buffer_load_dwordx4 v3, s[16:19], s46 offen lds
    s_cmp_le_i32 s40, 30
    s_cselect_b32 s14, 0x80000, 0
    s_cselect_b32 s38, s36, s39
    v_mfma_f32_32x32x16_bf16 v[64:79], v[24:27], v[168:171], v[64:79]
    ds_read_b64_tr_b16 v[20:21], v4 offset:17280
    ds_read_b64_tr_b16 v[22:23], v4 offset:18320
    s_add_u32 m0, s38, 33280
    s_nop 0
    buffer_load_dwordx4 v5, s[12:15], s42 offen nt lds
    s_add_u32 m0, s38, 33296
    s_waitcnt lgkmcnt(4)
    v_mfma_f32_32x32x16_bf16 v[32:47], v[28:31], a[44:47], v[32:47]
    buffer_load_dwordx4 v5, s[12:15], s42 offen offset:1024 nt lds
    s_add_u32 m0, s38, 33312
    v_mfma_f32_32x32x16_bf16 v[48:63], v[28:31], a[172:175], v[48:63]
    buffer_load_dwordx4 v5, s[12:15], s42 offen offset:2048 nt lds
    s_add_u32 m0, s38, 33328
    v_mfma_f32_32x32x16_bf16 v[64:79], v[28:31], v[172:175], v[64:79]
    ds_read_b64_tr_b16 v[24:25], v4 offset:17408
    ds_read_b64_tr_b16 v[26:27], v4 offset:18448
    buffer_load_dwordx4 v5, s[12:15], s42 offen offset:3072 nt lds
    s_add_u32 s42, s42, 16384
    s_and_b32 s42, s42, 0x7ffff
    s_waitcnt lgkmcnt(4)
    v_mfma_f32_32x32x16_bf16 v[32:47], v[16:19], a[48:51], v[32:47]
    v_mfma_f32_32x32x16_bf16 v[48:63], v[16:19], a[176:179], v[48:63]
    v_mfma_f32_32x32x16_bf16 v[64:79], v[16:19], v[176:179], v[64:79]
    ds_read_b64_tr_b16 v[28:29], v4 offset:17536
    ds_read_b64_tr_b16 v[30:31], v4 offset:18576
    s_waitcnt lgkmcnt(4)
    v_mfma_f32_32x32x16_bf16 v[32:47], v[20:23], a[52:55], v[32:47]
    v_mfma_f32_32x32x16_bf16 v[48:63], v[20:23], a[180:183], v[48:63]
    v_mfma_f32_32x32x16_bf16 v[64:79], v[20:23], v[180:183], v[64:79]
    ds_read_b64_tr_b16 v[16:17], v4 offset:16704
    ds_read_b64_tr_b16 v[18:19], v4 offset:17744
    s_waitcnt lgkmcnt(4)
    v_mfma_f32_32x32x16_bf16 v[32:47], v[24:27], a[56:59], v[32:47]
    v_mfma_f32_32x32x16_bf16 v[48:63], v[24:27], a[184:187], v[48:63]
    v_mfma_f32_32x32x16_bf16 v[64:79], v[24:27], v[184:187], v[64:79]
    ds_read_b64_tr_b16 v[20:21], v4 offset:16832
    ds_read_b64_tr_b16 v[22:23], v4 offset:17872
    s_waitcnt lgkmcnt(4)
    v_mfma_f32_32x32x16_bf16 v[32:47], v[28:31], a[60:63], v[32:47]
    v_mfma_f32_32x32x16_bf16 v[48:63], v[28:31], a[188:191], v[48:63]
    v_mfma_f32_32x32x16_bf16 v[64:79], v[28:31], v[188:191], v[64:79]
    s_waitcnt lgkmcnt(2)
    v_mfma_f32_32x32x16_bf16 v[80:95], v[16:19], a[32:35], v[80:95]
    ds_read_b64_tr_b16 v[24:25], v4 offset:16960
    ds_read_b64_tr_b16 v[26:27], v4 offset:18000
    v_mfma_f32_32x32x16_bf16 v[96:111], v[16:19], a[160:163], v[96:111]
    v_mfma_f32_32x32x16_bf16 v[112:127], v[16:19], v[160:163], v[112:127]
    s_waitcnt lgkmcnt(2)
    v_mfma_f32_32x32x16_bf16 v[80:95], v[20:23], a[36:39], v[80:95]
    ds_read_b64_tr_b16 v[28:29], v4 offset:17088
    ds_read_b64_tr_b16 v[30:31], v4 offset:18128
    v_mfma_f32_32x32x16_bf16 v[96:111], v[20:23], a[164:167], v[96:111]
    v_mfma_f32_32x32x16_bf16 v[112:127], v[20:23], v[164:167], v[112:127]
    s_waitcnt vmcnt(40)
    s_barrier
    ds_read_b64_tr_b16 v[16:17], v4 offset:17216
    ds_read_b64_tr_b16 v[18:19], v4 offset:18256
    s_waitcnt lgkmcnt(4)
    v_mfma_f32_32x32x16_bf16 v[80:95], v[24:27], a[40:43], v[80:95]
    s_cmp_le_i32 s40, 28
    s_cselect_b32 s10, 0x80000, 0
    s_cselect_b32 s37, s36, s39
    s_add_u32 m0, s37, 0
    s_nop 0
    buffer_load_dwordx4 v5, s[8:11], s41 offen nt lds
    s_add_u32 m0, s37, 16
    v_mfma_f32_32x32x16_bf16 v[96:111], v[24:27], a[168:171], v[96:111]
    buffer_load_dwordx4 v5, s[8:11], s41 offen offset:1024 nt lds
    s_add_u32 m0, s37, 32
    s_nop 0
    buffer_load_dwordx4 v5, s[8:11], s41 offen offset:2048 nt lds
    s_add_u32 m0, s37, 48
    v_mfma_f32_32x32x16_bf16 v[112:127], v[24:27], v[168:171], v[112:127]
    ds_read_b64_tr_b16 v[20:21], v4 offset:17344
    ds_read_b64_tr_b16 v[22:23], v4 offset:18384
    buffer_load_dwordx4 v5, s[8:11], s41 offen offset:3072 nt lds
    s_add_u32 s41, s41, 16384
    s_and_b32 s41, s41, 0x7ffff
    s_waitcnt lgkmcnt(4)
    v_mfma_f32_32x32x16_bf16 v[80:95], v[28:31], a[44:47], v[80:95]
    s_cmp_lg_u32 s40, s94
    s_cbranch_scc1 L_nn1
    s_mov_b64 exec, 1
    buffer_atomic_cmpswap v[12:13], v14, s[84:87], 0 offen sc0 sc1
    s_mov_b64 exec, -1
L_nn1:
    v_mfma_f32_32x32x16_bf16 v[96:111], v[28:31], a[172:175], v[96:111]
    s_cmp_ge_i32 s40, 6
    s_cselect_b32 s22, 0x80000, 0
    s_cselect_b32 s76, s43, s75
    s_mov_b32 m0, 83200
    s_add_u32 s45, s76, 0
    buffer_load_dwordx4 v2, s[20:23], s45 offen lds
    v_mfma_f32_32x32x16_bf16 v[112:127], v[28:31], v[172:175], v[112:127]
    ds_read_b64_tr_b16 v[24:25], v4 offset:17472
    ds_read_b64_tr_b16 v[26:27], v4 offset:18512
    s_mov_b32 m0, 86336
    s_nop 0
    buffer_load_dwordx4 v2, s[20:23], s45 offen offset:1024 lds
    s_mov_b32 m0, 89472
    s_nop 0
    buffer_load_dwordx4 v2, s[20:23], s45 offen offset:2048 lds
    s_waitcnt lgkmcnt(4)
    v_mfma_f32_32x32x16_bf16 v[80:95], v[16:19], a[48:51], v[80:95]
    s_mov_b32 m0, 92608
    s_nop 0
    buffer_load_dwordx4 v2, s[20:23], s45 offen offset:3072 lds
    s_mov_b32 m0, 84240
    s_add_u32 s45, s76, 4096
    v_mfma_f32_32x32x16_bf16 v[96:111], v[16:19], a[176:179], v[96:111]
    buffer_load_dwordx4 v2, s[20:23], s45 offen lds
    s_mov_b32 m0, 87376
    s_nop 0
    buffer_load_dwordx4 v2, s[20:23], s45 offen offset:1024 lds
    s_mov_b32 m0, 90512
    v_mfma_f32_32x32x16_bf16 v[112:127], v[16:19], v[176:179], v[112:127]
    ds_read_b64_tr_b16 v[28:29], v4 offset:17600
    ds_read_b64_tr_b16 v[30:31], v4 offset:18640
    buffer_load_dwordx4 v2, s[20:23], s45 offen offset:2048 lds
    s_mov_b32 m0, 93648
    s_nop 0
    buffer_load_dwordx4 v2, s[20:23], s45 offen offset:3072 lds
    s_mov_b32 m0, 85280
    s_waitcnt lgkmcnt(4)
    v_mfma_f32_32x32x16_bf16 v[80:95], v[20:23], a[52:55], v[80:95]
    s_add_u32 s45, s76, 8192
    buffer_load_dwordx4 v2, s[20:23], s45 offen lds
    s_mov_b32 m0, 88416
    s_nop 0
    buffer_load_dwordx4 v2, s[20:23], s45 offen offset:1024 lds
    v_mfma_f32_32x32x16_bf16 v[96:111], v[20:23], a[180:183], v[96:111]
    s_mov_b32 m0, 91552
    s_nop 0
    buffer_load_dwordx4 v2, s[20:23], s45 offen offset:2048 lds
    s_mov_b32 m0, 94688
    s_nop 0
    buffer_load_dwordx4 v2, s[20:23], s45 offen offset:3072 lds
    v_mfma_f32_32x32x16_bf16 v[112:127], v[20:23], v[180:183], v[112:127]
    s_mov_b32 m0, 86320
    s_add_u32 s45, s76, 12288
    buffer_load_dwordx4 v2, s[20:23], s45 offen lds
    s_mov_b32 m0, 89456
    s_waitcnt lgkmcnt(2)
    v_mfma_f32_32x32x16_bf16 v[80:95], v[24:27], a[56:59], v[80:95]
    buffer_load_dwordx4 v2, s[20:23], s45 offen offset:1024 lds
    s_mov_b32 m0, 92592
    s_nop 0
    buffer_load_dwordx4 v2, s[20:23], s45 offen offset:2048 lds
    s_mov_b32 m0, 95728
    v_mfma_f32_32x32x16_bf16 v[96:111], v[24:27], a[184:187], v[96:111]
    buffer_load_dwordx4 v2, s[20:23], s45 offen offset:3072 lds
    s_add_u32 s43, s43, 16384
    s_and_b32 s43, s43, 0x7ffff
    s_add_u32 s40, s40, 1
    v_mfma_f32_32x32x16_bf16 v[112:127], v[24:27], v[184:187], v[112:127]
    s_waitcnt lgkmcnt(0)
    v_mfma_f32_32x32x16_bf16 v[80:95], v[28:31], a[60:63], v[80:95]
    v_mfma_f32_32x32x16_bf16 v[96:111], v[28:31], a[188:191], v[96:111]
    v_mfma_f32_32x32x16_bf16 v[112:127], v[28:31], v[188:191], v[112:127]
    s_waitcnt vmcnt(40)
    s_barrier
    s_cmp_le_i32 s40, 20
    s_cselect_b32 s18, s47, 0
    s_mov_b32 m0, 116480
    s_add_u32 s46, s44, 3145728
    buffer_load_dwordx4 v3, s[16:19], s46 offen lds
    s_mov_b32 m0, 117520
    s_add_u32 s46, s44, 3178496
    buffer_load_dwordx4 v3, s[16:19], s46 offen lds
    s_mov_b32 m0, 118560
    s_add_u32 s46, s44, 3211264
    buffer_load_dwordx4 v3, s[16:19], s46 offen lds
    s_mov_b32 m0, 119600
    s_add_u32 s46, s44, 3244032
    buffer_load_dwordx4 v3, s[16:19], s46 offen lds
    s_mov_b32 m0, 120640
    s_add_u32 s46, s44, 3153920
    buffer_load_dwordx4 v3, s[16:19], s46 offen lds
    s_mov_b32 m0, 121680
    s_add_u32 s46, s44, 3186688
    buffer_load_dwordx4 v3, s[16:19], s46 offen lds
    s_mov_b32 m0, 122720
    s_add_u32 s46, s44, 3219456
    buffer_load_dwordx4 v3, s[16:19], s46 offen lds
    s_mov_b32 m0, 123760
    s_add_u32 s46, s44, 3252224
    buffer_load_dwordx4 v3, s[16:19], s46 offen lds
    s_nop 0
    s_waitcnt vmcnt(32)
    ds_read_b64_tr_b16 v[16:17], v4 offset:0
    ds_read_b64_tr_b16 v[18:19], v4 offset:1040
    ds_read_b64_tr_b16 v[20:21], v4 offset:128
    ds_read_b64_tr_b16 v[22:23], v4 offset:1168
    ds_read_b64_tr_b16 v[24:25], v4 offset:256
    ds_read_b64_tr_b16 v[26:27], v4 offset:1296
    s_waitcnt lgkmcnt(4)
    v_mfma_f32_32x32x16_bf16 v[32:47], v[16:19], a[64:67], v[32:47]
    s_mov_b32 m0, 124800
    s_add_u32 s46, s44, 3162112
    buffer_load_dwordx4 v3, s[16:19], s46 offen lds
    s_mov_b32 m0, 125840
    v_mfma_f32_32x32x16_bf16 v[48:63], v[16:19], a[192:195], v[48:63]
    s_add_u32 s46, s44, 3194880
    buffer_load_dwordx4 v3, s[16:19], s46 offen lds
    s_mov_b32 m0, 126880
    s_add_u32 s46, s44, 3227648
    v_mfma_f32_32x32x16_bf16 v[64:79], v[16:19], v[192:195], v[64:79]
    ds_read_b64_tr_b16 v[28:29], v4 offset:384
    ds_read_b64_tr_b16 v[30:31], v4 offset:1424
    buffer_load_dwordx4 v3, s[16:19], s46 offen lds
    s_mov_b32 m0, 127920
    s_add_u32 s46, s44, 3260416
    s_waitcnt lgkmcnt(4)
    v_mfma_f32_32x32x16_bf16 v[32:47], v[20:23], a[68:71], v[32:47]
    buffer_load_dwordx4 v3, s[16:19], s46 offen lds
    s_mov_b32 m0, 128960
    s_add_u32 s46, s44, 3170304
    v_mfma_f32_32x32x16_bf16 v[48:63], v[20:23], a[196:199], v[48:63]
    buffer_load_dwordx4 v3, s[16:19], s46 offen lds
    s_mov_b32 m0, 130000
    s_add_u32 s46, s44, 3203072
    v_mfma_f32_32x32x16_bf16 v[64:79], v[20:23], v[196:199], v[64:79]
    ds_read_b64_tr_b16 v[16:17], v4 offset:512
    ds_read_b64_tr_b16 v[18:19], v4 offset:1552
    buffer_load_dwordx4 v3, s[16:19], s46 offen lds
    s_mov_b32 m0, 131040
    s_add_u32 s46, s44, 3235840
    s_waitcnt lgkmcnt(4)
    v_mfma_f32_32x32x16_bf16 v[32:47], v[24:27], a[72:75], v[32:47]
    buffer_load_dwordx4 v3, s[16:19], s46 offen lds
    s_mov_b32 m0, 132080
    s_add_u32 s46, s44, 3268608
    v_mfma_f32_32x32x16_bf16 v[48:63], v[24:27], a[200:203], v[48:63]
    buffer_load_dwordx4 v3, s[16:19], s46 offen lds
    s_cmp_le_i32 s40, 30
    s_cselect_b32 s14, 0x80000, 0
    s_cselect_b32 s38, s36, s39
    v_mfma_f32_32x32x16_bf16 v[64:79], v[24:27], v[200:203], v[64:79]
    ds_read_b64_tr_b16 v[20:21], v4 offset:640
    ds_read_b64_tr_b16 v[22:23], v4 offset:1680
    s_add_u32 m0, s38, 49920
    s_nop 0
    buffer_load_dwordx4 v5, s[12:15], s42 offen nt lds
    s_add_u32 m0, s38, 49936
    s_waitcnt lgkmcnt(4)
    v_mfma_f32_32x32x16_bf16 v[32:47], v[28:31], a[76:79], v[32:47]
    buffer_load_dwordx4 v5, s[12:15], s42 offen offset:1024 nt lds
    s_add_u32 m0, s38, 49952
    v_mfma_f32_32x32x16_bf16 v[48:63], v[28:31], a[204:207], v[48:63]
    buffer_load_dwordx4 v5, s[12:15], s42 offen offset:2048 nt lds
    s_add_u32 m0, s38, 49968
    v_mfma_f32_32x32x16_bf16 v[64:79], v[28:31], v[204:207], v[64:79]
    ds_read_b64_tr_b16 v[24:25], v4 offset:768
    ds_read_b64_tr_b16 v[26:27], v4 offset:1808
    buffer_load_dwordx4 v5, s[12:15], s42 offen offset:3072 nt lds
    s_add_u32 s42, s42, 16384
    s_and_b32 s42, s42, 0x7ffff
    s_waitcnt lgkmcnt(4)
    v_mfma_f32_32x32x16_bf16 v[32:47], v[16:19], a[80:83], v[32:47]
    v_mfma_f32_32x32x16_bf16 v[48:63], v[16:19], a[208:211], v[48:63]
    v_mfma_f32_32x32x16_bf16 v[64:79], v[16:19], v[208:211], v[64:79]
    ds_read_b64_tr_b16 v[28:29], v4 offset:896
    ds_read_b64_tr_b16 v[30:31], v4 offset:1936
    s_waitcnt lgkmcnt(4)
    v_mfma_f32_32x32x16_bf16 v[32:47], v[20:23], a[84:87], v[32:47]
    v_mfma_f32_32x32x16_bf16 v[48:63], v[20:23], a[212:215], v[48:63]
    v_mfma_f32_32x32x16_bf16 v[64:79], v[20:23], v[212:215], v[64:79]
    ds_read_b64_tr_b16 v[16:17], v4 offset:64
    ds_read_b64_tr_b16 v[18:19], v4 offset:1104
    s_waitcnt lgkmcnt(4)
    v_mfma_f32_32x32x16_bf16 v[32:47], v[24:27], a[88:91], v[32:47]
    v_mfma_f32_32x32x16_bf16 v[48:63], v[24:27], a[216:219], v[48:63]
    v_mfma_f32_32x32x16_bf16 v[64:79], v[24:27], v[216:219], v[64:79]
    ds_read_b64_tr_b16 v[20:21], v4 offset:192
    ds_read_b64_tr_b16 v[22:23], v4 offset:1232
    s_waitcnt lgkmcnt(4)
    v_mfma_f32_32x32x16_bf16 v[32:47], v[28:31], a[92:95], v[32:47]
    v_mfma_f32_32x32x16_bf16 v[48:63], v[28:31], a[220:223], v[48:63]
    v_mfma_f32_32x32x16_bf16 v[64:79], v[28:31], v[220:223], v[64:79]
    s_waitcnt lgkmcnt(2)
    v_mfma_f32_32x32x16_bf16 v[80:95], v[16:19], a[64:67], v[80:95]
    ds_read_b64_tr_b16 v[24:25], v4 offset:320
    ds_read_b64_tr_b16 v[26:27], v4 offset:1360
    v_mfma_f32_32x32x16_bf16 v[96:111], v[16:19], a[192:195], v[96:111]
    v_mfma_f32_32x32x16_bf16 v[112:127], v[16:19], v[192:195], v[112:127]
    s_waitcnt lgkmcnt(2)
    v_mfma_f32_32x32x16_bf16 v[80:95], v[20:23], a[68:71], v[80:95]
    ds_read_b64_tr_b16 v[28:29], v4 offset:448
    ds_read_b64_tr_b16 v[30:31], v4 offset:1488
    v_mfma_f32_32x32x16_bf16 v[96:111], v[20:23], a[196:199], v[96:111]
    v_mfma_f32_32x32x16_bf16 v[112:127], v[20:23], v[196:199], v[112:127]
    s_waitcnt vmcnt(40)
    s_barrier
    ds_read_b64_tr_b16 v[16:17], v4 offset:576
    ds_read_b64_tr_b16 v[18:19], v4 offset:1616
    s_waitcnt lgkmcnt(4)
    v_mfma_f32_32x32x16_bf16 v[80:95], v[24:27], a[72:75], v[80:95]
    s_cmp_le_i32 s40, 28
    s_cselect_b32 s10, 0x80000, 0
    s_cselect_b32 s37, s36, s39
    s_add_u32 m0, s37, 16640
    s_nop 0
    buffer_load_dwordx4 v5, s[8:11], s41 offen nt lds
    s_add_u32 m0, s37, 16656
    v_mfma_f32_32x32x16_bf16 v[96:111], v[24:27], a[200:203], v[96:111]
    buffer_load_dwordx4 v5, s[8:11], s41 offen offset:1024 nt lds
    s_add_u32 m0, s37, 16672
    s_nop 0
    buffer_load_dwordx4 v5, s[8:11], s41 offen offset:2048 nt lds
    s_add_u32 m0, s37, 16688
    v_mfma_f32_32x32x16_bf16 v[112:127], v[24:27], v[200:203], v[112:127]
    ds_read_b64_tr_b16 v[20:21], v4 offset:704
    ds_read_b64_tr_b16 v[22:23], v4 offset:1744
    buffer_load_dwordx4 v5, s[8:11], s41 offen offset:3072 nt lds
    s_add_u32 s41, s41, 16384
    s_and_b32 s41, s41, 0x7ffff
    s_waitcnt lgkmcnt(4)
    v_mfma_f32_32x32x16_bf16 v[80:95], v[28:31], a[76:79], v[80:95]
    s_cmp_lg_u32 s40, s94
    s_cbranch_scc1 L_nn2
    s_mov_b64 exec, 1
    buffer_atomic_cmpswap v[12:13], v14, s[84:87], 0 offen sc0 sc1
    s_mov_b64 exec, -1
L_nn2:
    v_mfma_f32_32x32x16_bf16 v[96:111], v[28:31], a[204:207], v[96:111]
    s_cmp_ge_i32 s40, 6
    s_cselect_b32 s22, 0x80000, 0
    s_cselect_b32 s76, s43, s75
    s_mov_b32 m0, 66560
    s_add_u32 s45, s76, 0
    buffer_load_dwordx4 v2, s[20:23], s45 offen lds
    v_mfma_f32_32x32x16_bf16 v[112:127], v[28:31], v[204:207], v[112:127]
    ds_read_b64_tr_b16 v[24:25], v4 offset:832
    ds_read_b64_tr_b16 v[26:27], v4 offset:1872
    s_mov_b32 m0, 69696
    s_nop 0
    buffer_load_dwordx4 v2, s[20:23], s45 offen offset:1024 lds
    s_mov_b32 m0, 72832
    s_nop 0
    buffer_load_dwordx4 v2, s[20:23], s45 offen offset:2048 lds
    s_waitcnt lgkmcnt(4)
    v_mfma_f32_32x32x16_bf16 v[80:95], v[16:19], a[80:83], v[80:95]
    s_mov_b32 m0, 75968
    s_nop 0
    buffer_load_dwordx4 v2, s[20:23], s45 offen offset:3072 lds
    s_mov_b32 m0, 67600
    s_add_u32 s45, s76, 4096
    v_mfma_f32_32x32x16_bf16 v[96:111], v[16:19], a[208:211], v[96:111]
    buffer_load_dwordx4 v2, s[20:23], s45 offen lds
    s_mov_b32 m0, 70736
    s_nop 0
    buffer_load_dwordx4 v2, s[20:23], s45 offen offset:1024 lds
    s_mov_b32 m0, 73872
    v_mfma_f32_32x32x16_bf16 v[112:127], v[16:19], v[208:211], v[112:127]
    ds_read_b64_tr_b16 v[28:29], v4 offset:960
    ds_read_b64_tr_b16 v[30:31], v4 offset:2000
    buffer_load_dwordx4 v2, s[20:23], s45 offen offset:2048 lds
    s_mov_b32 m0, 77008
    s_nop 0
    buffer_load_dwordx4 v2, s[20:23], s45 offen offset:3072 lds
    s_mov_b32 m0, 68640
    s_waitcnt lgkmcnt(4)
    v_mfma_f32_32x32x16_bf16 v[80:95], v[20:23], a[84:87], v[80:95]
    s_add_u32 s45, s76, 8192
    buffer_load_dwordx4 v2, s[20:23], s45 offen lds
    s_mov_b32 m0, 71776
    s_nop 0
    buffer_load_dwordx4 v2, s[20:23], s45 offen offset:1024 lds
    v_mfma_f32_32x32x16_bf16 v[96:111], v[20:23], a[212:215], v[96:111]
    s_mov_b32 m0, 74912
    s_nop 0
    buffer_load_dwordx4 v2, s[20:23], s45 offen offset:2048 lds
    s_mov_b32 m0, 78048
    s_nop 0
    buffer_load_dwordx4 v2, s[20:23], s45 offen offset:3072 lds
    v_mfma_f32_32x32x16_bf16 v[112:127], v[20:23], v[212:215], v[112:127]
    s_mov_b32 m0, 69680
    s_add_u32 s45, s76, 12288
    buffer_load_dwordx4 v2, s[20:23], s45 offen lds
    s_mov_b32 m0, 72816
    s_waitcnt lgkmcnt(2)
    v_mfma_f32_32x32x16_bf16 v[80:95], v[24:27], a[88:91], v[80:95]
    buffer_load_dwordx4 v2, s[20:23], s45 offen offset:1024 lds
    s_mov_b32 m0, 75952
    s_nop 0
    buffer_load_dwordx4 v2, s[20:23], s45 offen offset:2048 lds
    s_mov_b32 m0, 79088
    v_mfma_f32_32x32x16_bf16 v[96:111], v[24:27], a[216:219], v[96:111]
    buffer_load_dwordx4 v2, s[20:23], s45 offen offset:3072 lds
    s_add_u32 s43, s43, 16384
    s_and_b32 s43, s43, 0x7ffff
    s_add_u32 s40, s40, 1
    v_mfma_f32_32x32x16_bf16 v[112:127], v[24:27], v[216:219], v[112:127]
    s_waitcnt lgkmcnt(0)
    v_mfma_f32_32x32x16_bf16 v[80:95], v[28:31], a[92:95], v[80:95]
    v_mfma_f32_32x32x16_bf16 v[96:111], v[28:31], a[220:223], v[96:111]
    v_mfma_f32_32x32x16_bf16 v[112:127], v[28:31], v[220:223], v[112:127]
    s_waitcnt vmcnt(40)
    s_barrier
    s_cmp_le_i32 s40, 20
    s_cselect_b32 s18, s47, 0
    s_add_u32 s74, s74, 128
    s_and_b32 s74, s74, 1023
    s_xor_b32 s44, s74, s73
    s_mov_b32 m0, 99840
    s_add_u32 s46, s44, 0
    buffer_load_dwordx4 v3, s[16:19], s46 offen lds
    s_mov_b32 m0, 100880
    s_add_u32 s46, s44, 32768
    buffer_load_dwordx4 v3, s[16:19], s46 offen lds
    s_mov_b32 m0, 101920
    s_add_u32 s46, s44, 65536
    buffer_load_dwordx4 v3, s[16:19], s46 offen lds
    s_mov_b32 m0, 102960
    s_add_u32 s46, s44, 98304
    buffer_load_dwordx4 v3, s[16:19], s46 offen lds
    s_mov_b32 m0, 104000
    s_add_u32 s46, s44, 8192
    buffer_load_dwordx4 v3, s[16:19], s46 offen lds
    s_mov_b32 m0, 105040
    s_add_u32 s46, s44, 40960
    buffer_load_dwordx4 v3, s[16:19], s46 offen lds
    s_mov_b32 m0, 106080
    s_add_u32 s46, s44, 73728
    buffer_load_dwordx4 v3, s[16:19], s46 offen lds
    s_mov_b32 m0, 107120
    s_add_u32 s46, s44, 106496
    buffer_load_dwordx4 v3, s[16:19], s46 offen lds
    s_nop 0
    s_waitcnt vmcnt(32)
    ds_read_b64_tr_b16 v[16:17], v4 offset:16640
    ds_read_b64_tr_b16 v[18:19], v4 offset:17680
    ds_read_b64_tr_b16 v[20:21], v4 offset:16768
    ds_read_b64_tr_b16 v[22:23], v4 offset:17808
    ds_read_b64_tr_b16 v[24:25], v4 offset:16896
    ds_read_b64_tr_b16 v[26:27], v4 offset:17936
    s_waitcnt lgkmcnt(4)
    v_mfma_f32_32x32x16_bf16 v[32:47], v[16:19], a[96:99], v[32:47]
    s_mov_b32 m0, 108160
    s_add_u32 s46, s44, 16384
    buffer_load_dwordx4 v3, s[16:19], s46 offen lds
    s_mov_b32 m0, 109200
    v_mfma_f32_32x32x16_bf16 v[48:63], v[16:19], a[224:227], v[48:63]
    s_add_u32 s46, s44, 49152
    buffer_load_dwordx4 v3, s[16:19], s46 offen lds
    s_mov_b32 m0, 110240
    s_add_u32 s46, s44, 81920
    v_mfma_f32_32x32x16_bf16 v[64:79], v[16:19], v[224:227], v[64:79]
    ds_read_b64_tr_b16 v[28:29], v4 offset:17024
    ds_read_b64_tr_b16 v[30:31], v4 offset:18064
    buffer_load_dwordx4 v3, s[16:19], s46 offen lds
    s_mov_b32 m0, 111280
    s_add_u32 s46, s44, 114688
    s_waitcnt lgkmcnt(4)
    v_mfma_f32_32x32x16_bf16 v[32:47], v[20:23], a[100:103], v[32:47]
    buffer_load_dwordx4 v3, s[16:19], s46 offen lds
    s_mov_b32 m0, 112320
    s_add_u32 s46, s44, 24576
    v_mfma_f32_32x32x16_bf16 v[48:63], v[20:23], a[228:231], v[48:63]
    buffer_load_dwordx4 v3, s[16:19], s46 offen lds
    s_mov_b32 m0, 113360
    s_add_u32 s46, s44, 57344
    v_mfma_f32_32x32x16_bf16 v[64:79], v[20:23], v[228:231], v[64:79]
    ds_read_b64_tr_b16 v[16:17], v4 offset:17152
    ds_read_b64_tr_b16 v[18:19], v4 offset:18192
    buffer_load_dwordx4 v3, s[16:19], s46 offen lds
    s_mov_b32 m0, 114400
    s_add_u32 s46, s44, 90112
    s_waitcnt lgkmcnt(4)
    v_mfma_f32_32x32x16_bf16 v[32:47], v[24:27], a[104:107], v[32:47]
    buffer_load_dwordx4 v3, s[16:19], s46 offen lds
    s_mov_b32 m0, 115440
    s_add_u32 s46, s44, 122880
    v_mfma_f32_32x32x16_bf16 v[48:63], v[24:27], a[232:235], v[48:63]
    buffer_load_dwordx4 v3, s[16:19], s46 offen lds
    s_cmp_le_i32 s40, 30
    s_cselect_b32 s14, 0x80000, 0
    s_cselect_b32 s38, s36, s39
    v_mfma_f32_32x32x16_bf16 v[64:79], v[24:27], v[232:235], v[64:79]
    ds_read_b64_tr_b16 v[20:21], v4 offset:17280
    ds_read_b64_tr_b16 v[22:23], v4 offset:18320
    s_add_u32 m0, s38, 33280
    s_nop 0
    buffer_load_dwordx4 v5, s[12:15], s42 offen nt lds
    s_add_u32 m0, s38, 33296
    s_waitcnt lgkmcnt(4)
    v_mfma_f32_32x32x16_bf16 v[32:47], v[28:31], a[108:111], v[32:47]
    buffer_load_dwordx4 v5, s[12:15], s42 offen offset:1024 nt lds
    s_add_u32 m0, s38, 33312
    v_mfma_f32_32x32x16_bf16 v[48:63], v[28:31], a[236:239], v[48:63]
    buffer_load_dwordx4 v5, s[12:15], s42 offen offset:2048 nt lds
    s_add_u32 m0, s38, 33328
    v_mfma_f32_32x32x16_bf16 v[64:79], v[28:31], v[236:239], v[64:79]
    ds_read_b64_tr_b16 v[24:25], v4 offset:17408
    ds_read_b64_tr_b16 v[26:27], v4 offset:18448
    buffer_load_dwordx4 v5, s[12:15], s42 offen offset:3072 nt lds
    s_add_u32 s42, s42, 16384
    s_and_b32 s42, s42, 0x7ffff
    s_waitcnt lgkmcnt(4)
    v_mfma_f32_32x32x16_bf16 v[32:47], v[16:19], a[112:115], v[32:47]
    v_mfma_f32_32x32x16_bf16 v[48:63], v[16:19], a[240:243], v[48:63]
    v_mfma_f32_32x32x16_bf16 v[64:79], v[16:19], v[240:243], v[64:79]
    ds_read_b64_tr_b16 v[28:29], v4 offset:17536
    ds_read_b64_tr_b16 v[30:31], v4 offset:18576
    s_waitcnt lgkmcnt(4)
    v_mfma_f32_32x32x16_bf16 v[32:47], v[20:23], a[116:119], v[32:47]
    v_mfma_f32_32x32x16_bf16 v[48:63], v[20:23], a[244:247], v[48:63]
    v_mfma_f32_32x32x16_bf16 v[64:79], v[20:23], v[244:247], v[64:79]
    ds_read_b64_tr_b16 v[16:17], v4 offset:16704
    ds_read_b64_tr_b16 v[18:19], v4 offset:17744
    s_waitcnt lgkmcnt(4)
    v_mfma_f32_32x32x16_bf16 v[32:47], v[24:27], a[120:123], v[32:47]
    v_mfma_f32_32x32x16_bf16 v[48:63], v[24:27], a[248:251], v[48:63]
    v_mfma_f32_32x32x16_bf16 v[64:79], v[24:27], v[248:251], v[64:79]
    ds_read_b64_tr_b16 v[20:21], v4 offset:16832
    ds_read_b64_tr_b16 v[22:23], v4 offset:17872
    s_waitcnt lgkmcnt(4)
    v_mfma_f32_32x32x16_bf16 v[32:47], v[28:31], a[124:127], v[32:47]
    v_mfma_f32_32x32x16_bf16 v[48:63], v[28:31], a[252:255], v[48:63]
    v_mfma_f32_32x32x16_bf16 v[64:79], v[28:31], v[252:255], v[64:79]
    s_waitcnt lgkmcnt(2)
    v_mfma_f32_32x32x16_bf16 v[80:95], v[16:19], a[96:99], v[80:95]
    ds_read_b64_tr_b16 v[24:25], v4 offset:16960
    ds_read_b64_tr_b16 v[26:27], v4 offset:18000
    v_mfma_f32_32x32x16_bf16 v[96:111], v[16:19], a[224:227], v[96:111]
    v_mfma_f32_32x32x16_bf16 v[112:127], v[16:19], v[224:227], v[112:127]
    s_waitcnt lgkmcnt(2)
    v_mfma_f32_32x32x16_bf16 v[80:95], v[20:23], a[100:103], v[80:95]
    ds_read_b64_tr_b16 v[28:29], v4 offset:17088
    ds_read_b64_tr_b16 v[30:31], v4 offset:18128
    v_mfma_f32_32x32x16_bf16 v[96:111], v[20:23], a[228:231], v[96:111]
    v_mfma_f32_32x32x16_bf16 v[112:127], v[20:23], v[228:231], v[112:127]
    s_waitcnt vmcnt(40)
    s_barrier
    ds_read_b64_tr_b16 v[16:17], v4 offset:17216
    ds_read_b64_tr_b16 v[18:19], v4 offset:18256
    s_waitcnt lgkmcnt(4)
    v_mfma_f32_32x32x16_bf16 v[80:95], v[24:27], a[104:107], v[80:95]
    s_cmp_le_i32 s40, 28
    s_cselect_b32 s10, 0x80000, 0
    s_cselect_b32 s37, s36, s39
    v_mul_f32 v32, s33, v32
    s_add_u32 m0, s37, 0
    v_mul_f32 v33, s33, v33
    buffer_load_dwordx4 v5, s[8:11], s41 offen nt lds
    v_mul_f32 v34, s33, v34
    s_add_u32 m0, s37, 16
    v_mul_f32 v35, s33, v35
    v_mfma_f32_32x32x16_bf16 v[96:111], v[24:27], a[232:235], v[96:111]
    buffer_load_dwordx4 v5, s[8:11], s41 offen offset:1024 nt lds
    v_cvt_pk_bf16_f32 v32, v32, v33
    s_add_u32 m0, s37, 32
    v_mul_f32 v36, s33, v36
    buffer_load_dwordx4 v5, s[8:11], s41 offen offset:2048 nt lds
    v_mul_f32 v37, s33, v37
    s_add_u32 m0, s37, 48
    v_cvt_pk_bf16_f32 v33, v34, v35
    v_mfma_f32_32x32x16_bf16 v[112:127], v[24:27], v[232:235], v[112:127]
    ds_read_b64_tr_b16 v[20:21], v4 offset:17344
    ds_read_b64_tr_b16 v[22:23], v4 offset:18384
    buffer_load_dwordx4 v5, s[8:11], s41 offen offset:3072 nt lds
    v_mul_f32 v38, s33, v38
    s_add_u32 s41, s41, 16384
    s_and_b32 s41, s41, 0x7ffff
    v_mul_f32 v39, s33, v39
    s_waitcnt lgkmcnt(4)
    v_mfma_f32_32x32x16_bf16 v[80:95], v[28:31], a[108:111], v[80:95]
    s_cmp_lg_u32 s40, s94
    s_cbranch_scc1 L_nn3
    s_mov_b64 exec, 1
    buffer_atomic_cmpswap v[12:13], v14, s[84:87], 0 offen sc0 sc1
    s_mov_b64 exec, -1
L_nn3:
    v_cvt_pk_bf16_f32 v34, v36, v37
    s_cmp_ge_i32 s40, 6
    s_cselect_b32 s22, 0x80000, 0
    s_cselect_b32 s76, s43, s75
    v_mul_f32 v40, s33, v40
    s_mov_b32 m0, 83200
    v_mfma_f32_32x32x16_bf16 v[96:111], v[28:31], a[236:239], v[96:111]
    v_mul_f32 v41, s33, v41
    s_add_u32 s45, s76, 0
    v_cvt_pk_bf16_f32 v35, v38, v39
    buffer_load_dwordx4 v2, s[20:23], s45 offen lds
    v_mul_f32 v42, s33, v42
    s_mov_b32 m0, 86336
    v_mul_f32 v43, s33, v43
    buffer_load_dwordx4 v2, s[20:23], s45 offen offset:1024 lds
    v_mfma_f32_32x32x16_bf16 v[112:127], v[28:31], v[236:239], v[112:127]
    ds_read_b64_tr_b16 v[24:25], v4 offset:17472
    ds_read_b64_tr_b16 v[26:27], v4 offset:18512
    v_cvt_pk_bf16_f32 v36, v40, v41
    s_mov_b32 m0, 89472
    v_mul_f32 v44, s33, v44
    buffer_load_dwordx4 v2, s[20:23], s45 offen offset:2048 lds
    v_mul_f32 v45, s33, v45
    s_mov_b32 m0, 92608
    v_cvt_pk_bf16_f32 v37, v42, v43
    buffer_load_dwordx4 v2, s[20:23], s45 offen offset:3072 lds
    s_waitcnt lgkmcnt(4)
    v_mfma_f32_32x32x16_bf16 v[80:95], v[16:19], a[112:115], v[80:95]
    v_mul_f32 v46, s33, v46
    s_mov_b32 m0, 84240
    v_mul_f32 v47, s33, v47
    s_add_u32 s45, s76, 4096
    v_cvt_pk_bf16_f32 v38, v44, v45
    buffer_load_dwordx4 v2, s[20:23], s45 offen lds
    v_cvt_pk_bf16_f32 v39, v46, v47
    s_mov_b32 m0, 87376
    ds_write_b128 v1, v[32:35] offset:0
    v_mfma_f32_32x32x16_bf16 v[96:111], v[16:19], a[240:243], v[96:111]
    buffer_load_dwordx4 v2, s[20:23], s45 offen offset:1024 lds
    ds_write_b128 v1, v[36:39] offset:1024
    s_mov_b32 m0, 90512
    v_mul_f32 v48, s33, v48
    buffer_load_dwordx4 v2, s[20:23], s45 offen offset:2048 lds
    v_mul_f32 v49, s33, v49
    s_mov_b32 m0, 93648
    v_mul_f32 v50, s33, v50
    v_mfma_f32_32x32x16_bf16 v[112:127], v[16:19], v[240:243], v[112:127]
    ds_read_b64_tr_b16 v[28:29], v4 offset:17600
    ds_read_b64_tr_b16 v[30:31], v4 offset:18640
    buffer_load_dwordx4 v2, s[20:23], s45 offen offset:3072 lds
    v_mul_f32 v51, s33, v51
    s_mov_b32 m0, 85280
    v_cvt_pk_bf16_f32 v48, v48, v49
    s_add_u32 s45, s76, 8192
    v_mul_f32 v52, s33, v52
    buffer_load_dwordx4 v2, s[20:23], s45 offen lds
    v_mul_f32 v53, s33, v53
    s_waitcnt lgkmcnt(6)
    v_mfma_f32_32x32x16_bf16 v[80:95], v[20:23], a[116:119], v[80:95]
    s_mov_b32 m0, 88416
    v_cvt_pk_bf16_f32 v49, v50, v51
    buffer_load_dwordx4 v2, s[20:23], s45 offen offset:1024 lds
    v_mul_f32 v54, s33, v54
    s_mov_b32 m0, 91552
    v_mul_f32 v55, s33, v55
    buffer_load_dwordx4 v2, s[20:23], s45 offen offset:2048 lds
    v_cvt_pk_bf16_f32 v50, v52, v53
    v_mfma_f32_32x32x16_bf16 v[96:111], v[20:23], a[244:247], v[96:111]
    s_mov_b32 m0, 94688
    v_mul_f32 v56, s33, v56
    buffer_load_dwordx4 v2, s[20:23], s45 offen offset:3072 lds
    v_mul_f32 v57, s33, v57
    s_mov_b32 m0, 86320
    v_cvt_pk_bf16_f32 v51, v54, v55
    s_add_u32 s45, s76, 12288
    v_mul_f32 v58, s33, v58
    v_mfma_f32_32x32x16_bf16 v[112:127], v[20:23], v[244:247], v[112:127]
    buffer_load_dwordx4 v2, s[20:23], s45 offen lds
    v_mul_f32 v59, s33, v59
    s_mov_b32 m0, 89456
    v_cvt_pk_bf16_f32 v52, v56, v57
    buffer_load_dwordx4 v2, s[20:23], s45 offen offset:1024 lds
    v_mul_f32 v60, s33, v60
    s_mov_b32 m0, 92592
    v_mul_f32 v61, s33, v61
    s_waitcnt lgkmcnt(4)
    v_mfma_f32_32x32x16_bf16 v[80:95], v[24:27], a[120:123], v[80:95]
    buffer_load_dwordx4 v2, s[20:23], s45 offen offset:2048 lds
    v_cvt_pk_bf16_f32 v53, v58, v59
    s_mov_b32 m0, 95728
    v_mul_f32 v62, s33, v62
    buffer_load_dwordx4 v2, s[20:23], s45 offen offset:3072 lds
    v_mul_f32 v63, s33, v63
    v_mfma_f32_32x32x16_bf16 v[96:111], v[24:27], a[248:251], v[96:111]
    s_add_u32 s43, s43, 16384
    s_and_b32 s43, s43, 0x7ffff
    s_add_u32 s40, s40, 1
    v_cvt_pk_bf16_f32 v54, v60, v61
    v_cvt_pk_bf16_f32 v55, v62, v63
    ds_write_b128 v1, v[48:51] offset:8192
    ds_write_b128 v1, v[52:55] offset:9216
    v_mul_f32 v64, s33, v64
    v_mul_f32 v65, s33, v65
    v_mul_f32 v66, s33, v66
    v_mul_f32 v67, s33, v67
    v_cvt_pk_bf16_f32 v64, v64, v65
    v_mul_f32 v68, s33, v68
    v_mfma_f32_32x32x16_bf16 v[112:127], v[24:27], v[248:251], v[112:127]
    v_mul_f32 v69, s33, v69
    v_cvt_pk_bf16_f32 v65, v66, v67
    v_mul_f32 v70, s33, v70
    v_mul_f32 v71, s33, v71
    v_cvt_pk_bf16_f32 v66, v68, v69
    v_mul_f32 v72, s33, v72
    v_mul_f32 v73, s33, v73
    v_cvt_pk_bf16_f32 v67, v70, v71
    v_mul_f32 v74, s33, v74
    v_mul_f32 v75, s33, v75
    v_cvt_pk_bf16_f32 v68, v72, v73
    v_mul_f32 v76, s33, v76
    v_mul_f32 v77, s33, v77
    s_waitcnt lgkmcnt(2)
    v_mfma_f32_32x32x16_bf16 v[80:95], v[28:31], a[124:127], v[80:95]
    v_cvt_pk_bf16_f32 v69, v74, v75
    v_mul_f32 v78, s33, v78
    v_mul_f32 v79, s33, v79
    v_cvt_pk_bf16_f32 v70, v76, v77
    v_cvt_pk_bf16_f32 v71, v78, v79
    ds_write_b128 v1, v[64:67] offset:16384
    ds_write_b128 v1, v[68:71] offset:17408
    v_mfma_f32_32x32x16_bf16 v[96:111], v[28:31], a[252:255], v[96:111]
    v_mfma_f32_32x32x16_bf16 v[112:127], v[28:31], v[252:255], v[112:127]
    s_waitcnt vmcnt(40)
    s_barrier
    s_cmp_le_i32 s40, 20
    s_cselect_b32 s18, s47, 0
    s_mov_b32 m0, 116480
    s_add_u32 s46, s44, 1048576
    buffer_load_dwordx4 v3, s[16:19], s46 offen lds
    s_mov_b32 m0, 117520
    s_add_u32 s46, s44, 1081344
    buffer_load_dwordx4 v3, s[16:19], s46 offen lds
    s_mov_b32 m0, 118560
    s_add_u32 s46, s44, 1114112
    buffer_load_dwordx4 v3, s[16:19], s46 offen lds
    s_mov_b32 m0, 119600
    s_add_u32 s46, s44, 1146880
    buffer_load_dwordx4 v3, s[16:19], s46 offen lds
    s_mov_b32 m0, 120640
    s_add_u32 s46, s44, 1056768
    buffer_load_dwordx4 v3, s[16:19], s46 offen lds
    s_mov_b32 m0, 121680
    s_add_u32 s46, s44, 1089536
    buffer_load_dwordx4 v3, s[16:19], s46 offen lds
    s_mov_b32 m0, 122720
    s_add_u32 s46, s44, 1122304
    buffer_load_dwordx4 v3, s[16:19], s46 offen lds
    s_mov_b32 m0, 123760
    s_add_u32 s46, s44, 1155072
    buffer_load_dwordx4 v3, s[16:19], s46 offen lds
    s_nop 0
    s_waitcnt vmcnt(32)
    ds_read_b64_tr_b16 v[16:17], v4 offset:0
    ds_read_b64_tr_b16 v[18:19], v4 offset:1040
    ds_read_b64_tr_b16 v[20:21], v4 offset:128
    ds_read_b64_tr_b16 v[22:23], v4 offset:1168
    ds_read_b64_tr_b16 v[24:25], v4 offset:256
    ds_read_b64_tr_b16 v[26:27], v4 offset:1296
    s_waitcnt lgkmcnt(4)
    v_mfma_f32_32x32x16_bf16 v[32:47], v[16:19], a[0:3], 0
    v_mul_f32 v80, s33, v80
    s_mov_b32 m0, 124800
    v_mul_f32 v81, s33, v81
    s_add_u32 s46, s44, 1064960
    v_mul_f32 v82, s33, v82
    v_mfma_f32_32x32x16_bf16 v[48:63], v[16:19], a[128:131], 0
    buffer_load_dwordx4 v3, s[16:19], s46 offen lds
    v_mul_f32 v83, s33, v83
    s_mov_b32 m0, 125840
    v_cvt_pk_bf16_f32 v80, v80, v81
    v_mfma_f32_32x32x16_bf16 v[64:79], v[16:19], v[128:131], 0
    ds_read_b64_tr_b16 v[28:29], v4 offset:384
    ds_read_b64_tr_b16 v[30:31], v4 offset:1424
    s_add_u32 s46, s44, 1097728
    v_mul_f32 v84, s33, v84
    buffer_load_dwordx4 v3, s[16:19], s46 offen lds
    s_waitcnt lgkmcnt(4)
    v_mfma_f32_32x32x16_bf16 v[32:47], v[20:23], a[4:7], v[32:47]
    v_mul_f32 v85, s33, v85
    s_mov_b32 m0, 126880
    v_cvt_pk_bf16_f32 v81, v82, v83
    s_add_u32 s46, s44, 1130496
    v_mul_f32 v86, s33, v86
    v_mfma_f32_32x32x16_bf16 v[48:63], v[20:23], a[132:135], v[48:63]
    buffer_load_dwordx4 v3, s[16:19], s46 offen lds
    v_mul_f32 v87, s33, v87
    s_mov_b32 m0, 127920
    v_cvt_pk_bf16_f32 v82, v84, v85
    v_mfma_f32_32x32x16_bf16 v[64:79], v[20:23], v[132:135], v[64:79]
    ds_read_b64_tr_b16 v[16:17], v4 offset:512
    ds_read_b64_tr_b16 v[18:19], v4 offset:1552
    s_add_u32 s46, s44, 1163264
    v_mul_f32 v88, s33, v88
    buffer_load_dwordx4 v3, s[16:19], s46 offen lds
    s_waitcnt lgkmcnt(4)
    v_mfma_f32_32x32x16_bf16 v[32:47], v[24:27], a[8:11], v[32:47]
    v_mul_f32 v89, s33, v89
    s_mov_b32 m0, 128960
    v_cvt_pk_bf16_f32 v83, v86, v87
    s_add_u32 s46, s44, 1073152
    v_mul_f32 v90, s33, v90
    v_mfma_f32_32x32x16_bf16 v[48:63], v[24:27], a[136:139], v[48:63]
    buffer_load_dwordx4 v3, s[16:19], s46 offen lds
    v_mul_f32 v91, s33, v91
    s_mov_b32 m0, 130000
    v_cvt_pk_bf16_f32 v84, v88, v89
    v_mfma_f32_32x32x16_bf16 v[64:79], v[24:27], v[136:139], v[64:79]
    ds_read_b64_tr_b16 v[20:21], v4 offset:640
    ds_read_b64_tr_b16 v[22:23], v4 offset:1680
    s_add_u32 s46, s44, 1105920
    v_mul_f32 v92, s33, v92
    buffer_load_dwordx4 v3, s[16:19], s46 offen lds
    s_waitcnt lgkmcnt(4)
    v_mfma_f32_32x32x16_bf16 v[32:47], v[28:31], a[12:15], v[32:47]
    v_mul_f32 v93, s33, v93
    s_mov_b32 m0, 131040
    v_cvt_pk_bf16_f32 v85, v90, v91
    s_add_u32 s46, s44, 1138688
    v_mul_f32 v94, s33, v94
    v_mfma_f32_32x32x16_bf16 v[48:63], v[28:31], a[140:143], v[48:63]
    buffer_load_dwordx4 v3, s[16:19], s46 offen lds
    v_mul_f32 v95, s33, v95
    s_mov_b32 m0, 132080
    v_cvt_pk_bf16_f32 v86, v92, v93
    v_mfma_f32_32x32x16_bf16 v[64:79], v[28:31], v[140:143], v[64:79]
    ds_read_b64_tr_b16 v[24:25], v4 offset:768
    ds_read_b64_tr_b16 v[26:27], v4 offset:1808
    s_add_u32 s46, s44, 1171456
    v_cvt_pk_bf16_f32 v87, v94, v95
    buffer_load_dwordx4 v3, s[16:19], s46 offen lds
    s_waitcnt lgkmcnt(4)
    v_mfma_f32_32x32x16_bf16 v[32:47], v[16:19], a[16:19], v[32:47]
    ds_write_b128 v1, v[80:83] offset:2048
    s_cmp_le_i32 s40, 30
    s_cselect_b32 s14, 0x80000, 0
    s_cselect_b32 s38, s36, s39
    ds_write_b128 v1, v[84:87] offset:3072
    s_add_u32 m0, s38, 49920
    v_mfma_f32_32x32x16_bf16 v[48:63], v[16:19], a[144:147], v[48:63]
    v_mul_f32 v96, s33, v96
    buffer_load_dwordx4 v5, s[12:15], s42 offen nt lds
    v_mul_f32 v97, s33, v97
    s_add_u32 m0, s38, 49936
    v_mfma_f32_32x32x16_bf16 v[64:79], v[16:19], v[144:147], v[64:79]
    ds_read_b64_tr_b16 v[28:29], v4 offset:896
    ds_read_b64_tr_b16 v[30:31], v4 offset:1936
    v_mul_f32 v98, s33, v98
    buffer_load_dwordx4 v5, s[12:15], s42 offen offset:1024 nt lds
    v_mul_f32 v99, s33, v99
    s_waitcnt lgkmcnt(6)
    v_mfma_f32_32x32x16_bf16 v[32:47], v[20:23], a[20:23], v[32:47]
    s_add_u32 m0, s38, 49952
    v_cvt_pk_bf16_f32 v96, v96, v97
    buffer_load_dwordx4 v5, s[12:15], s42 offen offset:2048 nt lds
    v_mul_f32 v100, s33, v100
    v_mfma_f32_32x32x16_bf16 v[48:63], v[20:23], a[148:151], v[48:63]
    s_add_u32 m0, s38, 49968
    v_mul_f32 v101, s33, v101
    buffer_load_dwordx4 v5, s[12:15], s42 offen offset:3072 nt lds
    v_cvt_pk_bf16_f32 v97, v98, v99
    v_mfma_f32_32x32x16_bf16 v[64:79], v[20:23], v[148:151], v[64:79]
    ds_read_b64_tr_b16 v[16:17], v4 offset:64
    ds_read_b64_tr_b16 v[18:19], v4 offset:1104
    s_add_u32 s42, s42, 16384
    s_and_b32 s42, s42, 0x7ffff
    v_mul_f32 v102, s33, v102
    v_mul_f32 v103, s33, v103
    v_cvt_pk_bf16_f32 v98, v100, v101
    s_waitcnt lgkmcnt(6)
    v_mfma_f32_32x32x16_bf16 v[32:47], v[24:27], a[24:27], v[32:47]
    v_mul_f32 v104, s33, v104
    v_mul_f32 v105, s33, v105
    v_cvt_pk_bf16_f32 v99, v102, v103
    v_mul_f32 v106, s33, v106
    v_mul_f32 v107, s33, v107
    v_cvt_pk_bf16_f32 v100, v104, v105
    v_mfma_f32_32x32x16_bf16 v[48:63], v[24:27], a[152:155], v[48:63]
    v_mul_f32 v108, s33, v108
    v_mul_f32 v109, s33, v109
    v_cvt_pk_bf16_f32 v101, v106, v107
    v_mul_f32 v110, s33, v110
    v_mul_f32 v111, s33, v111
    v_cvt_pk_bf16_f32 v102, v108, v109
    v_mfma_f32_32x32x16_bf16 v[64:79], v[24:27], v[152:155], v[64:79]
    ds_read_b64_tr_b16 v[20:21], v4 offset:192
    ds_read_b64_tr_b16 v[22:23], v4 offset:1232
    v_cvt_pk_bf16_f32 v103, v110, v111
    ds_write_b128 v1, v[96:99] offset:10240
    ds_write_b128 v1, v[100:103] offset:11264
    v_mul_f32 v112, s33, v112
    v_mul_f32 v113, s33, v113
    s_waitcnt lgkmcnt(6)
    v_mfma_f32_32x32x16_bf16 v[32:47], v[28:31], a[28:31], v[32:47]
    v_mul_f32 v114, s33, v114
    v_mul_f32 v115, s33, v115
    v_cvt_pk_bf16_f32 v112, v112, v113
    v_mul_f32 v116, s33, v116
    v_mul_f32 v117, s33, v117
    v_cvt_pk_bf16_f32 v113, v114, v115
    v_mfma_f32_32x32x16_bf16 v[48:63], v[28:31], a[156:159], v[48:63]
    v_mul_f32 v118, s33, v118
    v_mul_f32 v119, s33, v119
    v_cvt_pk_bf16_f32 v114, v116, v117
    v_mul_f32 v120, s33, v120
    v_mul_f32 v121, s33, v121
    v_cvt_pk_bf16_f32 v115, v118, v119
    v_mfma_f32_32x32x16_bf16 v[64:79], v[28:31], v[156:159], v[64:79]
    v_mul_f32 v122, s33, v122
    v_mul_f32 v123, s33, v123
    v_cvt_pk_bf16_f32 v116, v120, v121
    v_mul_f32 v124, s33, v124
    v_mul_f32 v125, s33, v125
    v_cvt_pk_bf16_f32 v117, v122, v123
    s_waitcnt lgkmcnt(4)
    v_mfma_f32_32x32x16_bf16 v[80:95], v[16:19], a[0:3], 0
    ds_read_b64_tr_b16 v[24:25], v4 offset:320
    ds_read_b64_tr_b16 v[26:27], v4 offset:1360
    v_mul_f32 v126, s33, v126
    v_mul_f32 v127, s33, v127
    v_cvt_pk_bf16_f32 v118, v124, v125
    v_cvt_pk_bf16_f32 v119, v126, v127
    v_mfma_f32_32x32x16_bf16 v[96:111], v[16:19], a[128:131], 0
    ds_write_b128 v1, v[112:115] offset:18432
    ds_write_b128 v1, v[116:119] offset:19456
    s_nop 1
    v_xor_b32 v1, 0x1000, v1
    v_mfma_f32_32x32x16_bf16 v[112:127], v[16:19], v[128:131], 0
    s_waitcnt lgkmcnt(6)
    v_mfma_f32_32x32x16_bf16 v[80:95], v[20:23], a[4:7], v[80:95]
    ds_read_b64_tr_b16 v[28:29], v4 offset:448
    ds_read_b64_tr_b16 v[30:31], v4 offset:1488
    v_mfma_f32_32x32x16_bf16 v[96:111], v[20:23], a[132:135], v[96:111]
    v_mfma_f32_32x32x16_bf16 v[112:127], v[20:23], v[132:135], v[112:127]
    s_waitcnt vmcnt(40)
    s_barrier
    ds_read_b64_tr_b16 v[16:17], v4 offset:576
    ds_read_b64_tr_b16 v[18:19], v4 offset:1616
    s_waitcnt lgkmcnt(6)
    v_mfma_f32_32x32x16_bf16 v[80:95], v[24:27], a[8:11], v[80:95]
    s_cmp_le_i32 s40, 28
    s_cselect_b32 s10, 0x80000, 0
    s_cselect_b32 s37, s36, s39
    s_add_u32 m0, s37, 16640
    v_mfma_f32_32x32x16_bf16 v[96:111], v[24:27], a[136:139], v[96:111]
    buffer_load_dwordx4 v5, s[8:11], s41 offen nt lds
    s_add_u32 m0, s37, 16656
    v_mfma_f32_32x32x16_bf16 v[112:127], v[24:27], v[136:139], v[112:127]
    ds_read_b64_tr_b16 v[20:21], v4 offset:704
    ds_read_b64_tr_b16 v[22:23], v4 offset:1744
    buffer_load_dwordx4 v5, s[8:11], s41 offen offset:1024 nt lds
    s_add_u32 m0, s37, 16672
    s_waitcnt lgkmcnt(4)
    v_mfma_f32_32x32x16_bf16 v[80:95], v[28:31], a[12:15], v[80:95]
    buffer_load_dwordx4 v5, s[8:11], s41 offen offset:2048 nt lds
    s_add_u32 m0, s37, 16688
    v_mfma_f32_32x32x16_bf16 v[96:111], v[28:31], a[140:143], v[96:111]
    buffer_load_dwordx4 v5, s[8:11], s41 offen offset:3072 nt lds
    s_add_u32 s41, s41, 16384
    s_and_b32 s41, s41, 0x7ffff
    v_mfma_f32_32x32x16_bf16 v[112:127], v[28:31], v[140:143], v[112:127]
    ds_read_b64_tr_b16 v[24:25], v4 offset:832
    ds_read_b64_tr_b16 v[26:27], v4 offset:1872
    s_cmp_lg_u32 s40, s94
    s_cbranch_scc1 L_nn4
    s_mov_b64 exec, 1
    buffer_atomic_cmpswap v[12:13], v14, s[84:87], 0 offen sc0 sc1
    s_mov_b64 exec, -1
L_nn4:
    s_waitcnt lgkmcnt(4)
    v_mfma_f32_32x32x16_bf16 v[80:95], v[16:19], a[16:19], v[80:95]
    s_cmp_ge_i32 s40, 6
    s_cselect_b32 s22, 0x80000, 0
    s_cselect_b32 s76, s43, s75
    s_mov_b32 m0, 66560
    s_add_u32 s45, s76, 0
    v_mfma_f32_32x32x16_bf16 v[96:111], v[16:19], a[144:147], v[96:111]
    buffer_load_dwordx4 v2, s[20:23], s45 offen lds
    s_mov_b32 m0, 69696
    v_mfma_f32_32x32x16_bf16 v[112:127], v[16:19], v[144:147], v[112:127]
    ds_read_b64_tr_b16 v[28:29], v4 offset:960
    ds_read_b64_tr_b16 v[30:31], v4 offset:2000
    buffer_load_dwordx4 v2, s[20:23], s45 offen offset:1024 lds
    s_mov_b32 m0, 72832
    s_nop 0
    buffer_load_dwordx4 v2, s[20:23], s45 offen offset:2048 lds
    s_waitcnt lgkmcnt(4)
    v_mfma_f32_32x32x16_bf16 v[80:95], v[20:23], a[20:23], v[80:95]
    s_mov_b32 m0, 75968
    s_nop 0
    buffer_load_dwordx4 v2, s[20:23], s45 offen offset:3072 lds
    s_mov_b32 m0, 67600
    s_add_u32 s45, s76, 4096
    v_mfma_f32_32x32x16_bf16 v[96:111], v[20:23], a[148:151], v[96:111]
    buffer_load_dwordx4 v2, s[20:23], s45 offen lds
    s_mov_b32 m0, 70736
    s_nop 0
    buffer_load_dwordx4 v2, s[20:23], s45 offen offset:1024 lds
    v_mfma_f32_32x32x16_bf16 v[112:127], v[20:23], v[148:151], v[112:127]
    s_mov_b32 m0, 73872
    s_nop 0
    buffer_load_dwordx4 v2, s[20:23], s45 offen offset:2048 lds
    s_mov_b32 m0, 77008
    s_waitcnt lgkmcnt(2)
    v_mfma_f32_32x32x16_bf16 v[80:95], v[24:27], a[24:27], v[80:95]
    buffer_load_dwordx4 v2, s[20:23], s45 offen offset:3072 lds
    s_mov_b32 m0, 68640
    s_add_u32 s45, s76, 8192
    v_mfma_f32_32x32x16_bf16 v[96:111], v[24:27], a[152:155], v[96:111]
    buffer_load_dwordx4 v2, s[20:23], s45 offen lds
    s_mov_b32 m0, 71776
    s_nop 0
    buffer_load_dwordx4 v2, s[20:23], s45 offen offset:1024 lds
    v_mfma_f32_32x32x16_bf16 v[112:127], v[24:27], v[152:155], v[112:127]
    s_mov_b32 m0, 74912
    s_nop 0
    buffer_load_dwordx4 v2, s[20:23], s45 offen offset:2048 lds
    s_mov_b32 m0, 78048
    s_waitcnt lgkmcnt(0)
    v_mfma_f32_32x32x16_bf16 v[80:95], v[28:31], a[28:31], v[80:95]
    buffer_load_dwordx4 v2, s[20:23], s45 offen offset:3072 lds
    s_mov_b32 m0, 69680
    s_add_u32 s45, s76, 12288
    buffer_load_dwordx4 v2, s[20:23], s45 offen lds
    v_mfma_f32_32x32x16_bf16 v[96:111], v[28:31], a[156:159], v[96:111]
    s_mov_b32 m0, 72816
    s_nop 0
    buffer_load_dwordx4 v2, s[20:23], s45 offen offset:1024 lds
    s_mov_b32 m0, 75952
    s_nop 0
    buffer_load_dwordx4 v2, s[20:23], s45 offen offset:2048 lds
    v_mfma_f32_32x32x16_bf16 v[112:127], v[28:31], v[156:159], v[112:127]
    s_mov_b32 m0, 79088
    s_nop 0
    buffer_load_dwordx4 v2, s[20:23], s45 offen offset:3072 lds
    s_add_u32 s43, s43, 16384
    s_and_b32 s43, s43, 0x7ffff
    s_add_u32 s40, s40, 1
    s_sub_u32 s35, s35, 1
    s_cmp_lg_u32 s35, 0
    s_waitcnt lgkmcnt(0)
    s_nop 1
    s_cbranch_scc1 L_w3_loop
    s_add_u32 s3, s43, 147456
    s_and_b32 s3, s3, 0x7ffff
    s_waitcnt vmcnt(40)
    s_barrier
    s_cmp_le_i32 s40, 30
    s_cselect_b32 s14, 0x80000, 0
    s_cselect_b32 s38, s36, s39
    s_add_u32 m0, s38, 33280
    s_nop 0
    buffer_load_dwordx4 v5, s[12:15], s42 offen nt lds
    s_add_u32 m0, s38, 33296
    s_nop 0
    buffer_load_dwordx4 v5, s[12:15], s42 offen offset:1024 nt lds
    s_add_u32 m0, s38, 33312
    s_nop 0
    buffer_load_dwordx4 v5, s[12:15], s42 offen offset:2048 nt lds
    s_add_u32 m0, s38, 33328
    s_nop 0
    buffer_load_dwordx4 v5, s[12:15], s42 offen offset:3072 nt lds
    s_add_u32 s42, s42, 16384
    s_and_b32 s42, s42, 0x7ffff
    s_waitcnt vmcnt(24)
    s_barrier
    s_cmp_le_i32 s40, 28
    s_cselect_b32 s10, 0x80000, 0
    s_cselect_b32 s37, s36, s39
    s_add_u32 m0, s37, 0
    s_nop 0
    buffer_load_dwordx4 v5, s[8:11], s41 offen nt lds
    s_add_u32 m0, s37, 16
    s_nop 0
    buffer_load_dwordx4 v5, s[8:11], s41 offen offset:1024 nt lds
    s_add_u32 m0, s37, 32
    s_nop 0
    buffer_load_dwordx4 v5, s[8:11], s41 offen offset:2048 nt lds
    s_add_u32 m0, s37, 48
    s_nop 0
    buffer_load_dwordx4 v5, s[8:11], s41 offen offset:3072 nt lds
    s_add_u32 s41, s41, 16384
    s_and_b32 s41, s41, 0x7ffff
    s_mov_b32 s45, s43
    s_mov_b32 s99, 83200
    s_mov_b32 s100, 4
L_tl19:
    s_add_u32 m0, s99, 0
    s_nop 0
    buffer_load_dwordx4 v2, s[20:23], s45 offen offset:0 lds
    s_add_u32 m0, s99, 3136
    s_nop 0
    buffer_load_dwordx4 v2, s[20:23], s45 offen offset:1024 lds
    s_add_u32 m0, s99, 6272
    s_nop 0
    buffer_load_dwordx4 v2, s[20:23], s45 offen offset:2048 lds
    s_add_u32 m0, s99, 9408
    s_nop 0
    buffer_load_dwordx4 v2, s[20:23], s45 offen offset:3072 lds
    s_add_u32 s99, s99, 1040
    s_add_u32 s45, s45, 4096
    s_sub_u32 s100, s100, 1
    s_cmp_lg_u32 s100, 0
    s_cbranch_scc1 L_tl19
    s_add_u32 s43, s43, 16384
    s_and_b32 s43, s43, 0x7ffff
    s_add_u32 s40, s40, 1
    s_mov_b32 s45, s3
    s_mov_b32 s99, 99840
    s_mov_b32 s100, 4
L_tl20:
    s_add_u32 m0, s99, 0
    s_nop 0
    buffer_load_dwordx4 v2, s[20:23], s45 offen offset:0 lds
    s_add_u32 m0, s99, 3136
    s_nop 0
    buffer_load_dwordx4 v2, s[20:23], s45 offen offset:1024 lds
    s_add_u32 m0, s99, 6272
    s_nop 0
    buffer_load_dwordx4 v2, s[20:23], s45 offen offset:2048 lds
    s_add_u32 m0, s99, 9408
    s_nop 0
    buffer_load_dwordx4 v2, s[20:23], s45 offen offset:3072 lds
    s_add_u32 s99, s99, 1040
    s_add_u32 s45, s45, 4096
    s_sub_u32 s100, s100, 1
    s_cmp_lg_u32 s100, 0
    s_cbranch_scc1 L_tl20
    s_add_u32 s3, s3, 16384
    s_waitcnt vmcnt(40)
    s_barrier
    s_cmp_le_i32 s40, 30
    s_cselect_b32 s14, 0x80000, 0
    s_cselect_b32 s38, s36, s39
    s_add_u32 m0, s38, 49920
    s_nop 0
    buffer_load_dwordx4 v5, s[12:15], s42 offen nt lds
    s_add_u32 m0, s38, 49936
    s_nop 0
    buffer_load_dwordx4 v5, s[12:15], s42 offen offset:1024 nt lds
    s_add_u32 m0, s38, 49952
    s_nop 0
    buffer_load_dwordx4 v5, s[12:15], s42 offen offset:2048 nt lds
    s_add_u32 m0, s38, 49968
    s_nop 0
    buffer_load_dwordx4 v5, s[12:15], s42 offen offset:3072 nt lds
    s_add_u32 s42, s42, 16384
    s_and_b32 s42, s42, 0x7ffff
    s_waitcnt vmcnt(40)
    s_barrier
    s_cmp_le_i32 s40, 28
    s_cselect_b32 s10, 0x80000, 0
    s_cselect_b32 s37, s36, s39
    s_add_u32 m0, s37, 16640
    s_nop 0
    buffer_load_dwordx4 v5, s[8:11], s41 offen nt lds
    s_add_u32 m0, s37, 16656
    s_nop 0
    buffer_load_dwordx4 v5, s[8:11], s41 offen offset:1024 nt lds
    s_add_u32 m0, s37, 16672
    s_nop 0
    buffer_load_dwordx4 v5, s[8:11], s41 offen offset:2048 nt lds
    s_add_u32 m0, s37, 16688
    s_nop 0
    buffer_load_dwordx4 v5, s[8:11], s41 offen offset:3072 nt lds
    s_add_u32 s41, s41, 16384
    s_and_b32 s41, s41, 0x7ffff
    s_mov_b32 s45, s43
    s_mov_b32 s99, 66560
    s_mov_b32 s100, 4
L_tl21:
    s_add_u32 m0, s99, 0
    s_nop 0
    buffer_load_dwordx4 v2, s[20:23], s45 offen offset:0 lds
    s_add_u32 m0, s99, 3136
    s_nop 0
    buffer_load_dwordx4 v2, s[20:23], s45 offen offset:1024 lds
    s_add_u32 m0, s99, 6272
    s_nop 0
    buffer_load_dwordx4 v2, s[20:23], s45 offen offset:2048 lds
    s_add_u32 m0, s99, 9408
    s_nop 0
    buffer_load_dwordx4 v2, s[20:23], s45 offen offset:3072 lds
    s_add_u32 s99, s99, 1040
    s_add_u32 s45, s45, 4096
    s_sub_u32 s100, s100, 1
    s_cmp_lg_u32 s100, 0
    s_cbranch_scc1 L_tl21
    s_add_u32 s43, s43, 16384
    s_and_b32 s43, s43, 0x7ffff
    s_add_u32 s40, s40, 1
    s_mov_b32 s45, s3
    s_mov_b32 s99, 116480
    s_mov_b32 s100, 4
L_tl22:
    s_add_u32 m0, s99, 0
    s_nop 0
    buffer_load_dwordx4 v2, s[20:23], s45 offen offset:0 lds
    s_add_u32 m0, s99, 3136
    s_nop 0
    buffer_load_dwordx4 v2, s[20:23], s45 offen offset:1024 lds
    s_add_u32 m0, s99, 6272
    s_nop 0
    buffer_load_dwordx4 v2, s[20:23], s45 offen offset:2048 lds
    s_add_u32 m0, s99, 9408
    s_nop 0
    buffer_load_dwordx4 v2, s[20:23], s45 offen offset:3072 lds
    s_add_u32 s99, s99, 1040
    s_add_u32 s45, s45, 4096
    s_sub_u32 s100, s100, 1
    s_cmp_lg_u32 s100, 0
    s_cbranch_scc1 L_tl22
    s_add_u32 s3, s3, 16384
    s_waitcnt vmcnt(56)
    s_barrier
    s_cmp_le_i32 s40, 30
    s_cselect_b32 s14, 0x80000, 0
    s_cselect_b32 s38, s36, s39
    s_add_u32 m0, s38, 33280
    s_nop 0
    buffer_load_dwordx4 v5, s[12:15], s42 offen nt lds
    s_add_u32 m0, s38, 33296
    s_nop 0
    buffer_load_dwordx4 v5, s[12:15], s42 offen offset:1024 nt lds
    s_add_u32 m0, s38, 33312
    s_nop 0
    buffer_load_dwordx4 v5, s[12:15], s42 offen offset:2048 nt lds
    s_add_u32 m0, s38, 33328
    s_nop 0
    buffer_load_dwordx4 v5, s[12:15], s42 offen offset:3072 nt lds
    s_add_u32 s42, s42, 16384
    s_and_b32 s42, s42, 0x7ffff
    s_waitcnt vmcnt(40)
    s_barrier
    s_cmp_le_i32 s40, 28
    s_cselect_b32 s10, 0x80000, 0
    s_cselect_b32 s37, s36, s39
    s_add_u32 m0, s37, 0
    s_nop 0
    buffer_load_dwordx4 v5, s[8:11], s41 offen nt lds
    s_add_u32 m0, s37, 16
    s_nop 0
    buffer_load_dwordx4 v5, s[8:11], s41 offen offset:1024 nt lds
    s_add_u32 m0, s37, 32
    s_nop 0
    buffer_load_dwordx4 v5, s[8:11], s41 offen offset:2048 nt lds
    s_add_u32 m0, s37, 48
    s_nop 0
    buffer_load_dwordx4 v5, s[8:11], s41 offen offset:3072 nt lds
    s_add_u32 s41, s41, 16384
    s_and_b32 s41, s41, 0x7ffff
    s_mov_b32 s45, s43
    s_mov_b32 s99, 83200
    s_mov_b32 s100, 4
L_tl23:
    s_add_u32 m0, s99, 0
    s_nop 0
    buffer_load_dwordx4 v2, s[20:23], s45 offen offset:0 lds
    s_add_u32 m0, s99, 3136
    s_nop 0
    buffer_load_dwordx4 v2, s[20:23], s45 offen offset:1024 lds
    s_add_u32 m0, s99, 6272
    s_nop 0
    buffer_load_dwordx4 v2, s[20:23], s45 offen offset:2048 lds
    s_add_u32 m0, s99, 9408
    s_nop 0
    buffer_load_dwordx4 v2, s[20:23], s45 offen offset:3072 lds
    s_add_u32 s99, s99, 1040
    s_add_u32 s45, s45, 4096
    s_sub_u32 s100, s100, 1
    s_cmp_lg_u32 s100, 0
    s_cbranch_scc1 L_tl23
    s_add_u32 s43, s43, 16384
    s_and_b32 s43, s43, 0x7ffff
    s_add_u32 s40, s40, 1
    s_add_u32 s4, s3, 49152
    s_mov_b32 s45, s4
    s_mov_b32 s99, 133120
    s_mov_b32 s100, 4
L_tl24:
    s_add_u32 m0, s99, 0
    s_nop 0
    buffer_load_dwordx4 v2, s[20:23], s45 offen offset:0 lds
    s_add_u32 m0, s99, 3136
    s_nop 0
    buffer_load_dwordx4 v2, s[20:23], s45 offen offset:1024 lds
    s_add_u32 m0, s99, 6272
    s_nop 0
    buffer_load_dwordx4 v2, s[20:23], s45 offen offset:2048 lds
    s_add_u32 m0, s99, 9408
    s_nop 0
    buffer_load_dwordx4 v2, s[20:23], s45 offen offset:3072 lds
    s_add_u32 s99, s99, 1040
    s_add_u32 s45, s45, 4096
    s_sub_u32 s100, s100, 1
    s_cmp_lg_u32 s100, 0
    s_cbranch_scc1 L_tl24
    s_waitcnt vmcnt(56)
    s_barrier
    s_cmp_le_i32 s40, 30
    s_cselect_b32 s14, 0x80000, 0
    s_cselect_b32 s38, s36, s39
    s_add_u32 m0, s38, 49920
    s_nop 0
    buffer_load_dwordx4 v5, s[12:15], s42 offen nt lds
    s_add_u32 m0, s38, 49936
    s_nop 0
    buffer_load_dwordx4 v5, s[12:15], s42 offen offset:1024 nt lds
    s_add_u32 m0, s38, 49952
    s_nop 0
    buffer_load_dwordx4 v5, s[12:15], s42 offen offset:2048 nt lds
    s_add_u32 m0, s38, 49968
    s_nop 0
    buffer_load_dwordx4 v5, s[12:15], s42 offen offset:3072 nt lds
    s_add_u32 s42, s42, 16384
    s_and_b32 s42, s42, 0x7ffff
    s_waitcnt vmcnt(40)
    s_barrier
    s_cmp_le_i32 s40, 28
    s_cselect_b32 s10, 0x80000, 0
    s_cselect_b32 s37, s36, s39
    s_add_u32 m0, s37, 16640
    s_nop 0
    buffer_load_dwordx4 v5, s[8:11], s41 offen nt lds
    s_add_u32 m0, s37, 16656
    s_nop 0
    buffer_load_dwordx4 v5, s[8:11], s41 offen offset:1024 nt lds
    s_add_u32 m0, s37, 16672
    s_nop 0
    buffer_load_dwordx4 v5, s[8:11], s41 offen offset:2048 nt lds
    s_add_u32 m0, s37, 16688
    s_nop 0
    buffer_load_dwordx4 v5, s[8:11], s41 offen offset:3072 nt lds
    s_add_u32 s41, s41, 16384
    s_and_b32 s41, s41, 0x7ffff
    s_mov_b32 s45, s43
    s_mov_b32 s99, 66560
    s_mov_b32 s100, 4
L_tl25:
    s_add_u32 m0, s99, 0
    s_nop 0
    buffer_load_dwordx4 v2, s[20:23], s45 offen offset:0 lds
    s_add_u32 m0, s99, 3136
    s_nop 0
    buffer_load_dwordx4 v2, s[20:23], s45 offen offset:1024 lds
    s_add_u32 m0, s99, 6272
    s_nop 0
    buffer_load_dwordx4 v2, s[20:23], s45 offen offset:2048 lds
    s_add_u32 m0, s99, 9408
    s_nop 0
    buffer_load_dwordx4 v2, s[20:23], s45 offen offset:3072 lds
    s_add_u32 s99, s99, 1040
    s_add_u32 s45, s45, 4096
    s_sub_u32 s100, s100, 1
    s_cmp_lg_u32 s100, 0
    s_cbranch_scc1 L_tl25
    s_add_u32 s43, s43, 16384
    s_and_b32 s43, s43, 0x7ffff
    s_add_u32 s40, s40, 1
    s_waitcnt vmcnt(40)
    s_barrier
    s_cmp_le_i32 s40, 30
    s_cselect_b32 s14, 0x80000, 0
    s_cselect_b32 s38, s36, s39
    s_add_u32 m0, s38, 33280
    s_nop 0
    buffer_load_dwordx4 v5, s[12:15], s42 offen nt lds
    s_add_u32 m0, s38, 33296
    s_nop 0
    buffer_load_dwordx4 v5, s[12:15], s42 offen offset:1024 nt lds
    s_add_u32 m0, s38, 33312
    s_nop 0
    buffer_load_dwordx4 v5, s[12:15], s42 offen offset:2048 nt lds
    s_add_u32 m0, s38, 33328
    s_nop 0
    buffer_load_dwordx4 v5, s[12:15], s42 offen offset:3072 nt lds
    s_add_u32 s42, s42, 16384
    s_and_b32 s42, s42, 0x7ffff
    s_waitcnt vmcnt(24)
    s_barrier
    s_cmp_le_i32 s40, 28
    s_cselect_b32 s10, 0x80000, 0
    s_cselect_b32 s37, s36, s39
    s_add_u32 m0, s37, 0
    s_nop 0
    buffer_load_dwordx4 v5, s[8:11], s41 offen nt lds
    s_add_u32 m0, s37, 16
    s_nop 0
    buffer_load_dwordx4 v5, s[8:11], s41 offen offset:1024 nt lds
    s_add_u32 m0, s37, 32
    s_nop 0
    buffer_load_dwordx4 v5, s[8:11], s41 offen offset:2048 nt lds
    s_add_u32 m0, s37, 48
    s_nop 0
    buffer_load_dwordx4 v5, s[8:11], s41 offen offset:3072 nt lds
    s_add_u32 s41, s41, 16384
    s_and_b32 s41, s41, 0x7ffff
    s_mov_b32 s45, s43
    s_mov_b32 s99, 83200
    s_mov_b32 s100, 4
L_tl26:
    s_add_u32 m0, s99, 0
    s_nop 0
    buffer_load_dwordx4 v2, s[20:23], s45 offen offset:0 lds
    s_add_u32 m0, s99, 3136
    s_nop 0
    buffer_load_dwordx4 v2, s[20:23], s45 offen offset:1024 lds
    s_add_u32 m0, s99, 6272
    s_nop 0
    buffer_load_dwordx4 v2, s[20:23], s45 offen offset:2048 lds
    s_add_u32 m0, s99, 9408
    s_nop 0
    buffer_load_dwordx4 v2, s[20:23], s45 offen offset:3072 lds
    s_add_u32 s99, s99, 1040
    s_add_u32 s45, s45, 4096
    s_sub_u32 s100, s100, 1
    s_cmp_lg_u32 s100, 0
    s_cbranch_scc1 L_tl26
    s_add_u32 s43, s43, 16384
    s_and_b32 s43, s43, 0x7ffff
    s_add_u32 s40, s40, 1
    s_waitcnt vmcnt(24)
    s_barrier
    s_cmp_le_i32 s40, 30
    s_cselect_b32 s14, 0x80000, 0
    s_cselect_b32 s38, s36, s39
    s_add_u32 m0, s38, 49920
    s_nop 0
    buffer_load_dwordx4 v5, s[12:15], s42 offen nt lds
    s_add_u32 m0, s38, 49936
    s_nop 0
    buffer_load_dwordx4 v5, s[12:15], s42 offen offset:1024 nt lds
    s_add_u32 m0, s38, 49952
    s_nop 0
    buffer_load_dwordx4 v5, s[12:15], s42 offen offset:2048 nt lds
    s_add_u32 m0, s38, 49968
    s_nop 0
    buffer_load_dwordx4 v5, s[12:15], s42 offen offset:3072 nt lds
    s_add_u32 s42, s42, 16384
    s_and_b32 s42, s42, 0x7ffff
    s_waitcnt vmcnt(24)
    s_barrier
    s_cmp_le_i32 s40, 28
    s_cselect_b32 s10, 0x80000, 0
    s_cselect_b32 s37, s36, s39
    s_add_u32 m0, s37, 16640
    s_nop 0
    buffer_load_dwordx4 v5, s[8:11], s41 offen nt lds
    s_add_u32 m0, s37, 16656
    s_nop 0
    buffer_load_dwordx4 v5, s[8:11], s41 offen offset:1024 nt lds
    s_add_u32 m0, s37, 16672
    s_nop 0
    buffer_load_dwordx4 v5, s[8:11], s41 offen offset:2048 nt lds
    s_add_u32 m0, s37, 16688
    s_nop 0
    buffer_load_dwordx4 v5, s[8:11], s41 offen offset:3072 nt lds
    s_add_u32 s41, s41, 16384
    s_and_b32 s41, s41, 0x7ffff
    s_mov_b32 s45, s43
    s_mov_b32 s99, 66560
    s_mov_b32 s100, 4
L_tl27:
    s_add_u32 m0, s99, 0
    s_nop 0
    buffer_load_dwordx4 v2, s[20:23], s45 offen offset:0 lds
    s_add_u32 m0, s99, 3136
    s_nop 0
    buffer_load_dwordx4 v2, s[20:23], s45 offen offset:1024 lds
    s_add_u32 m0, s99, 6272
    s_nop 0
    buffer_load_dwordx4 v2, s[20:23], s45 offen offset:2048 lds
    s_add_u32 m0, s99, 9408
    s_nop 0
    buffer_load_dwordx4 v2, s[20:23], s45 offen offset:3072 lds
    s_add_u32 s99, s99, 1040
    s_add_u32 s45, s45, 4096
    s_sub_u32 s100, s100, 1
    s_cmp_lg_u32 s100, 0
    s_cbranch_scc1 L_tl27
    s_add_u32 s43, s43, 16384
    s_and_b32 s43, s43, 0x7ffff
    s_add_u32 s40, s40, 1
    s_waitcnt vmcnt(24)
    s_barrier
    s_cmp_le_i32 s40, 30
    s_cselect_b32 s14, 0x80000, 0
    s_cselect_b32 s38, s36, s39
    s_add_u32 m0, s38, 33280
    s_nop 0
    buffer_load_dwordx4 v5, s[12:15], s42 offen nt lds
    s_add_u32 m0, s38, 33296
    s_nop 0
    buffer_load_dwordx4 v5, s[12:15], s42 offen offset:1024 nt lds
    s_add_u32 m0, s38, 33312
    s_nop 0
    buffer_load_dwordx4 v5, s[12:15], s42 offen offset:2048 nt lds
    s_add_u32 m0, s38, 33328
    s_nop 0
    buffer_load_dwordx4 v5, s[12:15], s42 offen offset:3072 nt lds
    s_add_u32 s42, s42, 16384
    s_and_b32 s42, s42, 0x7ffff
    s_waitcnt vmcnt(24)
    s_barrier
    s_mov_b32 s45, s43
    s_mov_b32 s99, 83200
    s_mov_b32 s100, 4
L_tl28:
    s_add_u32 m0, s99, 0
    s_nop 0
    buffer_load_dwordx4 v2, s[20:23], s45 offen offset:0 lds
    s_add_u32 m0, s99, 3136
    s_nop 0
    buffer_load_dwordx4 v2, s[20:23], s45 offen offset:1024 lds
    s_add_u32 m0, s99, 6272
    s_nop 0
    buffer_load_dwordx4 v2, s[20:23], s45 offen offset:2048 lds
    s_add_u32 m0, s99, 9408
    s_nop 0
    buffer_load_dwordx4 v2, s[20:23], s45 offen offset:3072 lds
    s_add_u32 s99, s99, 1040
    s_add_u32 s45, s45, 4096
    s_sub_u32 s100, s100, 1
    s_cmp_lg_u32 s100, 0
    s_cbranch_scc1 L_tl28
    s_add_u32 s43, s43, 16384
    s_and_b32 s43, s43, 0x7ffff
    s_add_u32 s40, s40, 1
    s_mov_b32 s45, s3
    s_mov_b32 s99, 0
    s_mov_b32 s100, 4
L_tl29:
    s_add_u32 m0, s99, 0
    s_nop 0
    buffer_load_dwordx4 v2, s[20:23], s45 offen offset:0 lds
    s_add_u32 m0, s99, 3136
    s_nop 0
    buffer_load_dwordx4 v2, s[20:23], s45 offen offset:1024 lds
    s_add_u32 m0, s99, 6272
    s_nop 0
    buffer_load_dwordx4 v2, s[20:23], s45 offen offset:2048 lds
    s_add_u32 m0, s99, 9408
    s_nop 0
    buffer_load_dwordx4 v2, s[20:23], s45 offen offset:3072 lds
    s_add_u32 s99, s99, 1040
    s_add_u32 s45, s45, 4096
    s_sub_u32 s100, s100, 1
    s_cmp_lg_u32 s100, 0
    s_cbranch_scc1 L_tl29
    s_add_u32 s3, s3, 16384
    s_waitcnt vmcnt(36)
    s_barrier
    s_cmp_le_i32 s40, 30
    s_cselect_b32 s14, 0x80000, 0
    s_cselect_b32 s38, s36, s39
    s_add_u32 m0, s38, 49920
    s_nop 0
    buffer_load_dwordx4 v5, s[12:15], s42 offen nt lds
    s_add_u32 m0, s38, 49936
    s_nop 0
    buffer_load_dwordx4 v5, s[12:15], s42 offen offset:1024 nt lds
    s_add_u32 m0, s38, 49952
    s_nop 0
    buffer_load_dwordx4 v5, s[12:15], s42 offen offset:2048 nt lds
    s_add_u32 m0, s38, 49968
    s_nop 0
    buffer_load_dwordx4 v5, s[12:15], s42 offen offset:3072 nt lds
    s_add_u32 s42, s42, 16384
    s_and_b32 s42, s42, 0x7ffff
    s_waitcnt vmcnt(36)
    s_barrier
    s_mov_b32 s45, s43
    s_mov_b32 s99, 66560
    s_mov_b32 s100, 4
L_tl30:
    s_add_u32 m0, s99, 0
    s_nop 0
    buffer_load_dwordx4 v2, s[20:23], s45 offen offset:0 lds
    s_add_u32 m0, s99, 3136
    s_nop 0
    buffer_load_dwordx4 v2, s[20:23], s45 offen offset:1024 lds
    s_add_u32 m0, s99, 6272
    s_nop 0
    buffer_load_dwordx4 v2, s[20:23], s45 offen offset:2048 lds
    s_add_u32 m0, s99, 9408
    s_nop 0
    buffer_load_dwordx4 v2, s[20:23], s45 offen offset:3072 lds
    s_add_u32 s99, s99, 1040
    s_add_u32 s45, s45, 4096
    s_sub_u32 s100, s100, 1
    s_cmp_lg_u32 s100, 0
    s_cbranch_scc1 L_tl30
    s_add_u32 s43, s43, 16384
    s_and_b32 s43, s43, 0x7ffff
    s_add_u32 s40, s40, 1
    s_mov_b32 s45, s3
    s_mov_b32 s99, 16640
    s_mov_b32 s100, 4
L_tl31:
    s_add_u32 m0, s99, 0
    s_nop 0
    buffer_load_dwordx4 v2, s[20:23], s45 offen offset:0 lds
    s_add_u32 m0, s99, 3136
    s_nop 0
    buffer_load_dwordx4 v2, s[20:23], s45 offen offset:1024 lds
    s_add_u32 m0, s99, 6272
    s_nop 0
    buffer_load_dwordx4 v2, s[20:23], s45 offen offset:2048 lds
    s_add_u32 m0, s99, 9408
    s_nop 0
    buffer_load_dwordx4 v2, s[20:23], s45 offen offset:3072 lds
    s_add_u32 s99, s99, 1040
    s_add_u32 s45, s45, 4096
    s_sub_u32 s100, s100, 1
    s_cmp_lg_u32 s100, 0
    s_cbranch_scc1 L_tl31
    s_add_u32 s3, s3, 16384
    s_waitcnt vmcnt(52)
    s_barrier
    s_mov_b32 s45, s3
    s_mov_b32 s99, 33280
    s_mov_b32 s100, 4
L_tl32:
    s_add_u32 m0, s99, 0
    s_nop 0
    buffer_load_dwordx4 v2, s[20:23], s45 offen offset:0 lds
    s_add_u32 m0, s99, 3136
    s_nop 0
    buffer_load_dwordx4 v2, s[20:23], s45 offen offset:1024 lds
    s_add_u32 m0, s99, 6272
    s_nop 0
    buffer_load_dwordx4 v2, s[20:23], s45 offen offset:2048 lds
    s_add_u32 m0, s99, 9408
    s_nop 0
    buffer_load_dwordx4 v2, s[20:23], s45 offen offset:3072 lds
    s_add_u32 s99, s99, 1040
    s_add_u32 s45, s45, 4096
    s_sub_u32 s100, s100, 1
    s_cmp_lg_u32 s100, 0
    s_cbranch_scc1 L_tl32
    s_add_u32 s3, s3, 16384
    s_waitcnt vmcnt(48)
    s_barrier
    s_mov_b32 s45, s43
    s_mov_b32 s99, 83200
    s_mov_b32 s100, 4
L_tl33:
    s_add_u32 m0, s99, 0
    s_nop 0
    buffer_load_dwordx4 v2, s[20:23], s45 offen offset:0 lds
    s_add_u32 m0, s99, 3136
    s_nop 0
    buffer_load_dwordx4 v2, s[20:23], s45 offen offset:1024 lds
    s_add_u32 m0, s99, 6272
    s_nop 0
    buffer_load_dwordx4 v2, s[20:23], s45 offen offset:2048 lds
    s_add_u32 m0, s99, 9408
    s_nop 0
    buffer_load_dwordx4 v2, s[20:23], s45 offen offset:3072 lds
    s_add_u32 s99, s99, 1040
    s_add_u32 s45, s45, 4096
    s_sub_u32 s100, s100, 1
    s_cmp_lg_u32 s100, 0
    s_cbranch_scc1 L_tl33
    s_add_u32 s43, s43, 16384
    s_and_b32 s43, s43, 0x7ffff
    s_add_u32 s40, s40, 1
    s_waitcnt vmcnt(0)
    s_barrier
    s_and_b32 s3, s2, 7
    s_lshr_b32 s4, s2, 3
    s_lshr_b32 s5, s3, 2
    s_and_b32 s3, s3, 3
    s_lshl_b32 s3, s3, 1
    s_lshr_b32 s6, s4, 4
    s_add_u32 s3, s3, s6
    s_and_b32 s4, s4, 15
    s_lshl_b32 s6, s5, 4
    s_add_u32 s6, s6, s4
    s_lshl_b32 s6, s6, 2
    v_mov_b32 v14, 0
    s_lshl_b32 s7, 1, s3
    s_lshl_b32 s6, s5, 2
    s_lshl_b32 s92, s4, 3
    s_add_u32 s6, s6, s92
    v_lshrrev_b32 v15, 1, v0
    v_and_b32 v13, 1, v0
    v_lshl_add_u32 v15, v13, 7, v15
    v_add_u32 v15, s6, v15
    v_lshlrev_b32 v15, 7, v15
    s_lshl_b32 s6, s2, 7
    v_mov_b32 v13, s6
    s_add_u32 s80, s70, 0x1800000
    s_addc_u32 s81, s71, 0
    s_and_b32 s81, s81, 0xffff
    s_mov_b32 s82, 0x10000
    s_mov_b32 s83, 0x20000
    v_readfirstlane_b32 s95, v12
    s_cmp_eq_u32 s95, 0
    s_cselect_b32 s95, s90, s95
    v_mov_b32 v12, s95
    s_mov_b64 s[88:89], exec
    s_mov_b32 s91, 200000
    s_mov_b32 s90, 0
    s_barrier
    s_mov_b64 exec, 1
    buffer_store_dword v12, v13, s[80:83], 0 offen sc0 sc1
    s_mov_b64 exec, 0xff
L_poll:
    buffer_load_dwordx2 v[10:11], v15, s[80:83], 0 offen sc0 sc1
    s_waitcnt vmcnt(0)
    v_cmp_eq_u32 vcc, s95, v10
    s_nop 3
    s_cmp_eq_u32 vcc_lo, 0xff
    s_cbranch_scc1 L_go
    s_cmp_lg_u32 s90, 0
    s_cbranch_scc1 L_quit
    s_sleep 4
    s_sub_u32 s91, s91, 1
    s_cmp_lg_u32 s91, 0
    s_cbranch_scc1 L_poll
    s_mov_b32 s90, 1
    s_mov_b64 exec, 1
    buffer_store_dword v12, v13, s[80:83], 0 offen offset:4 sc0 sc1
    s_waitcnt vmcnt(0)
    s_mov_b64 exec, 0xff
    s_branch L_poll
L_quit:
    s_mov_b32 s93, 0
    s_branch L_pub
L_go:
    v_cmp_eq_u32 vcc, s95, v11
    s_nop 3
    s_or_b32 s93, s7, vcc_lo
    s_and_b32 s93, s93, 0xff
L_pub:
    s_mov_b64 exec, 1
    v_mov_b32 v9, s93
    ds_write_b32 v14, v9
    s_mov_b64 exec, s[88:89]
    s_waitcnt lgkmcnt(0)
L_red:
    s_load_dwordx2 s[8:9], s[0:1], 80
    s_and_b32 s3, s2, 7
    s_lshr_b32 s4, s2, 3
    s_lshr_b32 s5, s3, 2
    s_and_b32 s3, s3, 3
    s_lshl_b32 s3, s3, 1
    s_lshr_b32 s6, s4, 4
    s_add_u32 s3, s3, s6
    s_and_b32 s4, s4, 15
    v_and_b32 v2, 7, v0
    v_bfe_u32 v3, v0, 3, 1
    v_bfe_u32 v4, v0, 4, 1
    v_lshrrev_b32 v5, 5, v0
    s_lshl_b32 s6, s32, 3
    v_add_u32 v2, s6, v2
    v_lshlrev_b32 v7, 11, v5
    v_lshl_add_u32 v7, v3, 10, v7
    v_lshl_add_u32 v7, v4, 9, v7
    v_lshl_add_u32 v7, v2, 4, v7
    v_lshlrev_b32 v8, 11, v2
    v_lshl_add_u32 v8, v5, 6, v8
    v_lshl_add_u32 v8, v4, 5, v8
    v_lshl_add_u32 v8, v3, 4, v8
    v_mov_b32 v14, 0
    s_lshl_b32 s14, s5, 2
    s_lshl_b32 s15, s4, 3
    s_add_u32 s14, s14, s15
    s_mul_i32 s14, s14, 98304
    s_mul_i32 s15, s4, 96
    s_lshl_b32 s15, s15, 11
    s_lshl_b32 s16, s5, 10
    s_add_u32 s15, s15, s16
    s_mov_b32 s20, s70
    s_and_b32 s21, s71, 0xffff
    s_mov_b32 s22, 25165824
    s_mov_b32 s23, 0x20000
    s_waitcnt lgkmcnt(0)
    s_mov_b32 s24, s8
    s_and_b32 s25, s9, 0xffff
    s_mov_b32 s26, 3145728
    s_mov_b32 s27, 0x20000
L_round:
    s_barrier
    ds_read_b32 v9, v14
    s_waitcnt lgkmcnt(0)
    v_readfirstlane_b32 s93, v9
L_slice:
    s_and_b32 s92, s93, 0xff
    s_cmp_eq_u32 s92, 0
    s_cbranch_scc1 L_nomore
    s_ff1_i32_b32 s94, s92
    s_bitset0_b32 s93, s94
    s_lshl_b32 s16, s94, 12
    s_add_u32 s16, s16, s14
    s_add_u32 s17, s16, 0
    buffer_load_dwordx4 v[16:19], v7, s[20:23], s17 offen sc1
    s_add_u32 s17, s16, 12582912
    buffer_load_dwordx4 v[20:23], v7, s[20:23], s17 offen sc1
    s_add_u32 s17, s16, 98304
    buffer_load_dwordx4 v[24:27], v7, s[20:23], s17 offen sc1
    s_add_u32 s17, s16, 12681216
    buffer_load_dwordx4 v[28:31], v7, s[20:23], s17 offen sc1
    s_add_u32 s17, s16, 196608
    buffer_load_dwordx4 v[32:35], v7, s[20:23], s17 offen sc1
    s_add_u32 s17, s16, 12779520
    buffer_load_dwordx4 v[36:39], v7, s[20:23], s17 offen sc1
    s_add_u32 s17, s16, 294912
    buffer_load_dwordx4 v[40:43], v7, s[20:23], s17 offen sc1
    s_add_u32 s17, s16, 12877824
    buffer_load_dwordx4 v[44:47], v7, s[20:23], s17 offen sc1
    s_add_u32 s17, s16, 32768
    buffer_load_dwordx4 v[48:51], v7, s[20:23], s17 offen sc1
    s_add_u32 s17, s16, 12615680
    buffer_load_dwordx4 v[52:55], v7, s[20:23], s17 offen sc1
    s_add_u32 s17, s16, 131072
    buffer_load_dwordx4 v[56:59], v7, s[20:23], s17 offen sc1
    s_add_u32 s17, s16, 12713984
    buffer_load_dwordx4 v[60:63], v7, s[20:23], s17 offen sc1
    s_add_u32 s17, s16, 229376
    buffer_load_dwordx4 v[64:67], v7, s[20:23], s17 offen sc1
    s_add_u32 s17, s16, 12812288
    buffer_load_dwordx4 v[68:71], v7, s[20:23], s17 offen sc1
    s_add_u32 s17, s16, 327680
    buffer_load_dwordx4 v[72:75], v7, s[20:23], s17 offen sc1
    s_add_u32 s17, s16, 12910592
    buffer_load_dwordx4 v[76:79], v7, s[20:23], s17 offen sc1
    s_add_u32 s17, s16, 65536
    buffer_load_dwordx4 v[80:83], v7, s[20:23], s17 offen sc1
    s_add_u32 s17, s16, 12648448
    buffer_load_dwordx4 v[84:87], v7, s[20:23], s17 offen sc1
    s_add_u32 s17, s16, 163840
    buffer_load_dwordx4 v[88:91], v7, s[20:23], s17 offen sc1
    s_add_u32 s17, s16, 12746752
    buffer_load_dwordx4 v[92:95], v7, s[20:23], s17 offen sc1
    s_add_u32 s17, s16, 262144
    buffer_load_dwordx4 v[96:99], v7, s[20:23], s17 offen sc1
    s_add_u32 s17, s16, 12845056
    buffer_load_dwordx4 v[100:103], v7, s[20:23], s17 offen sc1
    s_add_u32 s17, s16, 360448
    buffer_load_dwordx4 v[104:107], v7, s[20:23], s17 offen sc1
    s_add_u32 s17, s16, 12943360
    buffer_load_dwordx4 v[108:111], v7, s[20:23], s17 offen sc1
    s_lshl_b32 s17, s94, 7
    s_add_u32 s17, s17, s15
    s_waitcnt vmcnt(23)
    v_lshlrev_b32 v120, 16, v16
    v_and_b32 v121, 0xffff0000, v16
    v_lshlrev_b32 v122, 16, v17
    v_and_b32 v123, 0xffff0000, v17
    v_lshlrev_b32 v124, 16, v18
    v_and_b32 v125, 0xffff0000, v18
    v_lshlrev_b32 v126, 16, v19
    v_and_b32 v127, 0xffff0000, v19
    s_waitcnt vmcnt(22)
    v_lshlrev_b32 v112, 16, v20
    v_and_b32 v113, 0xffff0000, v20
    v_add_f32 v120, v120, v112
    v_add_f32 v121, v121, v113
    v_lshlrev_b32 v112, 16, v21
    v_and_b32 v113, 0xffff0000, v21
    v_add_f32 v122, v122, v112
    v_add_f32 v123, v123, v113
    v_lshlrev_b32 v112, 16, v22
    v_and_b32 v113, 0xffff0000, v22
    v_add_f32 v124, v124, v112
    v_add_f32 v125, v125, v113
    v_lshlrev_b32 v112, 16, v23
    v_and_b32 v113, 0xffff0000, v23
    v_add_f32 v126, v126, v112
    v_add_f32 v127, v127, v113
    s_waitcnt vmcnt(21)
    v_lshlrev_b32 v112, 16, v24
    v_and_b32 v113, 0xffff0000, v24
    v_add_f32 v120, v120, v112
    v_add_f32 v121, v121, v113
    v_lshlrev_b32 v112, 16, v25
    v_and_b32 v113, 0xffff0000, v25
    v_add_f32 v122, v122, v112
    v_add_f32 v123, v123, v113
    v_lshlrev_b32 v112, 16, v26
    v_and_b32 v113, 0xffff0000, v26
    v_add_f32 v124, v124, v112
    v_add_f32 v125, v125, v113
    v_lshlrev_b32 v112, 16, v27
    v_and_b32 v113, 0xffff0000, v27
    v_add_f32 v126, v126, v112
    v_add_f32 v127, v127, v113
    s_waitcnt vmcnt(20)
    v_lshlrev_b32 v112, 16, v28
    v_and_b32 v113, 0xffff0000, v28
    v_add_f32 v120, v120, v112
    v_add_f32 v121, v121, v113
    v_lshlrev_b32 v112, 16, v29
    v_and_b32 v113, 0xffff0000, v29
    v_add_f32 v122, v122, v112
    v_add_f32 v123, v123, v113
    v_lshlrev_b32 v112, 16, v30
    v_and_b32 v113, 0xffff0000, v30
    v_add_f32 v124, v124, v112
    v_add_f32 v125, v125, v113
    v_lshlrev_b32 v112, 16, v31
    v_and_b32 v113, 0xffff0000, v31
    v_add_f32 v126, v126, v112
    v_add_f32 v127, v127, v113
    s_waitcnt vmcnt(19)
    v_lshlrev_b32 v112, 16, v32
    v_and_b32 v113, 0xffff0000, v32
    v_add_f32 v120, v120, v112
    v_add_f32 v121, v121, v113
    v_lshlrev_b32 v112, 16, v33
    v_and_b32 v113, 0xffff0000, v33
    v_add_f32 v122, v122, v112
    v_add_f32 v123, v123, v113
    v_lshlrev_b32 v112, 16, v34
    v_and_b32 v113, 0xffff0000, v34
    v_add_f32 v124, v124, v112
    v_add_f32 v125, v125, v113
    v_lshlrev_b32 v112, 16, v35
    v_and_b32 v113, 0xffff0000, v35
    v_add_f32 v126, v126, v112
    v_add_f32 v127, v127, v113
    s_waitcnt vmcnt(18)
    v_lshlrev_b32 v112, 16, v36
    v_and_b32 v113, 0xffff0000, v36
    v_add_f32 v120, v120, v112
    v_add_f32 v121, v121, v113
    v_lshlrev_b32 v112, 16, v37
    v_and_b32 v113, 0xffff0000, v37
    v_add_f32 v122, v122, v112
    v_add_f32 v123, v123, v113
    v_lshlrev_b32 v112, 16, v38
    v_and_b32 v113, 0xffff0000, v38
    v_add_f32 v124, v124, v112
    v_add_f32 v125, v125, v113
    v_lshlrev_b32 v112, 16, v39
    v_and_b32 v113, 0xffff0000, v39
    v_add_f32 v126, v126, v112
    v_add_f32 v127, v127, v113
    s_waitcnt vmcnt(17)
    v_lshlrev_b32 v112, 16, v40
    v_and_b32 v113, 0xffff0000, v40
    v_add_f32 v120, v120, v112
    v_add_f32 v121, v121, v113
    v_lshlrev_b32 v112, 16, v41
    v_and_b32 v113, 0xffff0000, v41
    v_add_f32 v122, v122, v112
    v_add_f32 v123, v123, v113
    v_lshlrev_b32 v112, 16, v42
    v_and_b32 v113, 0xffff0000, v42
    v_add_f32 v124, v124, v112
    v_add_f32 v125, v125, v113
    v_lshlrev_b32 v112, 16, v43
    v_and_b32 v113, 0xffff0000, v43
    v_add_f32 v126, v126, v112
    v_add_f32 v127, v127, v113
    s_waitcnt vmcnt(16)
    v_lshlrev_b32 v112, 16, v44
    v_and_b32 v113, 0xffff0000, v44
    v_add_f32 v120, v120, v112
    v_add_f32 v121, v121, v113
    v_lshlrev_b32 v112, 16, v45
    v_and_b32 v113, 0xffff0000, v45
    v_add_f32 v122, v122, v112
    v_add_f32 v123, v123, v113
    v_lshlrev_b32 v112, 16, v46
    v_and_b32 v113, 0xffff0000, v46
    v_add_f32 v124, v124, v112
    v_add_f32 v125, v125, v113
    v_lshlrev_b32 v112, 16, v47
    v_and_b32 v113, 0xffff0000, v47
    v_add_f32 v126, v126, v112
    v_add_f32 v127, v127, v113
    v_cvt_pk_bf16_f32 v148, v120, v121
    v_cvt_pk_bf16_f32 v149, v122, v123
    v_cvt_pk_bf16_f32 v150, v124, v125
    v_cvt_pk_bf16_f32 v151, v126, v127
    s_add_u32 s18, s17, 0
    buffer_store_dwordx4 v[148:151], v8, s[24:27], s18 offen
    s_waitcnt vmcnt(16)
    v_lshlrev_b32 v128, 16, v48
    v_and_b32 v129, 0xffff0000, v48
    v_lshlrev_b32 v130, 16, v49
    v_and_b32 v131, 0xffff0000, v49
    v_lshlrev_b32 v132, 16, v50
    v_and_b32 v133, 0xffff0000, v50
    v_lshlrev_b32 v134, 16, v51
    v_and_b32 v135, 0xffff0000, v51
    s_waitcnt vmcnt(15)
    v_lshlrev_b32 v112, 16, v52
    v_and_b32 v113, 0xffff0000, v52
    v_add_f32 v128, v128, v112
    v_add_f32 v129, v129, v113
    v_lshlrev_b32 v112, 16, v53
    v_and_b32 v113, 0xffff0000, v53
    v_add_f32 v130, v130, v112
    v_add_f32 v131, v131, v113
    v_lshlrev_b32 v112, 16, v54
    v_and_b32 v113, 0xffff0000, v54
    v_add_f32 v132, v132, v112
    v_add_f32 v133, v133, v113
    v_lshlrev_b32 v112, 16, v55
    v_and_b32 v113, 0xffff0000, v55
    v_add_f32 v134, v134, v112
    v_add_f32 v135, v135, v113
    s_waitcnt vmcnt(14)
    v_lshlrev_b32 v112, 16, v56
    v_and_b32 v113, 0xffff0000, v56
    v_add_f32 v128, v128, v112
    v_add_f32 v129, v129, v113
    v_lshlrev_b32 v112, 16, v57
    v_and_b32 v113, 0xffff0000, v57
    v_add_f32 v130, v130, v112
    v_add_f32 v131, v131, v113
    v_lshlrev_b32 v112, 16, v58
    v_and_b32 v113, 0xffff0000, v58
    v_add_f32 v132, v132, v112
    v_add_f32 v133, v133, v113
    v_lshlrev_b32 v112, 16, v59
    v_and_b32 v113, 0xffff0000, v59
    v_add_f32 v134, v134, v112
    v_add_f32 v135, v135, v113
    s_waitcnt vmcnt(13)
    v_lshlrev_b32 v112, 16, v60
    v_and_b32 v113, 0xffff0000, v60
    v_add_f32 v128, v128, v112
    v_add_f32 v129, v129, v113
    v_lshlrev_b32 v112, 16, v61
    v_and_b32 v113, 0xffff0000, v61
    v_add_f32 v130, v130, v112
    v_add_f32 v131, v131, v113
    v_lshlrev_b32 v112, 16, v62
    v_and_b32 v113, 0xffff0000, v62
    v_add_f32 v132, v132, v112
    v_add_f32 v133, v133, v113
    v_lshlrev_b32 v112, 16, v63
    v_and_b32 v113, 0xffff0000, v63
    v_add_f32 v134, v134, v112
    v_add_f32 v135, v135, v113
    s_waitcnt vmcnt(12)
    v_lshlrev_b32 v112, 16, v64
    v_and_b32 v113, 0xffff0000, v64
    v_add_f32 v128, v128, v112
    v_add_f32 v129, v129, v113
    v_lshlrev_b32 v112, 16, v65
    v_and_b32 v113, 0xffff0000, v65
    v_add_f32 v130, v130, v112
    v_add_f32 v131, v131, v113
    v_lshlrev_b32 v112, 16, v66
    v_and_b32 v113, 0xffff0000, v66
    v_add_f32 v132, v132, v112
    v_add_f32 v133, v133, v113
    v_lshlrev_b32 v112, 16, v67
    v_and_b32 v113, 0xffff0000, v67
    v_add_f32 v134, v134, v112
    v_add_f32 v135, v135, v113
    s_waitcnt vmcnt(11)
    v_lshlrev_b32 v112, 16, v68
    v_and_b32 v113, 0xffff0000, v68
    v_add_f32 v128, v128, v112
    v_add_f32 v129, v129, v113
    v_lshlrev_b32 v112, 16, v69
    v_and_b32 v113, 0xffff0000, v69
    v_add_f32 v130, v130, v112
    v_add_f32 v131, v131, v113
    v_lshlrev_b32 v112, 16, v70
    v_and_b32 v113, 0xffff0000, v70
    v_add_f32 v132, v132, v112
    v_add_f32 v133, v133, v113
    v_lshlrev_b32 v112, 16, v71
    v_and_b32 v113, 0xffff0000, v71
    v_add_f32 v134, v134, v112
    v_add_f32 v135, v135, v113
    s_waitcnt vmcnt(10)
    v_lshlrev_b32 v112, 16, v72
    v_and_b32 v113, 0xffff0000, v72
    v_add_f32 v128, v128, v112
    v_add_f32 v129, v129, v113
    v_lshlrev_b32 v112, 16, v73
    v_and_b32 v113, 0xffff0000, v73
    v_add_f32 v130, v130, v112
    v_add_f32 v131, v131, v113
    v_lshlrev_b32 v112, 16, v74
    v_and_b32 v113, 0xffff0000, v74
    v_add_f32 v132, v132, v112
    v_add_f32 v133, v133, v113
    v_lshlrev_b32 v112, 16, v75
    v_and_b32 v113, 0xffff0000, v75
    v_add_f32 v134, v134, v112
    v_add_f32 v135, v135, v113
    s_waitcnt vmcnt(9)
    v_lshlrev_b32 v112, 16, v76
    v_and_b32 v113, 0xffff0000, v76
    v_add_f32 v128, v128, v112
    v_add_f32 v129, v129, v113
    v_lshlrev_b32 v112, 16, v77
    v_and_b32 v113, 0xffff0000, v77
    v_add_f32 v130, v130, v112
    v_add_f32 v131, v131, v113
    v_lshlrev_b32 v112, 16, v78
    v_and_b32 v113, 0xffff0000, v78
    v_add_f32 v132, v132, v112
    v_add_f32 v133, v133, v113
    v_lshlrev_b32 v112, 16, v79
    v_and_b32 v113, 0xffff0000, v79
    v_add_f32 v134, v134, v112
    v_add_f32 v135, v135, v113
    v_cvt_pk_bf16_f32 v152, v128, v129
    v_cvt_pk_bf16_f32 v153, v130, v131
    v_cvt_pk_bf16_f32 v154, v132, v133
    v_cvt_pk_bf16_f32 v155, v134, v135
    s_add_u32 s18, s17, 65536
    buffer_store_dwordx4 v[152:155], v8, s[24:27], s18 offen
    s_waitcnt vmcnt(9)
    v_lshlrev_b32 v136, 16, v80
    v_and_b32 v137, 0xffff0000, v80
    v_lshlrev_b32 v138, 16, v81
    v_and_b32 v139, 0xffff0000, v81
    v_lshlrev_b32 v140, 16, v82
    v_and_b32 v141, 0xffff0000, v82
    v_lshlrev_b32 v142, 16, v83
    v_and_b32 v143, 0xffff0000, v83
    s_waitcnt vmcnt(8)
    v_lshlrev_b32 v112, 16, v84
    v_and_b32 v113, 0xffff0000, v84
    v_add_f32 v136, v136, v112
    v_add_f32 v137, v137, v113
    v_lshlrev_b32 v112, 16, v85
    v_and_b32 v113, 0xffff0000, v85
    v_add_f32 v138, v138, v112
    v_add_f32 v139, v139, v113
    v_lshlrev_b32 v112, 16, v86
    v_and_b32 v113, 0xffff0000, v86
    v_add_f32 v140, v140, v112
    v_add_f32 v141, v141, v113
    v_lshlrev_b32 v112, 16, v87
    v_and_b32 v113, 0xffff0000, v87
    v_add_f32 v142, v142, v112
    v_add_f32 v143, v143, v113
    s_waitcnt vmcnt(7)
    v_lshlrev_b32 v112, 16, v88
    v_and_b32 v113, 0xffff0000, v88
    v_add_f32 v136, v136, v112
    v_add_f32 v137, v137, v113
    v_lshlrev_b32 v112, 16, v89
    v_and_b32 v113, 0xffff0000, v89
    v_add_f32 v138, v138, v112
    v_add_f32 v139, v139, v113
    v_lshlrev_b32 v112, 16, v90
    v_and_b32 v113, 0xffff0000, v90
    v_add_f32 v140, v140, v112
    v_add_f32 v141, v141, v113
    v_lshlrev_b32 v112, 16, v91
    v_and_b32 v113, 0xffff0000, v91
    v_add_f32 v142, v142, v112
    v_add_f32 v143, v143, v113
    s_waitcnt vmcnt(6)
    v_lshlrev_b32 v112, 16, v92
    v_and_b32 v113, 0xffff0000, v92
    v_add_f32 v136, v136, v112
    v_add_f32 v137, v137, v113
    v_lshlrev_b32 v112, 16, v93
    v_and_b32 v113, 0xffff0000, v93
    v_add_f32 v138, v138, v112
    v_add_f32 v139, v139, v113
    v_lshlrev_b32 v112, 16, v94
    v_and_b32 v113, 0xffff0000, v94
    v_add_f32 v140, v140, v112
    v_add_f32 v141, v141, v113
    v_lshlrev_b32 v112, 16, v95
    v_and_b32 v113, 0xffff0000, v95
    v_add_f32 v142, v142, v112
    v_add_f32 v143, v143, v113
    s_waitcnt vmcnt(5)
    v_lshlrev_b32 v112, 16, v96
    v_and_b32 v113, 0xffff0000, v96
    v_add_f32 v136, v136, v112
    v_add_f32 v137, v137, v113
    v_lshlrev_b32 v112, 16, v97
    v_and_b32 v113, 0xffff0000, v97
    v_add_f32 v138, v138, v112
    v_add_f32 v139, v139, v113
    v_lshlrev_b32 v112, 16, v98
    v_and_b32 v113, 0xffff0000, v98
    v_add_f32 v140, v140, v112
    v_add_f32 v141, v141, v113
    v_lshlrev_b32 v112, 16, v99
    v_and_b32 v113, 0xffff0000, v99
    v_add_f32 v142, v142, v112
    v_add_f32 v143, v143, v113
    s_waitcnt vmcnt(4)
    v_lshlrev_b32 v112, 16, v100
    v_and_b32 v113, 0xffff0000, v100
    v_add_f32 v136, v136, v112
    v_add_f32 v137, v137, v113
    v_lshlrev_b32 v112, 16, v101
    v_and_b32 v113, 0xffff0000, v101
    v_add_f32 v138, v138, v112
    v_add_f32 v139, v139, v113
    v_lshlrev_b32 v112, 16, v102
    v_and_b32 v113, 0xffff0000, v102
    v_add_f32 v140, v140, v112
    v_add_f32 v141, v141, v113
    v_lshlrev_b32 v112, 16, v103
    v_and_b32 v113, 0xffff0000, v103
    v_add_f32 v142, v142, v112
    v_add_f32 v143, v143, v113
    s_waitcnt vmcnt(3)
    v_lshlrev_b32 v112, 16, v104
    v_and_b32 v113, 0xffff0000, v104
    v_add_f32 v136, v136, v112
    v_add_f32 v137, v137, v113
    v_lshlrev_b32 v112, 16, v105
    v_and_b32 v113, 0xffff0000, v105
    v_add_f32 v138, v138, v112
    v_add_f32 v139, v139, v113
    v_lshlrev_b32 v112, 16, v106
    v_and_b32 v113, 0xffff0000, v106
    v_add_f32 v140, v140, v112
    v_add_f32 v141, v141, v113
    v_lshlrev_b32 v112, 16, v107
    v_and_b32 v113, 0xffff0000, v107
    v_add_f32 v142, v142, v112
    v_add_f32 v143, v143, v113
    s_waitcnt vmcnt(2)
    v_lshlrev_b32 v112, 16, v108
    v_and_b32 v113, 0xffff0000, v108
    v_add_f32 v136, v136, v112
    v_add_f32 v137, v137, v113
    v_lshlrev_b32 v112, 16, v109
    v_and_b32 v113, 0xffff0000, v109
    v_add_f32 v138, v138, v112
    v_add_f32 v139, v139, v113
    v_lshlrev_b32 v112, 16, v110
    v_and_b32 v113, 0xffff0000, v110
    v_add_f32 v140, v140, v112
    v_add_f32 v141, v141, v113
    v_lshlrev_b32 v112, 16, v111
    v_and_b32 v113, 0xffff0000, v111
    v_add_f32 v142, v142, v112
    v_add_f32 v143, v143, v113
    v_cvt_pk_bf16_f32 v156, v136, v137
    v_cvt_pk_bf16_f32 v157, v138, v139
    v_cvt_pk_bf16_f32 v158, v140, v141
    v_cvt_pk_bf16_f32 v159, v142, v143
    s_add_u32 s18, s17, 131072
    buffer_store_dwordx4 v[156:159], v8, s[24:27], s18 offen
    s_branch L_slice
L_nomore:
L_fin:
L_end:
    s_endpgm
L_att:
    v_and_b32 v28, 3, v0
    v_lshl_add_u32 v28, v28, 2, v20
    v_mul_u32_u24 v28, 1040, v28
    v_lshl_add_u32 v28, v22, 8, v28
    v_lshl_add_u32 v1, v21, 4, v28
    v_add_u32 v28, v25, v21
    v_mul_u32_u24 v28, 1040, v28
    v_and_b32 v29, 3, v0
    v_lshl_add_u32 v29, v29, 3, v28
    v_lshl_add_u32 v29, v22, 5, v29
    v_add_u32 v2, 33280, v29
    v_lshl_add_u32 v29, v23, 5, v28
    v_lshl_add_u32 v29, v22, 4, v29
    v_lshl_add_u32 v29, v24, 3, v29
    v_add_u32 v3, 66560, v29
    s_lshl_b32 s3, s32, 13
    s_add_u32 s3, s3, 133120
    v_lshlrev_b32 v4, 4, v0
    v_add_u32 v4, s3, v4
    v_mov_b32 v15, v26
    v_lshlrev_b32 v9, 4, v0
    s_mul_i32 s3, s32, 16640
    v_add_u32 v13, s3, v27
    v_add_u32 v14, 83200, v13
    v_mov_b32 v16, 0
    v_mov_b32 v17, 0
    v_mov_b32 v18, 0
    v_mov_b32 v19, 0
    v_mov_b32 v20, 0
    v_mov_b32 v21, 0
    v_mov_b32 v22, 0
    v_mov_b32 v23, 0
    s_nop 1
    v_mfma_f32_32x32x16_bf16 a[0:15], v[16:19], v[20:23], 0
    v_mfma_f32_32x32x16_bf16 a[16:31], v[16:19], v[20:23], 0
    v_mfma_f32_32x32x16_bf16 a[32:47], v[16:19], v[20:23], 0
    v_mfma_f32_32x32x16_bf16 a[48:63], v[16:19], v[20:23], 0
    v_mfma_f32_32x32x16_bf16 a[64:79], v[16:19], v[20:23], 0
    v_mfma_f32_32x32x16_bf16 a[80:95], v[16:19], v[20:23], 0
    v_mfma_f32_32x32x16_bf16 a[96:111], v[16:19], v[20:23], 0
    v_mfma_f32_32x32x16_bf16 a[112:127], v[16:19], v[20:23], 0
    v_mfma_f32_32x32x16_bf16 a[128:143], v[16:19], v[20:23], 0
    v_mfma_f32_32x32x16_bf16 a[144:159], v[16:19], v[20:23], 0
    v_mfma_f32_32x32x16_bf16 a[160:175], v[16:19], v[20:23], 0
    v_mfma_f32_32x32x16_bf16 a[176:191], v[16:19], v[20:23], 0
    v_mfma_f32_32x32x16_bf16 a[192:207], v[16:19], v[20:23], 0
    v_mfma_f32_32x32x16_bf16 a[208:223], v[16:19], v[20:23], 0
    v_mfma_f32_32x32x16_bf16 a[224:239], v[16:19], v[20:23], 0
    v_mfma_f32_32x32x16_bf16 a[240:255], v[16:19], v[20:23], 0
    s_barrier
    ds_read_b128 v[48:51], v13 offset:0
    ds_read_b128 v[52:55], v13 offset:32
    ds_read_b128 v[56:59], v13 offset:64
    ds_read_b128 v[60:63], v13 offset:96
    ds_read_b128 v[64:67], v13 offset:128
    ds_read_b128 v[68:71], v13 offset:160
    ds_read_b128 v[72:75], v13 offset:192
    ds_read_b128 v[76:79], v13 offset:224
    ds_read_b128 v[80:83], v13 offset:256
    ds_read_b128 v[84:87], v13 offset:288
    ds_read_b128 v[88:91], v13 offset:320
    ds_read_b128 v[92:95], v13 offset:352
    ds_read_b128 v[96:99], v13 offset:384
    ds_read_b128 v[100:103], v13 offset:416
    ds_read_b128 v[104:107], v13 offset:448
    ds_read_b128 v[108:111], v13 offset:480
    v_add_u32 v11, 49920, v15
    ds_read_b64_tr_b16 v[16:17], v11 offset:0
    ds_read_b64_tr_b16 v[18:19], v11 offset:1040
    ds_read_b64_tr_b16 v[20:21], v11 offset:128
    ds_read_b64_tr_b16 v[22:23], v11 offset:1168
    ds_read_b64_tr_b16 v[24:25], v11 offset:256
    ds_read_b64_tr_b16 v[26:27], v11 offset:1296
    ds_read_b64_tr_b16 v[28:29], v11 offset:384
    ds_read_b64_tr_b16 v[30:31], v11 offset:1424
    ds_read_b64_tr_b16 v[32:33], v11 offset:512
    ds_read_b64_tr_b16 v[34:35], v11 offset:1552
    ds_read_b64_tr_b16 v[36:37], v11 offset:640
    ds_read_b64_tr_b16 v[38:39], v11 offset:1680
    s_waitcnt lgkmcnt(8)
    v_mfma_f32_32x32x16_bf16 v[208:223], v[16:19], v[48:51], 0
    ds_read_b64_tr_b16 v[40:41], v11 offset:768
    ds_read_b64_tr_b16 v[42:43], v11 offset:1808
    v_add_u32 v12, 66560, v15
    v_mfma_f32_32x32x16_bf16 v[208:223], v[20:23], v[52:55], v[208:223]
    ds_read_b64_tr_b16 v[44:45], v11 offset:896
    ds_read_b64_tr_b16 v[46:47], v11 offset:1936
    s_waitcnt lgkmcnt(8)
    v_mfma_f32_32x32x16_bf16 v[208:223], v[24:27], v[56:59], v[208:223]
    ds_read_b64_tr_b16 v[16:17], v11 offset:64
    ds_read_b64_tr_b16 v[18:19], v11 offset:1104
    v_mfma_f32_32x32x16_bf16 v[208:223], v[28:31], v[60:63], v[208:223]
    ds_read_b64_tr_b16 v[20:21], v11 offset:192
    ds_read_b64_tr_b16 v[22:23], v11 offset:1232
    s_waitcnt lgkmcnt(8)
    v_mfma_f32_32x32x16_bf16 v[208:223], v[32:35], v[64:67], v[208:223]
    ds_read_b64_tr_b16 v[24:25], v11 offset:320
    ds_read_b64_tr_b16 v[26:27], v11 offset:1360
    v_mfma_f32_32x32x16_bf16 v[208:223], v[36:39], v[68:71], v[208:223]
    ds_read_b64_tr_b16 v[28:29], v11 offset:448
    ds_read_b64_tr_b16 v[30:31], v11 offset:1488
    s_waitcnt lgkmcnt(8)
    v_mfma_f32_32x32x16_bf16 v[208:223], v[40:43], v[72:75], v[208:223]
    ds_read_b64_tr_b16 v[32:33], v11 offset:576
    ds_read_b64_tr_b16 v[34:35], v11 offset:1616
    v_mfma_f32_32x32x16_bf16 v[208:223], v[44:47], v[76:79], v[208:223]
    ds_read_b64_tr_b16 v[36:37], v11 offset:704
    ds_read_b64_tr_b16 v[38:39], v11 offset:1744
    s_waitcnt lgkmcnt(8)
    v_mfma_f32_32x32x16_bf16 v[224:239], v[16:19], v[48:51], 0
    ds_read_b64_tr_b16 v[40:41], v11 offset:832
    ds_read_b64_tr_b16 v[42:43], v11 offset:1872
    v_mfma_f32_32x32x16_bf16 v[224:239], v[20:23], v[52:55], v[224:239]
    ds_read_b64_tr_b16 v[44:45], v11 offset:960
    ds_read_b64_tr_b16 v[46:47], v11 offset:2000
    s_waitcnt lgkmcnt(8)
    v_mfma_f32_32x32x16_bf16 v[224:239], v[24:27], v[56:59], v[224:239]
    v_mfma_f32_32x32x16_bf16 v[224:239], v[28:31], v[60:63], v[224:239]
    s_waitcnt lgkmcnt(4)
    v_mfma_f32_32x32x16_bf16 v[224:239], v[32:35], v[64:67], v[224:239]
    v_mfma_f32_32x32x16_bf16 v[224:239], v[36:39], v[68:71], v[224:239]
    s_waitcnt lgkmcnt(0)
    v_mfma_f32_32x32x16_bf16 v[224:239], v[40:43], v[72:75], v[224:239]
    v_mfma_f32_32x32x16_bf16 v[224:239], v[44:47], v[76:79], v[224:239]
    ds_read_b64_tr_b16 v[16:17], v12 offset:0
    ds_read_b64_tr_b16 v[18:19], v12 offset:1040
    ds_read_b64_tr_b16 v[20:21], v12 offset:128
    ds_read_b64_tr_b16 v[22:23], v12 offset:1168
    ds_read_b64_tr_b16 v[24:25], v12 offset:256
    ds_read_b64_tr_b16 v[26:27], v12 offset:1296
    ds_read_b64_tr_b16 v[28:29], v12 offset:384
    ds_read_b64_tr_b16 v[30:31], v12 offset:1424
    ds_read_b64_tr_b16 v[32:33], v12 offset:512
    ds_read_b64_tr_b16 v[34:35], v12 offset:1552
    ds_read_b64_tr_b16 v[36:37], v12 offset:640
    ds_read_b64_tr_b16 v[38:39], v12 offset:1680
    s_waitcnt lgkmcnt(8)
    v_mfma_f32_32x32x16_bf16 v[208:223], v[16:19], v[80:83], v[208:223]
    ds_read_b64_tr_b16 v[40:41], v12 offset:768
    ds_read_b64_tr_b16 v[42:43], v12 offset:1808
    v_mfma_f32_32x32x16_bf16 v[208:223], v[20:23], v[84:87], v[208:223]
    ds_read_b64_tr_b16 v[44:45], v12 offset:896
    ds_read_b64_tr_b16 v[46:47], v12 offset:1936
    s_waitcnt lgkmcnt(8)
    v_mfma_f32_32x32x16_bf16 v[208:223], v[24:27], v[88:91], v[208:223]
    ds_read_b64_tr_b16 v[16:17], v12 offset:64
    ds_read_b64_tr_b16 v[18:19], v12 offset:1104
    v_mfma_f32_32x32x16_bf16 v[208:223], v[28:31], v[92:95], v[208:223]
    ds_read_b64_tr_b16 v[20:21], v12 offset:192
    ds_read_b64_tr_b16 v[22:23], v12 offset:1232
    s_waitcnt lgkmcnt(8)
    v_mfma_f32_32x32x16_bf16 v[208:223], v[32:35], v[96:99], v[208:223]
    ds_read_b64_tr_b16 v[24:25], v12 offset:320
    ds_read_b64_tr_b16 v[26:27], v12 offset:1360
    v_mfma_f32_32x32x16_bf16 v[208:223], v[36:39], v[100:103], v[208:223]
    ds_read_b64_tr_b16 v[28:29], v12 offset:448
    ds_read_b64_tr_b16 v[30:31], v12 offset:1488
    s_waitcnt lgkmcnt(8)
    v_mfma_f32_32x32x16_bf16 v[208:223], v[40:43], v[104:107], v[208:223]
    ds_read_b64_tr_b16 v[32:33], v12 offset:576
    ds_read_b64_tr_b16 v[34:35], v12 offset:1616
    v_mfma_f32_32x32x16_bf16 v[208:223], v[44:47], v[108:111], v[208:223]
    ds_read_b64_tr_b16 v[36:37], v12 offset:704
    ds_read_b64_tr_b16 v[38:39], v12 offset:1744
    s_waitcnt lgkmcnt(8)
    v_mfma_f32_32x32x16_bf16 v[224:239], v[16:19], v[80:83], v[224:239]
    ds_read_b64_tr_b16 v[40:41], v12 offset:832
    ds_read_b64_tr_b16 v[42:43], v12 offset:1872
    v_mfma_f32_32x32x16_bf16 v[224:239], v[20:23], v[84:87], v[224:239]
    ds_read_b64_tr_b16 v[44:45], v12 offset:960
    ds_read_b64_tr_b16 v[46:47], v12 offset:2000
    s_waitcnt lgkmcnt(8)
    v_mfma_f32_32x32x16_bf16 v[224:239], v[24:27], v[88:91], v[224:239]
    v_mfma_f32_32x32x16_bf16 v[224:239], v[28:31], v[92:95], v[224:239]
    s_waitcnt lgkmcnt(4)
    v_mfma_f32_32x32x16_bf16 v[224:239], v[32:35], v[96:99], v[224:239]
    v_mfma_f32_32x32x16_bf16 v[224:239], v[36:39], v[100:103], v[224:239]
    s_waitcnt lgkmcnt(0)
    v_mfma_f32_32x32x16_bf16 v[224:239], v[40:43], v[104:107], v[224:239]
    v_mfma_f32_32x32x16_bf16 v[224:239], v[44:47], v[108:111], v[224:239]
    s_barrier
    ds_read_b128 v[144:147], v14 offset:0
    ds_read_b128 v[148:151], v14 offset:32
    ds_read_b128 v[152:155], v14 offset:64
    ds_read_b128 v[156:159], v14 offset:96
    ds_read_b128 v[160:163], v14 offset:128
    ds_read_b128 v[164:167], v14 offset:160
    ds_read_b128 v[168:171], v14 offset:192
    ds_read_b128 v[172:175], v14 offset:224
    ds_read_b128 v[176:179], v14 offset:256
    ds_read_b128 v[180:183], v14 offset:288
    ds_read_b128 v[184:187], v14 offset:320
    ds_read_b128 v[188:191], v14 offset:352
    ds_read_b128 v[192:195], v14 offset:384
    ds_read_b128 v[196:199], v14 offset:416
    ds_read_b128 v[200:203], v14 offset:448
    ds_read_b128 v[204:207], v14 offset:480
    v_add_u32 v11, 133120, v15
    ds_read_b64_tr_b16 v[16:17], v11 offset:0
    ds_read_b64_tr_b16 v[18:19], v11 offset:1040
    ds_read_b64_tr_b16 v[20:21], v11 offset:128
    ds_read_b64_tr_b16 v[22:23], v11 offset:1168
    ds_read_b64_tr_b16 v[24:25], v11 offset:256
    ds_read_b64_tr_b16 v[26:27], v11 offset:1296
    ds_read_b64_tr_b16 v[28:29], v11 offset:384
    ds_read_b64_tr_b16 v[30:31], v11 offset:1424
    ds_read_b64_tr_b16 v[32:33], v11 offset:512
    ds_read_b64_tr_b16 v[34:35], v11 offset:1552
    ds_read_b64_tr_b16 v[36:37], v11 offset:640
    ds_read_b64_tr_b16 v[38:39], v11 offset:1680
    s_waitcnt lgkmcnt(8)
    v_mfma_f32_32x32x16_bf16 v[208:223], v[16:19], v[144:147], v[208:223]
    ds_read_b64_tr_b16 v[40:41], v11 offset:768
    ds_read_b64_tr_b16 v[42:43], v11 offset:1808
    v_add_u32 v12, 49920, v15
    v_mfma_f32_32x32x16_bf16 v[208:223], v[20:23], v[148:151], v[208:223]
    ds_read_b64_tr_b16 v[44:45], v11 offset:896
    ds_read_b64_tr_b16 v[46:47], v11 offset:1936
    s_waitcnt lgkmcnt(8)
    v_mfma_f32_32x32x16_bf16 v[208:223], v[24:27], v[152:155], v[208:223]
    ds_read_b64_tr_b16 v[16:17], v11 offset:64
    ds_read_b64_tr_b16 v[18:19], v11 offset:1104
    v_mfma_f32_32x32x16_bf16 v[208:223], v[28:31], v[156:159], v[208:223]
    ds_read_b64_tr_b16 v[20:21], v11 offset:192
    ds_read_b64_tr_b16 v[22:23], v11 offset:1232
    s_waitcnt lgkmcnt(8)
    v_mfma_f32_32x32x16_bf16 v[208:223], v[32:35], v[160:163], v[208:223]
    ds_read_b64_tr_b16 v[24:25], v11 offset:320
    ds_read_b64_tr_b16 v[26:27], v11 offset:1360
    v_mfma_f32_32x32x16_bf16 v[208:223], v[36:39], v[164:167], v[208:223]
    ds_read_b64_tr_b16 v[28:29], v11 offset:448
    ds_read_b64_tr_b16 v[30:31], v11 offset:1488
    s_waitcnt lgkmcnt(8)
    v_mfma_f32_32x32x16_bf16 v[208:223], v[40:43], v[168:171], v[208:223]
    ds_read_b64_tr_b16 v[32:33], v11 offset:576
    ds_read_b64_tr_b16 v[34:35], v11 offset:1616
    v_mfma_f32_32x32x16_bf16 v[208:223], v[44:47], v[172:175], v[208:223]
    ds_read_b64_tr_b16 v[36:37], v11 offset:704
    ds_read_b64_tr_b16 v[38:39], v11 offset:1744
    s_waitcnt lgkmcnt(8)
    v_mfma_f32_32x32x16_bf16 v[224:239], v[16:19], v[144:147], v[224:239]
    ds_read_b64_tr_b16 v[40:41], v11 offset:832
    ds_read_b64_tr_b16 v[42:43], v11 offset:1872
    v_mfma_f32_32x32x16_bf16 v[224:239], v[20:23], v[148:151], v[224:239]
    ds_read_b64_tr_b16 v[44:45], v11 offset:960
    ds_read_b64_tr_b16 v[46:47], v11 offset:2000
    s_waitcnt lgkmcnt(8)
    v_mfma_f32_32x32x16_bf16 v[224:239], v[24:27], v[152:155], v[224:239]
    v_mfma_f32_32x32x16_bf16 v[224:239], v[28:31], v[156:159], v[224:239]
    s_waitcnt lgkmcnt(4)
    v_mfma_f32_32x32x16_bf16 v[224:239], v[32:35], v[160:163], v[224:239]
    v_mfma_f32_32x32x16_bf16 v[224:239], v[36:39], v[164:167], v[224:239]
    s_waitcnt lgkmcnt(0)
    v_mfma_f32_32x32x16_bf16 v[224:239], v[40:43], v[168:171], v[224:239]
    v_mfma_f32_32x32x16_bf16 v[224:239], v[44:47], v[172:175], v[224:239]
    s_barrier
    ds_read_b64_tr_b16 v[16:17], v12 offset:0
    ds_read_b64_tr_b16 v[18:19], v12 offset:1040
    ds_read_b64_tr_b16 v[20:21], v12 offset:128
    ds_read_b64_tr_b16 v[22:23], v12 offset:1168
    ds_read_b64_tr_b16 v[24:25], v12 offset:256
    ds_read_b64_tr_b16 v[26:27], v12 offset:1296
    ds_read_b64_tr_b16 v[28:29], v12 offset:384
    ds_read_b64_tr_b16 v[30:31], v12 offset:1424
    ds_read_b64_tr_b16 v[32:33], v12 offset:512
    ds_read_b64_tr_b16 v[34:35], v12 offset:1552
    ds_read_b64_tr_b16 v[36:37], v12 offset:640
    ds_read_b64_tr_b16 v[38:39], v12 offset:1680
    s_waitcnt lgkmcnt(8)
    v_mfma_f32_32x32x16_bf16 v[208:223], v[16:19], v[176:179], v[208:223]
    ds_read_b64_tr_b16 v[40:41], v12 offset:768
    ds_read_b64_tr_b16 v[42:43], v12 offset:1808
    v_mfma_f32_32x32x16_bf16 v[208:223], v[20:23], v[180:183], v[208:223]
    ds_read_b64_tr_b16 v[44:45], v12 offset:896
    ds_read_b64_tr_b16 v[46:47], v12 offset:1936
    s_waitcnt lgkmcnt(8)
    v_mfma_f32_32x32x16_bf16 v[208:223], v[24:27], v[184:187], v[208:223]
    ds_read_b64_tr_b16 v[16:17], v12 offset:64
    ds_read_b64_tr_b16 v[18:19], v12 offset:1104
    v_mfma_f32_32x32x16_bf16 v[208:223], v[28:31], v[188:191], v[208:223]
    ds_read_b64_tr_b16 v[20:21], v12 offset:192
    ds_read_b64_tr_b16 v[22:23], v12 offset:1232
    s_waitcnt lgkmcnt(8)
    v_mfma_f32_32x32x16_bf16 v[208:223], v[32:35], v[192:195], v[208:223]
    ds_read_b64_tr_b16 v[24:25], v12 offset:320
    ds_read_b64_tr_b16 v[26:27], v12 offset:1360
    v_mfma_f32_32x32x16_bf16 v[208:223], v[36:39], v[196:199], v[208:223]
    ds_read_b64_tr_b16 v[28:29], v12 offset:448
    ds_read_b64_tr_b16 v[30:31], v12 offset:1488
    s_waitcnt lgkmcnt(8)
    v_mfma_f32_32x32x16_bf16 v[208:223], v[40:43], v[200:203], v[208:223]
    ds_read_b64_tr_b16 v[32:33], v12 offset:576
    ds_read_b64_tr_b16 v[34:35], v12 offset:1616
    v_mfma_f32_32x32x16_bf16 v[208:223], v[44:47], v[204:207], v[208:223]
    ds_read_b64_tr_b16 v[36:37], v12 offset:704
    ds_read_b64_tr_b16 v[38:39], v12 offset:1744
    s_waitcnt lgkmcnt(8)
    v_mfma_f32_32x32x16_bf16 v[224:239], v[16:19], v[176:179], v[224:239]
    ds_read_b64_tr_b16 v[40:41], v12 offset:832
    ds_read_b64_tr_b16 v[42:43], v12 offset:1872
    v_mfma_f32_32x32x16_bf16 v[224:239], v[20:23], v[180:183], v[224:239]
    ds_read_b64_tr_b16 v[44:45], v12 offset:960
    ds_read_b64_tr_b16 v[46:47], v12 offset:2000
    s_nop 2
    v_mul_f32 v208, s33, v208
    v_mul_f32 v209, s33, v209
    v_mul_f32 v210, s33, v210
    v_mul_f32 v211, s33, v211
    v_cvt_pk_bf16_f32 v112, v208, v209
    v_mul_f32 v212, s33, v212
    v_mul_f32 v213, s33, v213
    s_waitcnt lgkmcnt(8)
    v_mfma_f32_32x32x16_bf16 v[224:239], v[24:27], v[184:187], v[224:239]
    v_cvt_pk_bf16_f32 v113, v210, v211
    v_mul_f32 v214, s33, v214
    v_mul_f32 v215, s33, v215
    v_cvt_pk_bf16_f32 v114, v212, v213
    v_mul_f32 v216, s33, v216
    v_mul_f32 v217, s33, v217
    v_cvt_pk_bf16_f32 v115, v214, v215
    v_mfma_f32_32x32x16_bf16 v[224:239], v[28:31], v[188:191], v[224:239]
    v_mul_f32 v218, s33, v218
    v_mul_f32 v219, s33, v219
    v_cvt_pk_bf16_f32 v116, v216, v217
    v_mul_f32 v220, s33, v220
    v_mul_f32 v221, s33, v221
    v_cvt_pk_bf16_f32 v117, v218, v219
    v_mul_f32 v222, s33, v222
    s_waitcnt lgkmcnt(4)
    v_mfma_f32_32x32x16_bf16 v[224:239], v[32:35], v[192:195], v[224:239]
    v_mul_f32 v223, s33, v223
    v_cvt_pk_bf16_f32 v118, v220, v221
    v_cvt_pk_bf16_f32 v119, v222, v223
    v_mfma_f32_32x32x16_bf16 v[224:239], v[36:39], v[196:199], v[224:239]
    s_waitcnt lgkmcnt(0)
    v_mfma_f32_32x32x16_bf16 v[224:239], v[40:43], v[200:203], v[224:239]
    v_mfma_f32_32x32x16_bf16 v[224:239], v[44:47], v[204:207], v[224:239]
    s_nop 11
    v_mul_f32 v224, s33, v224
    v_mul_f32 v225, s33, v225
    v_mul_f32 v226, s33, v226
    v_mul_f32 v227, s33, v227
    v_cvt_pk_bf16_f32 v120, v224, v225
    v_mul_f32 v228, s33, v228
    v_mul_f32 v229, s33, v229
    v_cvt_pk_bf16_f32 v121, v226, v227
    v_mul_f32 v230, s33, v230
    v_mul_f32 v231, s33, v231
    v_cvt_pk_bf16_f32 v122, v228, v229
    v_mul_f32 v232, s33, v232
    v_mul_f32 v233, s33, v233
    v_cvt_pk_bf16_f32 v123, v230, v231
    v_mul_f32 v234, s33, v234
    v_mul_f32 v235, s33, v235
    v_cvt_pk_bf16_f32 v124, v232, v233
    v_mul_f32 v236, s33, v236
    v_mul_f32 v237, s33, v237
    v_cvt_pk_bf16_f32 v125, v234, v235
    v_mul_f32 v238, s33, v238
    v_mul_f32 v239, s33, v239
    v_cvt_pk_bf16_f32 v126, v236, v237
    v_cvt_pk_bf16_f32 v127, v238, v239
    v_add_u32 v11, 66560, v15
    ds_read_b64_tr_b16 v[16:17], v11 offset:0
    ds_read_b64_tr_b16 v[18:19], v11 offset:1040
    ds_read_b64_tr_b16 v[20:21], v11 offset:128
    ds_read_b64_tr_b16 v[22:23], v11 offset:1168
    ds_read_b64_tr_b16 v[24:25], v11 offset:256
    ds_read_b64_tr_b16 v[26:27], v11 offset:1296
    ds_read_b64_tr_b16 v[28:29], v11 offset:384
    ds_read_b64_tr_b16 v[30:31], v11 offset:1424
    ds_read_b64_tr_b16 v[32:33], v11 offset:512
    ds_read_b64_tr_b16 v[34:35], v11 offset:1552
    ds_read_b64_tr_b16 v[36:37], v11 offset:640
    ds_read_b64_tr_b16 v[38:39], v11 offset:1680
    s_waitcnt lgkmcnt(8)
    v_mfma_f32_32x32x16_bf16 v[208:223], v[16:19], v[48:51], 0
    ds_read_b64_tr_b16 v[40:41], v11 offset:768
    ds_read_b64_tr_b16 v[42:43], v11 offset:1808
    v_add_u32 v12, 33280, v15
    v_mfma_f32_32x32x16_bf16 v[208:223], v[20:23], v[52:55], v[208:223]
    ds_read_b64_tr_b16 v[44:45], v11 offset:896
    ds_read_b64_tr_b16 v[46:47], v11 offset:1936
    s_waitcnt lgkmcnt(8)
    v_mfma_f32_32x32x16_bf16 v[208:223], v[24:27], v[56:59], v[208:223]
    ds_read_b64_tr_b16 v[16:17], v11 offset:64
    ds_read_b64_tr_b16 v[18:19], v11 offset:1104
    v_mfma_f32_32x32x16_bf16 v[208:223], v[28:31], v[60:63], v[208:223]
    ds_read_b64_tr_b16 v[20:21], v11 offset:192
    ds_read_b64_tr_b16 v[22:23], v11 offset:1232
    s_waitcnt lgkmcnt(8)
    v_mfma_f32_32x32x16_bf16 v[208:223], v[32:35], v[64:67], v[208:223]
    ds_read_b64_tr_b16 v[24:25], v11 offset:320
    ds_read_b64_tr_b16 v[26:27], v11 offset:1360
    v_mfma_f32_32x32x16_bf16 v[208:223], v[36:39], v[68:71], v[208:223]
    ds_read_b64_tr_b16 v[28:29], v11 offset:448
    ds_read_b64_tr_b16 v[30:31], v11 offset:1488
    s_waitcnt lgkmcnt(8)
    v_mfma_f32_32x32x16_bf16 v[208:223], v[40:43], v[72:75], v[208:223]
    ds_read_b64_tr_b16 v[32:33], v11 offset:576
    ds_read_b64_tr_b16 v[34:35], v11 offset:1616
    v_mfma_f32_32x32x16_bf16 v[208:223], v[44:47], v[76:79], v[208:223]
    ds_read_b64_tr_b16 v[36:37], v11 offset:704
    ds_read_b64_tr_b16 v[38:39], v11 offset:1744
    s_waitcnt lgkmcnt(8)
    v_mfma_f32_32x32x16_bf16 v[224:239], v[16:19], v[48:51], 0
    ds_read_b64_tr_b16 v[40:41], v11 offset:832
    ds_read_b64_tr_b16 v[42:43], v11 offset:1872
    v_mfma_f32_32x32x16_bf16 v[224:239], v[20:23], v[52:55], v[224:239]
    ds_read_b64_tr_b16 v[44:45], v11 offset:960
    ds_read_b64_tr_b16 v[46:47], v11 offset:2000
    s_waitcnt lgkmcnt(8)
    v_mfma_f32_32x32x16_bf16 v[224:239], v[24:27], v[56:59], v[224:239]
    v_mfma_f32_32x32x16_bf16 v[224:239], v[28:31], v[60:63], v[224:239]
    s_waitcnt lgkmcnt(4)
    v_mfma_f32_32x32x16_bf16 v[224:239], v[32:35], v[64:67], v[224:239]
    v_mfma_f32_32x32x16_bf16 v[224:239], v[36:39], v[68:71], v[224:239]
    s_waitcnt lgkmcnt(0)
    v_mfma_f32_32x32x16_bf16 v[224:239], v[40:43], v[72:75], v[224:239]
    v_mfma_f32_32x32x16_bf16 v[224:239], v[44:47], v[76:79], v[224:239]
    v_add_u32 v11, 83200, v15
    ds_read_b64_tr_b16 v[16:17], v12 offset:0
    ds_read_b64_tr_b16 v[18:19], v12 offset:1040
    ds_read_b64_tr_b16 v[20:21], v12 offset:128
    ds_read_b64_tr_b16 v[22:23], v12 offset:1168
    ds_read_b64_tr_b16 v[24:25], v12 offset:256
    ds_read_b64_tr_b16 v[26:27], v12 offset:1296
    ds_read_b64_tr_b16 v[28:29], v12 offset:384
    ds_read_b64_tr_b16 v[30:31], v12 offset:1424
    ds_read_b64_tr_b16 v[32:33], v12 offset:512
    ds_read_b64_tr_b16 v[34:35], v12 offset:1552
    ds_read_b64_tr_b16 v[36:37], v12 offset:640
    ds_read_b64_tr_b16 v[38:39], v12 offset:1680
    s_waitcnt lgkmcnt(8)
    v_mfma_f32_32x32x16_bf16 v[208:223], v[16:19], v[80:83], v[208:223]
    ds_read_b64_tr_b16 v[40:41], v12 offset:768
    ds_read_b64_tr_b16 v[42:43], v12 offset:1808
    v_mfma_f32_32x32x16_bf16 v[208:223], v[20:23], v[84:87], v[208:223]
    ds_read_b64_tr_b16 v[44:45], v12 offset:896
    ds_read_b64_tr_b16 v[46:47], v12 offset:1936
    s_waitcnt lgkmcnt(8)
    v_mfma_f32_32x32x16_bf16 v[208:223], v[24:27], v[88:91], v[208:223]
    ds_read_b64_tr_b16 v[16:17], v12 offset:64
    ds_read_b64_tr_b16 v[18:19], v12 offset:1104
    v_mfma_f32_32x32x16_bf16 v[208:223], v[28:31], v[92:95], v[208:223]
    ds_read_b64_tr_b16 v[20:21], v12 offset:192
    ds_read_b64_tr_b16 v[22:23], v12 offset:1232
    s_waitcnt lgkmcnt(8)
    v_mfma_f32_32x32x16_bf16 v[208:223], v[32:35], v[96:99], v[208:223]
    ds_read_b64_tr_b16 v[24:25], v12 offset:320
    ds_read_b64_tr_b16 v[26:27], v12 offset:1360
    v_mfma_f32_32x32x16_bf16 v[208:223], v[36:39], v[100:103], v[208:223]
    ds_read_b64_tr_b16 v[28:29], v12 offset:448
    ds_read_b64_tr_b16 v[30:31], v12 offset:1488
    s_waitcnt lgkmcnt(8)
    v_mfma_f32_32x32x16_bf16 v[208:223], v[40:43], v[104:107], v[208:223]
    ds_read_b64_tr_b16 v[32:33], v12 offset:576
    ds_read_b64_tr_b16 v[34:35], v12 offset:1616
    v_mfma_f32_32x32x16_bf16 v[208:223], v[44:47], v[108:111], v[208:223]
    ds_read_b64_tr_b16 v[36:37], v12 offset:704
    ds_read_b64_tr_b16 v[38:39], v12 offset:1744
    s_waitcnt lgkmcnt(8)
    v_mfma_f32_32x32x16_bf16 v[224:239], v[16:19], v[80:83], v[224:239]
    ds_read_b64_tr_b16 v[40:41], v12 offset:832
    ds_read_b64_tr_b16 v[42:43], v12 offset:1872
    v_mfma_f32_32x32x16_bf16 v[224:239], v[20:23], v[84:87], v[224:239]
    ds_read_b64_tr_b16 v[44:45], v12 offset:960
    ds_read_b64_tr_b16 v[46:47], v12 offset:2000
    s_waitcnt lgkmcnt(8)
    v_mfma_f32_32x32x16_bf16 v[224:239], v[24:27], v[88:91], v[224:239]
    v_mfma_f32_32x32x16_bf16 v[224:239], v[28:31], v[92:95], v[224:239]
    s_waitcnt lgkmcnt(4)
    v_mfma_f32_32x32x16_bf16 v[224:239], v[32:35], v[96:99], v[224:239]
    v_mfma_f32_32x32x16_bf16 v[224:239], v[36:39], v[100:103], v[224:239]
    s_waitcnt lgkmcnt(0)
    v_mfma_f32_32x32x16_bf16 v[224:239], v[40:43], v[104:107], v[224:239]
    v_mfma_f32_32x32x16_bf16 v[224:239], v[44:47], v[108:111], v[224:239]
    v_add_u32 v12, 133120, v15
    s_waitcnt vmcnt(0)
    s_barrier
    ds_read_b64_tr_b16 v[16:17], v11 offset:0
    ds_read_b64_tr_b16 v[18:19], v11 offset:1040
    ds_read_b64_tr_b16 v[20:21], v11 offset:128
    ds_read_b64_tr_b16 v[22:23], v11 offset:1168
    ds_read_b64_tr_b16 v[24:25], v11 offset:256
    ds_read_b64_tr_b16 v[26:27], v11 offset:1296
    ds_read_b64_tr_b16 v[28:29], v11 offset:384
    ds_read_b64_tr_b16 v[30:31], v11 offset:1424
    ds_read_b64_tr_b16 v[32:33], v11 offset:512
    ds_read_b64_tr_b16 v[34:35], v11 offset:1552
    ds_read_b64_tr_b16 v[36:37], v11 offset:640
    ds_read_b64_tr_b16 v[38:39], v11 offset:1680
    s_waitcnt lgkmcnt(8)
    v_mfma_f32_32x32x16_bf16 v[208:223], v[16:19], v[144:147], v[208:223]
    ds_read_b64_tr_b16 v[40:41], v11 offset:768
    ds_read_b64_tr_b16 v[42:43], v11 offset:1808
    v_mfma_f32_32x32x16_bf16 v[208:223], v[20:23], v[148:151], v[208:223]
    ds_read_b64_tr_b16 v[44:45], v11 offset:896
    ds_read_b64_tr_b16 v[46:47], v11 offset:1936
    s_waitcnt lgkmcnt(8)
    v_mfma_f32_32x32x16_bf16 v[208:223], v[24:27], v[152:155], v[208:223]
    ds_read_b64_tr_b16 v[16:17], v11 offset:64
    ds_read_b64_tr_b16 v[18:19], v11 offset:1104
    v_mfma_f32_32x32x16_bf16 v[208:223], v[28:31], v[156:159], v[208:223]
    ds_read_b64_tr_b16 v[20:21], v11 offset:192
    ds_read_b64_tr_b16 v[22:23], v11 offset:1232
    s_waitcnt lgkmcnt(8)
    v_mfma_f32_32x32x16_bf16 v[208:223], v[32:35], v[160:163], v[208:223]
    ds_read_b64_tr_b16 v[24:25], v11 offset:320
    ds_read_b64_tr_b16 v[26:27], v11 offset:1360
    v_mfma_f32_32x32x16_bf16 v[208:223], v[36:39], v[164:167], v[208:223]
    ds_read_b64_tr_b16 v[28:29], v11 offset:448
    ds_read_b64_tr_b16 v[30:31], v11 offset:1488
    s_waitcnt lgkmcnt(8)
    v_mfma_f32_32x32x16_bf16 v[208:223], v[40:43], v[168:171], v[208:223]
    ds_read_b64_tr_b16 v[32:33], v11 offset:576
    ds_read_b64_tr_b16 v[34:35], v11 offset:1616
    v_mfma_f32_32x32x16_bf16 v[208:223], v[44:47], v[172:175], v[208:223]
    ds_read_b64_tr_b16 v[36:37], v11 offset:704
    ds_read_b64_tr_b16 v[38:39], v11 offset:1744
    s_waitcnt lgkmcnt(8)
    v_mfma_f32_32x32x16_bf16 v[224:239], v[16:19], v[144:147], v[224:239]
    ds_read_b64_tr_b16 v[40:41], v11 offset:832
    ds_read_b64_tr_b16 v[42:43], v11 offset:1872
    v_mfma_f32_32x32x16_bf16 v[224:239], v[20:23], v[148:151], v[224:239]
    ds_read_b64_tr_b16 v[44:45], v11 offset:960
    ds_read_b64_tr_b16 v[46:47], v11 offset:2000
    s_waitcnt lgkmcnt(8)
    v_mfma_f32_32x32x16_bf16 v[224:239], v[24:27], v[152:155], v[224:239]
    v_mfma_f32_32x32x16_bf16 v[224:239], v[28:31], v[156:159], v[224:239]
    s_waitcnt lgkmcnt(4)
    v_mfma_f32_32x32x16_bf16 v[224:239], v[32:35], v[160:163], v[224:239]
    v_mfma_f32_32x32x16_bf16 v[224:239], v[36:39], v[164:167], v[224:239]
    s_waitcnt lgkmcnt(0)
    v_mfma_f32_32x32x16_bf16 v[224:239], v[40:43], v[168:171], v[224:239]
    v_mfma_f32_32x32x16_bf16 v[224:239], v[44:47], v[172:175], v[224:239]
    ds_read_b64_tr_b16 v[16:17], v12 offset:0
    ds_read_b64_tr_b16 v[18:19], v12 offset:1040
    ds_read_b64_tr_b16 v[20:21], v12 offset:128
    ds_read_b64_tr_b16 v[22:23], v12 offset:1168
    ds_read_b64_tr_b16 v[24:25], v12 offset:256
    ds_read_b64_tr_b16 v[26:27], v12 offset:1296
    ds_read_b64_tr_b16 v[28:29], v12 offset:384
    ds_read_b64_tr_b16 v[30:31], v12 offset:1424
    ds_read_b64_tr_b16 v[32:33], v12 offset:512
    ds_read_b64_tr_b16 v[34:35], v12 offset:1552
    ds_read_b64_tr_b16 v[36:37], v12 offset:640
    ds_read_b64_tr_b16 v[38:39], v12 offset:1680
    s_waitcnt lgkmcnt(8)
    v_mfma_f32_32x32x16_bf16 v[208:223], v[16:19], v[176:179], v[208:223]
    ds_read_b64_tr_b16 v[40:41], v12 offset:768
    ds_read_b64_tr_b16 v[42:43], v12 offset:1808
    v_mfma_f32_32x32x16_bf16 v[208:223], v[20:23], v[180:183], v[208:223]
    ds_read_b64_tr_b16 v[44:45], v12 offset:896
    ds_read_b64_tr_b16 v[46:47], v12 offset:1936
    s_waitcnt lgkmcnt(8)
    v_mfma_f32_32x32x16_bf16 v[208:223], v[24:27], v[184:187], v[208:223]
    ds_read_b64_tr_b16 v[16:17], v12 offset:64
    ds_read_b64_tr_b16 v[18:19], v12 offset:1104
    v_mfma_f32_32x32x16_bf16 v[208:223], v[28:31], v[188:191], v[208:223]
    ds_read_b64_tr_b16 v[20:21], v12 offset:192
    ds_read_b64_tr_b16 v[22:23], v12 offset:1232
    s_waitcnt lgkmcnt(8)
    v_mfma_f32_32x32x16_bf16 v[208:223], v[32:35], v[192:195], v[208:223]
    ds_read_b64_tr_b16 v[24:25], v12 offset:320
    ds_read_b64_tr_b16 v[26:27], v12 offset:1360
    v_mfma_f32_32x32x16_bf16 v[208:223], v[36:39], v[196:199], v[208:223]
    ds_read_b64_tr_b16 v[28:29], v12 offset:448
    ds_read_b64_tr_b16 v[30:31], v12 offset:1488
    s_waitcnt lgkmcnt(8)
    v_mfma_f32_32x32x16_bf16 v[208:223], v[40:43], v[200:203], v[208:223]
    ds_read_b64_tr_b16 v[32:33], v12 offset:576
    ds_read_b64_tr_b16 v[34:35], v12 offset:1616
    v_mfma_f32_32x32x16_bf16 v[208:223], v[44:47], v[204:207], v[208:223]
    ds_read_b64_tr_b16 v[36:37], v12 offset:704
    ds_read_b64_tr_b16 v[38:39], v12 offset:1744
    s_waitcnt lgkmcnt(8)
    v_mfma_f32_32x32x16_bf16 v[224:239], v[16:19], v[176:179], v[224:239]
    ds_read_b64_tr_b16 v[40:41], v12 offset:832
    ds_read_b64_tr_b16 v[42:43], v12 offset:1872
    v_mfma_f32_32x32x16_bf16 v[224:239], v[20:23], v[180:183], v[224:239]
    ds_read_b64_tr_b16 v[44:45], v12 offset:960
    ds_read_b64_tr_b16 v[46:47], v12 offset:2000
    s_nop 2
    v_mul_f32 v208, s33, v208
    v_mul_f32 v209, s33, v209
    v_mul_f32 v210, s33, v210
    v_mul_f32 v211, s33, v211
    v_cvt_pk_bf16_f32 v128, v208, v209
    v_mul_f32 v212, s33, v212
    s_waitcnt lgkmcnt(8)
    v_mfma_f32_32x32x16_bf16 v[224:239], v[24:27], v[184:187], v[224:239]
    v_mul_f32 v213, s33, v213
    v_cvt_pk_bf16_f32 v129, v210, v211
    v_mul_f32 v214, s33, v214
    v_mul_f32 v215, s33, v215
    v_cvt_pk_bf16_f32 v130, v212, v213
    v_mul_f32 v216, s33, v216
    v_mfma_f32_32x32x16_bf16 v[224:239], v[28:31], v[188:191], v[224:239]
    v_mul_f32 v217, s33, v217
    v_cvt_pk_bf16_f32 v131, v214, v215
    v_mul_f32 v218, s33, v218
    v_mul_f32 v219, s33, v219
    v_cvt_pk_bf16_f32 v132, v216, v217
    v_mul_f32 v220, s33, v220
    s_waitcnt lgkmcnt(4)
    v_mfma_f32_32x32x16_bf16 v[224:239], v[32:35], v[192:195], v[224:239]
    v_mul_f32 v221, s33, v221
    v_cvt_pk_bf16_f32 v133, v218, v219
    v_mul_f32 v222, s33, v222
    v_mul_f32 v223, s33, v223
    v_cvt_pk_bf16_f32 v134, v220, v221
    v_cvt_pk_bf16_f32 v135, v222, v223
    v_mfma_f32_32x32x16_bf16 v[224:239], v[36:39], v[196:199], v[224:239]
    s_waitcnt lgkmcnt(0)
    v_mfma_f32_32x32x16_bf16 v[224:239], v[40:43], v[200:203], v[224:239]
    v_mfma_f32_32x32x16_bf16 v[224:239], v[44:47], v[204:207], v[224:239]
    s_barrier
    ds_read_b128 v[16:19], v1 offset:0
    ds_read_b128 v[20:23], v1 offset:32
    ds_read_b128 v[24:27], v1 offset:64
    ds_read_b128 v[28:31], v1 offset:96
    ds_read_b128 v[32:35], v1 offset:128
    ds_read_b128 v[36:39], v1 offset:160
    s_waitcnt lgkmcnt(4)
    v_mfma_f32_32x32x16_bf16 v[176:191], v[16:19], v[112:115], 0
    ds_read_b128 v[40:43], v1 offset:192
    s_nop 1
    v_mul_f32 v224, s33, v224
    v_mul_f32 v225, s33, v225
    v_mul_f32 v226, s33, v226
    v_mul_f32 v227, s33, v227
    v_cvt_pk_bf16_f32 v136, v224, v225
    v_mul_f32 v228, s33, v228
    v_mul_f32 v229, s33, v229
    v_cvt_pk_bf16_f32 v137, v226, v227
    v_mfma_f32_32x32x16_bf16 v[176:191], v[20:23], v[116:119], v[176:191]
    ds_read_b128 v[44:47], v1 offset:224
    v_mul_f32 v230, s33, v230
    v_mul_f32 v231, s33, v231
    v_cvt_pk_bf16_f32 v138, v228, v229
    v_mul_f32 v232, s33, v232
    v_mul_f32 v233, s33, v233
    v_cvt_pk_bf16_f32 v139, v230, v231
    v_mul_f32 v234, s33, v234
    v_mul_f32 v235, s33, v235
    s_waitcnt lgkmcnt(4)
    v_mfma_f32_32x32x16_bf16 v[176:191], v[24:27], v[120:123], v[176:191]
    ds_read_b128 v[16:19], v1 offset:512
    v_cvt_pk_bf16_f32 v140, v232, v233
    v_mul_f32 v236, s33, v236
    v_mul_f32 v237, s33, v237
    v_cvt_pk_bf16_f32 v141, v234, v235
    v_mul_f32 v238, s33, v238
    v_mul_f32 v239, s33, v239
    v_cvt_pk_bf16_f32 v142, v236, v237
    v_cvt_pk_bf16_f32 v143, v238, v239
    v_mfma_f32_32x32x16_bf16 v[176:191], v[28:31], v[124:127], v[176:191]
    ds_read_b128 v[20:23], v1 offset:544
    v_mov_b32 v48, 0
    v_mov_b32 v49, 0
    v_mov_b32 v50, 0
    v_mov_b32 v51, 0
    v_mov_b32 v52, 0
    v_mov_b32 v53, 0
    v_mov_b32 v54, 0
    v_mov_b32 v55, 0
    s_waitcnt lgkmcnt(4)
    v_mfma_f32_32x32x16_bf16 v[176:191], v[32:35], v[128:131], v[176:191]
    ds_read_b128 v[24:27], v1 offset:576
    v_mov_b32 v56, 0
    v_mov_b32 v57, 0
    v_mov_b32 v58, 0
    v_mov_b32 v59, 0
    v_mov_b32 v60, 0
    v_mov_b32 v61, 0
    v_mov_b32 v62, 0
    v_mov_b32 v63, 0
    v_mfma_f32_32x32x16_bf16 v[176:191], v[36:39], v[132:135], v[176:191]
    ds_read_b128 v[28:31], v1 offset:608
    v_mov_b32 v64, 0
    v_mov_b32 v65, 0
    v_mov_b32 v66, 0
    v_mov_b32 v67, 0
    v_mov_b32 v68, 0
    v_mov_b32 v69, 0
    v_mov_b32 v70, 0
    v_mov_b32 v71, 0
    s_waitcnt lgkmcnt(4)
    v_mfma_f32_32x32x16_bf16 v[176:191], v[40:43], v[136:139], v[176:191]
    ds_read_b128 v[32:35], v1 offset:640
    v_mov_b32 v72, 0
    v_mov_b32 v73, 0
    v_mov_b32 v74, 0
    v_mov_b32 v75, 0
    v_mov_b32 v76, 0
    v_mov_b32 v77, 0
    v_mov_b32 v78, 0
    v_mov_b32 v79, 0
    v_mfma_f32_32x32x16_bf16 v[176:191], v[44:47], v[140:143], v[176:191]
    ds_read_b128 v[36:39], v1 offset:672
    v_mov_b32 v80, 0
    v_mov_b32 v81, 0
    v_mov_b32 v82, 0
    v_mov_b32 v83, 0
    v_mov_b32 v84, 0
    v_mov_b32 v85, 0
    v_mov_b32 v86, 0
    v_mov_b32 v87, 0
    s_waitcnt lgkmcnt(4)
    v_mfma_f32_32x32x16_bf16 v[192:207], v[16:19], v[112:115], 0
    ds_read_b128 v[40:43], v1 offset:704
    v_mov_b32 v88, 0
    v_mov_b32 v89, 0
    v_mov_b32 v90, 0
    v_mov_b32 v91, 0
    v_mov_b32 v92, 0
    v_mov_b32 v93, 0
    v_mov_b32 v94, 0
    v_mov_b32 v95, 0
    v_mfma_f32_32x32x16_bf16 v[192:207], v[20:23], v[116:119], v[192:207]
    ds_read_b128 v[44:47], v1 offset:736
    v_mov_b32 v96, 0
    v_mov_b32 v97, 0
    v_mov_b32 v98, 0
    v_mov_b32 v99, 0
    v_mov_b32 v100, 0
    v_mov_b32 v101, 0
    v_mov_b32 v102, 0
    v_mov_b32 v103, 0
    s_waitcnt lgkmcnt(4)
    v_mfma_f32_32x32x16_bf16 v[192:207], v[24:27], v[120:123], v[192:207]
    v_mov_b32 v104, 0
    v_mov_b32 v105, 0
    v_mov_b32 v106, 0
    v_mov_b32 v107, 0
    v_mov_b32 v108, 0
    v_mov_b32 v109, 0
    v_mov_b32 v110, 0
    v_mov_b32 v111, 0
    v_mfma_f32_32x32x16_bf16 v[192:207], v[28:31], v[124:127], v[192:207]
    v_mov_b32 v208, 0
    v_mov_b32 v209, 0
    v_mov_b32 v210, 0
    v_mov_b32 v211, 0
    v_mov_b32 v212, 0
    v_mov_b32 v213, 0
    v_mov_b32 v214, 0
    v_mov_b32 v215, 0
    s_waitcnt lgkmcnt(2)
    v_mfma_f32_32x32x16_bf16 v[192:207], v[32:35], v[128:131], v[192:207]
    v_mov_b32 v216, 0
    v_mov_b32 v217, 0
    v_mov_b32 v218, 0
    v_mov_b32 v219, 0
    v_mov_b32 v220, 0
    v_mov_b32 v221, 0
    v_mov_b32 v222, 0
    v_mov_b32 v223, 0
    v_mfma_f32_32x32x16_bf16 v[192:207], v[36:39], v[132:135], v[192:207]
    v_mov_b32 v7, 1.0
    v_mov_b32 v8, 0
    s_cmp_le_i32 s40, 30
    s_cselect_b32 s14, 0x80000, 0
    s_cselect_b32 s38, s36, s39
    s_add_u32 m0, s38, 33280
    s_waitcnt lgkmcnt(0)
    v_mfma_f32_32x32x16_bf16 v[192:207], v[40:43], v[136:139], v[192:207]
    buffer_load_dwordx4 v5, s[12:15], s42 offen nt lds
    s_add_u32 m0, s38, 33296
    s_nop 0
    buffer_load_dwordx4 v5, s[12:15], s42 offen offset:1024 nt lds
    s_add_u32 m0, s38, 33312
    v_mfma_f32_32x32x16_bf16 v[192:207], v[44:47], v[140:143], v[192:207]
    buffer_load_dwordx4 v5, s[12:15], s42 offen offset:2048 nt lds
    s_add_u32 m0, s38, 33328
    s_nop 0
    buffer_load_dwordx4 v5, s[12:15], s42 offen offset:3072 nt lds
    s_add_u32 s42, s42, 16384
    s_and_b32 s42, s42, 0x7ffff
    s_mov_b32 s35, 4
    s_waitcnt lgkmcnt(0)
    s_nop 11
L_att_loop:
    s_waitcnt vmcnt(8)
    s_barrier
    ds_read_b64_tr_b16 v[16:17], v2 offset:16640
    ds_read_b64_tr_b16 v[18:19], v2 offset:18720
    ds_read_b64_tr_b16 v[20:21], v2 offset:16704
    ds_read_b64_tr_b16 v[22:23], v2 offset:18784
    ds_read_b64_tr_b16 v[24:25], v2 offset:16768
    ds_read_b64_tr_b16 v[26:27], v2 offset:18848
    ds_read_b64_tr_b16 v[28:29], v2 offset:16832
    ds_read_b64_tr_b16 v[30:31], v2 offset:18912
    ds_read_b64_tr_b16 v[32:33], v2 offset:16896
    ds_read_b64_tr_b16 v[34:35], v2 offset:18976
    ds_read_b64_tr_b16 v[36:37], v2 offset:16960
    ds_read_b64_tr_b16 v[38:39], v2 offset:19040
    s_waitcnt lgkmcnt(8)
    v_mfma_f32_32x32x16_bf16 v[48:63], v[16:19], v[208:211], v[48:63]
    ds_read_b64_tr_b16 v[40:41], v2 offset:17024
    ds_read_b64_tr_b16 v[42:43], v2 offset:19104
    v_max3_f32 v11, v176, v177, v178
    v_max3_f32 v12, v184, v185, v186
    s_cmp_le_i32 s40, 28
    s_cselect_b32 s10, 0x80000, 0
    s_cselect_b32 s37, s36, s39
    v_max3_f32 v13, v192, v193, v194
    v_mfma_f32_32x32x16_bf16 v[64:79], v[20:23], v[208:211], v[64:79]
    ds_read_b64_tr_b16 v[44:45], v2 offset:17088
    ds_read_b64_tr_b16 v[46:47], v2 offset:19168
    v_max3_f32 v14, v200, v201, v202
    s_add_u32 m0, s37, 0
    v_max3_f32 v11, v11, v179, v180
    v_max3_f32 v12, v12, v187, v188
    s_waitcnt lgkmcnt(8)
    v_mfma_f32_32x32x16_bf16 v[80:95], v[24:27], v[208:211], v[80:95]
    ds_read_b64_tr_b16 v[16:17], v2 offset:17152
    ds_read_b64_tr_b16 v[18:19], v2 offset:19232
    buffer_load_dwordx4 v5, s[8:11], s41 offen nt lds
    v_max3_f32 v13, v13, v195, v196
    v_max3_f32 v14, v14, v203, v204
    s_add_u32 m0, s37, 16
    v_mfma_f32_32x32x16_bf16 v[96:111], v[28:31], v[208:211], v[96:111]
    ds_read_b64_tr_b16 v[20:21], v2 offset:17216
    ds_read_b64_tr_b16 v[22:23], v2 offset:19296
    v_max3_f32 v11, v11, v181, v182
    v_max3_f32 v12, v12, v189, v190
    buffer_load_dwordx4 v5, s[8:11], s41 offen offset:1024 nt lds
    v_max3_f32 v13, v13, v197, v198
    s_waitcnt lgkmcnt(8)
    v_mfma_f32_32x32x16_bf16 v[48:63], v[32:35], v[212:215], v[48:63]
    ds_read_b64_tr_b16 v[24:25], v2 offset:17280
    ds_read_b64_tr_b16 v[26:27], v2 offset:19360
    v_max3_f32 v14, v14, v205, v206
    s_add_u32 m0, s37, 32
    v_max3_f32 v11, v11, v183, v12
    v_max3_f32 v13, v13, v199, v14
    v_mfma_f32_32x32x16_bf16 v[64:79], v[36:39], v[212:215], v[64:79]
    ds_read_b64_tr_b16 v[28:29], v2 offset:17344
    ds_read_b64_tr_b16 v[30:31], v2 offset:19424
    buffer_load_dwordx4 v5, s[8:11], s41 offen offset:2048 nt lds
    v_max3_f32 v11, v11, v191, v207
    v_max_f32 v11, v11, v13
    s_add_u32 m0, s37, 48
    s_waitcnt lgkmcnt(8)
    v_mfma_f32_32x32x16_bf16 v[80:95], v[40:43], v[212:215], v[80:95]
    ds_read_b64_tr_b16 v[32:33], v2 offset:17408
    ds_read_b64_tr_b16 v[34:35], v2 offset:19488
    v_mov_b32 v12, v11
    s_nop 1
    v_permlane32_swap_b32 v11, v12
    buffer_load_dwordx4 v5, s[8:11], s41 offen offset:3072 nt lds
    v_max_f32 v10, v11, v12
    v_mfma_f32_32x32x16_bf16 v[96:111], v[44:47], v[212:215], v[96:111]
    v_sub_f32 v240, 0, v10
    s_add_u32 s41, s41, 16384
    s_and_b32 s41, s41, 0x7ffff
    v_sub_f32 v241, 0, v10
    v_sub_f32 v242, 0, v10
    s_add_u32 s40, s40, 1
    s_waitcnt lgkmcnt(6)
    v_mfma_f32_32x32x16_bf16 v[48:63], v[16:19], v[216:219], v[48:63]
    ds_read_b64_tr_b16 v[36:37], v2 offset:17472
    ds_read_b64_tr_b16 v[38:39], v2 offset:19552
    v_sub_f32 v243, 0, v10
    v_sub_f32 v244, 0, v10
    v_sub_f32 v245, 0, v10
    v_sub_f32 v246, 0, v10
    v_sub_f32 v247, 0, v10
    v_sub_f32 v248, 0, v10
    v_mfma_f32_32x32x16_bf16 v[64:79], v[20:23], v[216:219], v[64:79]
    ds_read_b64_tr_b16 v[40:41], v2 offset:17536
    ds_read_b64_tr_b16 v[42:43], v2 offset:19616
    v_sub_f32 v249, 0, v10
    v_sub_f32 v250, 0, v10
    v_sub_f32 v251, 0, v10
    v_sub_f32 v252, 0, v10
    v_sub_f32 v253, 0, v10
    v_sub_f32 v254, 0, v10
    s_waitcnt lgkmcnt(6)
    v_mfma_f32_32x32x16_bf16 v[80:95], v[24:27], v[216:219], v[80:95]
    ds_read_b64_tr_b16 v[44:45], v2 offset:17600
    ds_read_b64_tr_b16 v[46:47], v2 offset:19680
    v_sub_f32 v255, 0, v10
    v_sub_f32 v176, v176, v10
    v_sub_f32 v177, v177, v10
    v_sub_f32 v178, v178, v10
    v_sub_f32 v179, v179, v10
    v_sub_f32 v180, v180, v10
    v_mfma_f32_32x32x16_bf16 v[96:111], v[28:31], v[216:219], v[96:111]
    v_sub_f32 v181, v181, v10
    v_sub_f32 v182, v182, v10
    v_sub_f32 v183, v183, v10
    v_sub_f32 v184, v184, v10
    v_sub_f32 v185, v185, v10
    v_sub_f32 v186, v186, v10
    s_waitcnt lgkmcnt(4)
    v_mfma_f32_32x32x16_bf16 v[48:63], v[32:35], v[220:223], v[48:63]
    v_sub_f32 v187, v187, v10
    v_sub_f32 v188, v188, v10
    v_sub_f32 v189, v189, v10
    v_sub_f32 v190, v190, v10
    v_sub_f32 v191, v191, v10
    v_sub_f32 v192, v192, v10
    s_waitcnt lgkmcnt(0)
    s_waitcnt vmcnt(8)
    s_barrier
    ds_read_b128 v[16:19], v1 offset:16640
    ds_read_b128 v[20:23], v1 offset:16672
    ds_read_b128 v[24:27], v1 offset:16704
    v_mfma_f32_32x32x16_bf16 v[64:79], v[36:39], v[220:223], v[64:79]
    ds_read_b128 v[28:31], v1 offset:16736
    v_sub_f32 v193, v193, v10
    v_sub_f32 v194, v194, v10
    v_sub_f32 v195, v195, v10
    v_sub_f32 v196, v196, v10
    v_sub_f32 v197, v197, v10
    v_sub_f32 v198, v198, v10
    v_mfma_f32_32x32x16_bf16 v[80:95], v[40:43], v[220:223], v[80:95]
    ds_read_b128 v[32:35], v1 offset:16768
    v_sub_f32 v199, v199, v10
    v_sub_f32 v200, v200, v10
    v_sub_f32 v201, v201, v10
    v_sub_f32 v202, v202, v10
    v_sub_f32 v203, v203, v10
    v_sub_f32 v204, v204, v10
    v_mfma_f32_32x32x16_bf16 v[96:111], v[44:47], v[220:223], v[96:111]
    ds_read_b128 v[36:39], v1 offset:16800
    v_sub_f32 v205, v205, v10
    v_sub_f32 v206, v206, v10
    v_sub_f32 v207, v207, v10
    v_add_f32 v13, v7, v8
    v_mov_b32 v14, v13
    s_nop 1
    v_permlane32_swap_b32 v13, v14
    s_waitcnt lgkmcnt(4)
    v_mfma_f32_32x32x16_bf16 v[208:223], v[16:19], v[112:115], v[240:255]
    ds_read_b128 v[40:43], v1 offset:16832
    v_add_f32 v13, v13, v14
    v_rcp_f32 v15, v13
    s_nop 0
    v_mul_f32 v48, v15, v48
    v_mul_f32 v49, v15, v49
    v_mul_f32 v50, v15, v50
    v_mfma_f32_32x32x16_bf16 v[208:223], v[20:23], v[116:119], v[208:223]
    ds_read_b128 v[44:47], v1 offset:16864
    v_mul_f32 v51, v15, v51
    v_cvt_pk_bf16_f32 v144, v48, v49
    v_mul_f32 v52, v15, v52
    v_mul_f32 v53, v15, v53
    v_cvt_pk_bf16_f32 v145, v50, v51
    v_mul_f32 v54, v15, v54
    s_waitcnt lgkmcnt(4)
    v_mfma_f32_32x32x16_bf16 v[208:223], v[24:27], v[120:123], v[208:223]
    ds_read_b128 v[16:19], v1 offset:17152
    v_mul_f32 v55, v15, v55
    v_cvt_pk_bf16_f32 v146, v52, v53
    v_mul_f32 v56, v15, v56
    v_mul_f32 v57, v15, v57
    v_cvt_pk_bf16_f32 v147, v54, v55
    v_mul_f32 v58, v15, v58
    v_mfma_f32_32x32x16_bf16 v[208:223], v[28:31], v[124:127], v[208:223]
    ds_read_b128 v[20:23], v1 offset:17184
    v_mul_f32 v59, v15, v59
    v_cvt_pk_bf16_f32 v148, v56, v57
    v_mul_f32 v60, v15, v60
    v_mul_f32 v61, v15, v61
    v_cvt_pk_bf16_f32 v149, v58, v59
    v_mul_f32 v62, v15, v62
    s_waitcnt lgkmcnt(4)
    v_mfma_f32_32x32x16_bf16 v[208:223], v[32:35], v[128:131], v[208:223]
    ds_read_b128 v[24:27], v1 offset:17216
    v_mul_f32 v63, v15, v63
    v_cvt_pk_bf16_f32 v150, v60, v61
    v_mul_f32 v64, v15, v64
    v_mul_f32 v65, v15, v65
    v_cvt_pk_bf16_f32 v151, v62, v63
    v_mul_f32 v66, v15, v66
    v_mfma_f32_32x32x16_bf16 v[208:223], v[36:39], v[132:135], v[208:223]
    ds_read_b128 v[28:31], v1 offset:17248
    v_mul_f32 v67, v15, v67
    v_cvt_pk_bf16_f32 v152, v64, v65
    v_mul_f32 v68, v15, v68
    v_mul_f32 v69, v15, v69
    v_cvt_pk_bf16_f32 v153, v66, v67
    v_mul_f32 v70, v15, v70
    s_waitcnt lgkmcnt(4)
    v_mfma_f32_32x32x16_bf16 v[208:223], v[40:43], v[136:139], v[208:223]
    ds_read_b128 v[32:35], v1 offset:17280
    v_mul_f32 v71, v15, v71
    v_cvt_pk_bf16_f32 v154, v68, v69
    v_mul_f32 v72, v15, v72
    v_mul_f32 v73, v15, v73
    v_cvt_pk_bf16_f32 v155, v70, v71
    v_mul_f32 v74, v15, v74
    v_mfma_f32_32x32x16_bf16 v[208:223], v[44:47], v[140:143], v[208:223]
    ds_read_b128 v[36:39], v1 offset:17312
    v_mul_f32 v75, v15, v75
    v_cvt_pk_bf16_f32 v156, v72, v73
    v_mul_f32 v76, v15, v76
    v_mul_f32 v77, v15, v77
    v_cvt_pk_bf16_f32 v157, v74, v75
    v_mul_f32 v78, v15, v78
    s_waitcnt lgkmcnt(4)
    v_mfma_f32_32x32x16_bf16 v[224:239], v[16:19], v[112:115], v[240:255]
    ds_read_b128 v[40:43], v1 offset:17344
    v_mul_f32 v79, v15, v79
    v_cvt_pk_bf16_f32 v158, v76, v77
    v_mul_f32 v80, v15, v80
    v_mul_f32 v81, v15, v81
    v_cvt_pk_bf16_f32 v159, v78, v79
    v_mul_f32 v82, v15, v82
    v_mfma_f32_32x32x16_bf16 v[224:239], v[20:23], v[116:119], v[224:239]
    ds_read_b128 v[44:47], v1 offset:17376
    v_mul_f32 v83, v15, v83
    v_cvt_pk_bf16_f32 v160, v80, v81
    v_mul_f32 v84, v15, v84
    v_mul_f32 v85, v15, v85
    v_cvt_pk_bf16_f32 v161, v82, v83
    v_mul_f32 v86, v15, v86
    s_waitcnt lgkmcnt(4)
    v_mfma_f32_32x32x16_bf16 v[224:239], v[24:27], v[120:123], v[224:239]
    ds_read_b64_tr_b16 v[16:17], v3 offset:0
    ds_read_b64_tr_b16 v[18:19], v3 offset:2080
    v_mul_f32 v87, v15, v87
    v_cvt_pk_bf16_f32 v162, v84, v85
    v_mul_f32 v88, v15, v88
    v_mul_f32 v89, v15, v89
    v_cvt_pk_bf16_f32 v163, v86, v87
    v_mul_f32 v90, v15, v90
    v_mfma_f32_32x32x16_bf16 v[224:239], v[28:31], v[124:127], v[224:239]
    ds_read_b64_tr_b16 v[20:21], v3 offset:64
    ds_read_b64_tr_b16 v[22:23], v3 offset:2144
    v_mul_f32 v91, v15, v91
    v_cvt_pk_bf16_f32 v164, v88, v89
    v_mul_f32 v92, v15, v92
    v_mul_f32 v93, v15, v93
    v_cvt_pk_bf16_f32 v165, v90, v91
    v_mul_f32 v94, v15, v94
    s_waitcnt lgkmcnt(6)
    v_mfma_f32_32x32x16_bf16 v[224:239], v[32:35], v[128:131], v[224:239]
    ds_read_b64_tr_b16 v[24:25], v3 offset:128
    ds_read_b64_tr_b16 v[26:27], v3 offset:2208
    v_mul_f32 v95, v15, v95
    v_cvt_pk_bf16_f32 v166, v92, v93
    v_mul_f32 v96, v15, v96
    v_mul_f32 v97, v15, v97
    v_cvt_pk_bf16_f32 v167, v94, v95
    v_mul_f32 v98, v15, v98
    v_mfma_f32_32x32x16_bf16 v[224:239], v[36:39], v[132:135], v[224:239]
    ds_read_b64_tr_b16 v[28:29], v3 offset:192
    ds_read_b64_tr_b16 v[30:31], v3 offset:2272
    v_mul_f32 v99, v15, v99
    v_cvt_pk_bf16_f32 v168, v96, v97
    v_mul_f32 v100, v15, v100
    v_mul_f32 v101, v15, v101
    v_cvt_pk_bf16_f32 v169, v98, v99
    v_mul_f32 v102, v15, v102
    s_waitcnt lgkmcnt(8)
    v_mfma_f32_32x32x16_bf16 v[224:239], v[40:43], v[136:139], v[224:239]
    ds_read_b64_tr_b16 v[32:33], v3 offset:256
    ds_read_b64_tr_b16 v[34:35], v3 offset:2336
    v_mul_f32 v103, v15, v103
    v_cvt_pk_bf16_f32 v170, v100, v101
    v_mul_f32 v104, v15, v104
    v_mul_f32 v105, v15, v105
    v_cvt_pk_bf16_f32 v171, v102, v103
    v_mul_f32 v106, v15, v106
    v_mfma_f32_32x32x16_bf16 v[224:239], v[44:47], v[140:143], v[224:239]
    ds_read_b64_tr_b16 v[36:37], v3 offset:320
    ds_read_b64_tr_b16 v[38:39], v3 offset:2400
    v_mul_f32 v107, v15, v107
    v_cvt_pk_bf16_f32 v172, v104, v105
    v_mul_f32 v108, v15, v108
    v_mul_f32 v109, v15, v109
    v_cvt_pk_bf16_f32 v173, v106, v107
    v_mul_f32 v110, v15, v110
    s_waitcnt lgkmcnt(8)
    v_mfma_f32_32x32x16_bf16 a[0:15], v[16:19], v[144:147], a[0:15]
    ds_read_b64_tr_b16 v[40:41], v3 offset:384
    ds_read_b64_tr_b16 v[42:43], v3 offset:2464
    v_mul_f32 v111, v15, v111
    v_cvt_pk_bf16_f32 v174, v108, v109
    v_cvt_pk_bf16_f32 v175, v110, v111
    v_exp_f32 v176, v176
    v_mfma_f32_32x32x16_bf16 a[16:31], v[20:23], v[144:147], a[16:31]
    ds_read_b64_tr_b16 v[44:45], v3 offset:448
    ds_read_b64_tr_b16 v[46:47], v3 offset:2528
    v_exp_f32 v177, v177
    v_exp_f32 v178, v178
    s_waitcnt lgkmcnt(8)
    v_mfma_f32_32x32x16_bf16 a[32:47], v[24:27], v[144:147], a[32:47]
    ds_read_b64_tr_b16 v[16:17], v3 offset:512
    ds_read_b64_tr_b16 v[18:19], v3 offset:2592
    s_cmp_le_i32 s40, 30
    s_cselect_b32 s14, 0x80000, 0
    s_cselect_b32 s38, s36, s39
    v_mov_b32 v7, v176
    v_exp_f32 v179, v179
    v_mfma_f32_32x32x16_bf16 a[48:63], v[28:31], v[144:147], a[48:63]
    ds_read_b64_tr_b16 v[20:21], v3 offset:576
    ds_read_b64_tr_b16 v[22:23], v3 offset:2656
    v_mov_b32 v8, v177
    s_add_u32 m0, s38, 49920
    v_cvt_pk_bf16_f32 v176, v176, v177
    v_exp_f32 v180, v180
    v_add_f32 v7, v7, v178
    s_waitcnt lgkmcnt(8)
    v_mfma_f32_32x32x16_bf16 a[64:79], v[32:35], v[144:147], a[64:79]
    ds_read_b64_tr_b16 v[24:25], v3 offset:640
    ds_read_b64_tr_b16 v[26:27], v3 offset:2720
    buffer_load_dwordx4 v5, s[12:15], s42 offen nt lds
    v_exp_f32 v181, v181
    v_add_f32 v8, v8, v179
    v_mfma_f32_32x32x16_bf16 a[80:95], v[36:39], v[144:147], a[80:95]
    ds_read_b64_tr_b16 v[28:29], v3 offset:704
    ds_read_b64_tr_b16 v[30:31], v3 offset:2784
    v_cvt_pk_bf16_f32 v177, v178, v179
    s_add_u32 m0, s38, 49936
    v_exp_f32 v182, v182
    v_add_f32 v7, v7, v180
    s_waitcnt lgkmcnt(8)
    v_mfma_f32_32x32x16_bf16 a[96:111], v[40:43], v[144:147], a[96:111]
    ds_read_b64_tr_b16 v[32:33], v3 offset:768
    ds_read_b64_tr_b16 v[34:35], v3 offset:2848
    v_exp_f32 v183, v183
    buffer_load_dwordx4 v5, s[12:15], s42 offen offset:1024 nt lds
    v_add_f32 v8, v8, v181
    v_mfma_f32_32x32x16_bf16 a[112:127], v[44:47], v[144:147], a[112:127]
    v_cvt_pk_bf16_f32 v178, v180, v181
    v_exp_f32 v184, v184
    s_add_u32 m0, s38, 49952
    v_add_f32 v7, v7, v182
    s_waitcnt lgkmcnt(6)
    v_mfma_f32_32x32x16_bf16 a[128:143], v[16:19], v[144:147], a[128:143]
    ds_read_b64_tr_b16 v[36:37], v3 offset:832
    ds_read_b64_tr_b16 v[38:39], v3 offset:2912
    v_exp_f32 v185, v185
    v_add_f32 v8, v8, v183
    buffer_load_dwordx4 v5, s[12:15], s42 offen offset:2048 nt lds
    v_mfma_f32_32x32x16_bf16 a[144:159], v[20:23], v[144:147], a[144:159]
    ds_read_b64_tr_b16 v[40:41], v3 offset:896
    ds_read_b64_tr_b16 v[42:43], v3 offset:2976
    v_cvt_pk_bf16_f32 v179, v182, v183
    v_exp_f32 v186, v186
    v_add_f32 v7, v7, v184
    s_add_u32 m0, s38, 49968
    s_waitcnt lgkmcnt(6)
    v_mfma_f32_32x32x16_bf16 a[160:175], v[24:27], v[144:147], a[160:175]
    ds_read_b64_tr_b16 v[44:45], v3 offset:960
    ds_read_b64_tr_b16 v[46:47], v3 offset:3040
    v_exp_f32 v187, v187
    v_add_f32 v8, v8, v185
    v_cvt_pk_bf16_f32 v180, v184, v185
    v_mfma_f32_32x32x16_bf16 a[176:191], v[28:31], v[144:147], a[176:191]
    buffer_load_dwordx4 v5, s[12:15], s42 offen offset:3072 nt lds
    v_exp_f32 v188, v188
    v_add_f32 v7, v7, v186
    s_waitcnt lgkmcnt(4)
    v_mfma_f32_32x32x16_bf16 a[192:207], v[32:35], v[144:147], a[192:207]
    v_exp_f32 v189, v189
    s_add_u32 s42, s42, 16384
    s_and_b32 s42, s42, 0x7ffff
    v_add_f32 v8, v8, v187
    v_cvt_pk_bf16_f32 v181, v186, v187
    s_waitcnt lgkmcnt(0)
    s_waitcnt vmcnt(8)
    s_barrier
    ds_read_b64_tr_b16 v[16:17], v2 offset:0
    ds_read_b64_tr_b16 v[18:19], v2 offset:2080
    ds_read_b64_tr_b16 v[20:21], v2 offset:64
    ds_read_b64_tr_b16 v[22:23], v2 offset:2144
    ds_read_b64_tr_b16 v[24:25], v2 offset:128
    ds_read_b64_tr_b16 v[26:27], v2 offset:2208
    v_mfma_f32_32x32x16_bf16 a[208:223], v[36:39], v[144:147], a[208:223]
    ds_read_b64_tr_b16 v[28:29], v2 offset:192
    ds_read_b64_tr_b16 v[30:31], v2 offset:2272
    v_exp_f32 v190, v190
    v_add_f32 v7, v7, v188
    v_exp_f32 v191, v191
    v_add_f32 v8, v8, v189
    v_cvt_pk_bf16_f32 v182, v188, v189
    v_mfma_f32_32x32x16_bf16 a[224:239], v[40:43], v[144:147], a[224:239]
    ds_read_b64_tr_b16 v[32:33], v2 offset:256
    ds_read_b64_tr_b16 v[34:35], v2 offset:2336
    v_exp_f32 v192, v192
    v_add_f32 v7, v7, v190
    v_exp_f32 v193, v193
    v_add_f32 v8, v8, v191
    v_cvt_pk_bf16_f32 v183, v190, v191
    v_mfma_f32_32x32x16_bf16 a[240:255], v[44:47], v[144:147], a[240:255]
    ds_read_b64_tr_b16 v[36:37], v2 offset:320
    ds_read_b64_tr_b16 v[38:39], v2 offset:2400
    v_exp_f32 v194, v194
    v_add_f32 v7, v7, v192
    v_exp_f32 v195, v195
    v_add_f32 v8, v8, v193
    v_cvt_pk_bf16_f32 v184, v192, v193
    s_waitcnt lgkmcnt(8)
    v_mfma_f32_32x32x16_bf16 v[48:63], v[16:19], v[176:179], 0
    ds_read_b64_tr_b16 v[40:41], v2 offset:384
    ds_read_b64_tr_b16 v[42:43], v2 offset:2464
    v_exp_f32 v196, v196
    v_add_f32 v7, v7, v194
    v_exp_f32 v197, v197
    v_add_f32 v8, v8, v195
    v_cvt_pk_bf16_f32 v185, v194, v195
    v_mfma_f32_32x32x16_bf16 v[64:79], v[20:23], v[176:179], 0
    ds_read_b64_tr_b16 v[44:45], v2 offset:448
    ds_read_b64_tr_b16 v[46:47], v2 offset:2528
    v_exp_f32 v198, v198
    v_add_f32 v7, v7, v196
    v_exp_f32 v199, v199
    v_add_f32 v8, v8, v197
    v_cvt_pk_bf16_f32 v186, v196, v197
    s_waitcnt lgkmcnt(8)
    v_mfma_f32_32x32x16_bf16 v[80:95], v[24:27], v[176:179], 0
    ds_read_b64_tr_b16 v[16:17], v2 offset:512
    ds_read_b64_tr_b16 v[18:19], v2 offset:2592
    v_exp_f32 v200, v200
    v_add_f32 v7, v7, v198
    v_exp_f32 v201, v201
    v_add_f32 v8, v8, v199
    v_cvt_pk_bf16_f32 v187, v198, v199
    v_mfma_f32_32x32x16_bf16 v[96:111], v[28:31], v[176:179], 0
    ds_read_b64_tr_b16 v[20:21], v2 offset:576
    ds_read_b64_tr_b16 v[22:23], v2 offset:2656
    v_exp_f32 v202, v202
    v_add_f32 v7, v7, v200
    v_exp_f32 v203, v203
    v_add_f32 v8, v8, v201
    v_cvt_pk_bf16_f32 v188, v200, v201
    s_waitcnt lgkmcnt(8)
    v_mfma_f32_32x32x16_bf16 v[48:63], v[32:35], v[180:183], v[48:63]
    ds_read_b64_tr_b16 v[24:25], v2 offset:640
    ds_read_b64_tr_b16 v[26:27], v2 offset:2720
    v_exp_f32 v204, v204
    v_add_f32 v7, v7, v202
    v_exp_f32 v205, v205
    v_add_f32 v8, v8, v203
    v_mfma_f32_32x32x16_bf16 v[64:79], v[36:39], v[180:183], v[64:79]
    ds_read_b64_tr_b16 v[28:29], v2 offset:704
    ds_read_b64_tr_b16 v[30:31], v2 offset:2784
    v_cvt_pk_bf16_f32 v189, v202, v203
    v_exp_f32 v206, v206
    v_add_f32 v7, v7, v204
    v_exp_f32 v207, v207
    v_add_f32 v8, v8, v205
    s_waitcnt lgkmcnt(8)
    v_mfma_f32_32x32x16_bf16 v[80:95], v[40:43], v[180:183], v[80:95]
    ds_read_b64_tr_b16 v[32:33], v2 offset:768
    ds_read_b64_tr_b16 v[34:35], v2 offset:2848
    v_cvt_pk_bf16_f32 v190, v204, v205
    v_add_f32 v7, v7, v206
    v_add_f32 v8, v8, v207
    v_cvt_pk_bf16_f32 v191, v206, v207
    v_max3_f32 v11, v208, v209, v210
    v_max3_f32 v12, v216, v217, v218
    v_mfma_f32_32x32x16_bf16 v[96:111], v[44:47], v[180:183], v[96:111]
    s_cmp_le_i32 s40, 28
    s_cselect_b32 s10, 0x80000, 0
    s_cselect_b32 s37, s36, s39
    v_max3_f32 v13, v224, v225, v226
    v_max3_f32 v14, v232, v233, v234
    s_add_u32 m0, s37, 16640
    v_max3_f32 v11, v11, v211, v212
    s_waitcnt lgkmcnt(6)
    v_mfma_f32_32x32x16_bf16 v[48:63], v[16:19], v[184:187], v[48:63]
    ds_read_b64_tr_b16 v[36:37], v2 offset:832
    ds_read_b64_tr_b16 v[38:39], v2 offset:2912
    v_max3_f32 v12, v12, v219, v220
    buffer_load_dwordx4 v5, s[8:11], s41 offen nt lds
    v_max3_f32 v13, v13, v227, v228
    v_max3_f32 v14, v14, v235, v236
    v_mfma_f32_32x32x16_bf16 v[64:79], v[20:23], v[184:187], v[64:79]
    ds_read_b64_tr_b16 v[40:41], v2 offset:896
    ds_read_b64_tr_b16 v[42:43], v2 offset:2976
    s_add_u32 m0, s37, 16656
    v_max3_f32 v11, v11, v213, v214
    v_max3_f32 v12, v12, v221, v222
    buffer_load_dwordx4 v5, s[8:11], s41 offen offset:1024 nt lds
    v_max3_f32 v13, v13, v229, v230
    s_waitcnt lgkmcnt(6)
    v_mfma_f32_32x32x16_bf16 v[80:95], v[24:27], v[184:187], v[80:95]
    ds_read_b64_tr_b16 v[44:45], v2 offset:960
    ds_read_b64_tr_b16 v[46:47], v2 offset:3040
    v_max3_f32 v14, v14, v237, v238
    s_add_u32 m0, s37, 16672
    v_max3_f32 v11, v11, v215, v12
    v_max3_f32 v13, v13, v231, v14
    v_mfma_f32_32x32x16_bf16 v[96:111], v[28:31], v[184:187], v[96:111]
    buffer_load_dwordx4 v5, s[8:11], s41 offen offset:2048 nt lds
    v_max3_f32 v11, v11, v223, v239
    v_max_f32 v11, v11, v13
    s_add_u32 m0, s37, 16688
    v_mov_b32 v12, v11
    s_nop 1
    v_permlane32_swap_b32 v11, v12
    s_waitcnt lgkmcnt(4)
    v_mfma_f32_32x32x16_bf16 v[48:63], v[32:35], v[188:191], v[48:63]
    buffer_load_dwordx4 v5, s[8:11], s41 offen offset:3072 nt lds
    v_max_f32 v10, v11, v12
    s_add_u32 s41, s41, 16384
    s_and_b32 s41, s41, 0x7ffff
    s_add_u32 s40, s40, 1
    s_waitcnt lgkmcnt(0)
    s_waitcnt vmcnt(8)
    s_barrier
    ds_read_b64_tr_b16 v[16:17], v3 offset:16640
    ds_read_b64_tr_b16 v[18:19], v3 offset:18720
    ds_read_b64_tr_b16 v[20:21], v3 offset:16704
    ds_read_b64_tr_b16 v[22:23], v3 offset:18784
    ds_read_b64_tr_b16 v[24:25], v3 offset:16768
    ds_read_b64_tr_b16 v[26:27], v3 offset:18848
    v_mfma_f32_32x32x16_bf16 v[64:79], v[36:39], v[188:191], v[64:79]
    ds_read_b64_tr_b16 v[28:29], v3 offset:16832
    ds_read_b64_tr_b16 v[30:31], v3 offset:18912
    v_mfma_f32_32x32x16_bf16 v[80:95], v[40:43], v[188:191], v[80:95]
    ds_read_b64_tr_b16 v[32:33], v3 offset:16896
    ds_read_b64_tr_b16 v[34:35], v3 offset:18976
    v_mfma_f32_32x32x16_bf16 v[96:111], v[44:47], v[188:191], v[96:111]
    ds_read_b64_tr_b16 v[36:37], v3 offset:16960
    ds_read_b64_tr_b16 v[38:39], v3 offset:19040
    s_waitcnt lgkmcnt(8)
    v_mfma_f32_32x32x16_bf16 a[0:15], v[16:19], v[148:151], a[0:15]
    ds_read_b64_tr_b16 v[40:41], v3 offset:17024
    ds_read_b64_tr_b16 v[42:43], v3 offset:19104
    v_mfma_f32_32x32x16_bf16 a[16:31], v[20:23], v[148:151], a[16:31]
    ds_read_b64_tr_b16 v[44:45], v3 offset:17088
    ds_read_b64_tr_b16 v[46:47], v3 offset:19168
    v_cmp_lt_f32 vcc, s34, v10
    s_cbranch_vccnz L_rare_1
L_back_1:
    v_exp_f32 v208, v208
    s_waitcnt lgkmcnt(8)
    v_mfma_f32_32x32x16_bf16 a[32:47], v[24:27], v[148:151], a[32:47]
    ds_read_b64_tr_b16 v[16:17], v3 offset:17152
    ds_read_b64_tr_b16 v[18:19], v3 offset:19232
    v_exp_f32 v209, v209
    v_exp_f32 v210, v210
    v_mfma_f32_32x32x16_bf16 a[48:63], v[28:31], v[148:151], a[48:63]
    ds_read_b64_tr_b16 v[20:21], v3 offset:17216
    ds_read_b64_tr_b16 v[22:23], v3 offset:19296
    s_cmp_le_i32 s40, 30
    s_cselect_b32 s14, 0x80000, 0
    s_cselect_b32 s38, s36, s39
    v_add_f32 v7, v7, v208
    s_waitcnt lgkmcnt(8)
    v_mfma_f32_32x32x16_bf16 a[64:79], v[32:35], v[148:151], a[64:79]
    ds_read_b64_tr_b16 v[24:25], v3 offset:17280
    ds_read_b64_tr_b16 v[26:27], v3 offset:19360
    v_exp_f32 v211, v211
    v_add_f32 v8, v8, v209
    s_add_u32 m0, s38, 33280
    v_mfma_f32_32x32x16_bf16 a[80:95], v[36:39], v[148:151], a[80:95]
    ds_read_b64_tr_b16 v[28:29], v3 offset:17344
    ds_read_b64_tr_b16 v[30:31], v3 offset:19424
    v_cvt_pk_bf16_f32 v208, v208, v209
    v_exp_f32 v212, v212
    v_add_f32 v7, v7, v210
    s_waitcnt lgkmcnt(8)
    v_mfma_f32_32x32x16_bf16 a[96:111], v[40:43], v[148:151], a[96:111]
    ds_read_b64_tr_b16 v[32:33], v3 offset:17408
    ds_read_b64_tr_b16 v[34:35], v3 offset:19488
    buffer_load_dwordx4 v5, s[12:15], s42 offen nt lds
    v_mfma_f32_32x32x16_bf16 a[112:127], v[44:47], v[148:151], a[112:127]
    ds_read_b64_tr_b16 v[36:37], v3 offset:17472
    ds_read_b64_tr_b16 v[38:39], v3 offset:19552
    v_exp_f32 v213, v213
    v_add_f32 v8, v8, v211
    v_cvt_pk_bf16_f32 v209, v210, v211
    s_waitcnt lgkmcnt(8)
    v_mfma_f32_32x32x16_bf16 a[128:143], v[16:19], v[148:151], a[128:143]
    ds_read_b64_tr_b16 v[40:41], v3 offset:17536
    ds_read_b64_tr_b16 v[42:43], v3 offset:19616
    s_add_u32 m0, s38, 33296
    v_exp_f32 v214, v214
    v_add_f32 v7, v7, v212
    v_mfma_f32_32x32x16_bf16 a[144:159], v[20:23], v[148:151], a[144:159]
    ds_read_b64_tr_b16 v[44:45], v3 offset:17600
    ds_read_b64_tr_b16 v[46:47], v3 offset:19680
    v_exp_f32 v215, v215
    s_waitcnt lgkmcnt(8)
    v_mfma_f32_32x32x16_bf16 a[160:175], v[24:27], v[148:151], a[160:175]
    ds_read_b128 v[16:19], v1 offset:0
    buffer_load_dwordx4 v5, s[12:15], s42 offen offset:1024 nt lds
    v_add_f32 v8, v8, v213
    v_cvt_pk_bf16_f32 v210, v212, v213
    v_mfma_f32_32x32x16_bf16 a[176:191], v[28:31], v[148:151], a[176:191]
    ds_read_b128 v[20:23], v1 offset:32
    v_exp_f32 v216, v216
    s_add_u32 m0, s38, 33312
    v_add_f32 v7, v7, v214
    s_waitcnt lgkmcnt(6)
    v_mfma_f32_32x32x16_bf16 a[192:207], v[32:35], v[148:151], a[192:207]
    ds_read_b128 v[24:27], v1 offset:64
    v_exp_f32 v217, v217
    v_add_f32 v8, v8, v215
    v_mfma_f32_32x32x16_bf16 a[208:223], v[36:39], v[148:151], a[208:223]
    ds_read_b128 v[28:31], v1 offset:96
    buffer_load_dwordx4 v5, s[12:15], s42 offen offset:2048 nt lds
    v_cvt_pk_bf16_f32 v211, v214, v215
    s_waitcnt lgkmcnt(4)
    v_mfma_f32_32x32x16_bf16 a[224:239], v[40:43], v[148:151], a[224:239]
    ds_read_b128 v[32:35], v1 offset:128
    v_exp_f32 v218, v218
    v_add_f32 v7, v7, v216
    s_add_u32 m0, s38, 33328
    v_mfma_f32_32x32x16_bf16 a[240:255], v[44:47], v[148:151], a[240:255]
    ds_read_b128 v[36:39], v1 offset:160
    v_exp_f32 v219, v219
    v_add_f32 v8, v8, v217
    v_cvt_pk_bf16_f32 v212, v216, v217
    s_waitcnt lgkmcnt(4)
    v_mfma_f32_32x32x16_bf16 v[176:191], v[16:19], v[112:115], v[240:255]
    ds_read_b128 v[40:43], v1 offset:192
    buffer_load_dwordx4 v5, s[12:15], s42 offen offset:3072 nt lds
    v_exp_f32 v220, v220
    v_mfma_f32_32x32x16_bf16 v[176:191], v[20:23], v[116:119], v[176:191]
    ds_read_b128 v[44:47], v1 offset:224
    v_add_f32 v7, v7, v218
    v_exp_f32 v221, v221
    s_add_u32 s42, s42, 16384
    s_and_b32 s42, s42, 0x7ffff
    s_waitcnt lgkmcnt(4)
    v_mfma_f32_32x32x16_bf16 v[176:191], v[24:27], v[120:123], v[176:191]
    ds_read_b128 v[16:19], v1 offset:512
    v_add_f32 v8, v8, v219
    v_cvt_pk_bf16_f32 v213, v218, v219
    v_exp_f32 v222, v222
    v_add_f32 v7, v7, v220
    v_mfma_f32_32x32x16_bf16 v[176:191], v[28:31], v[124:127], v[176:191]
    ds_read_b128 v[20:23], v1 offset:544
    v_exp_f32 v223, v223
    v_add_f32 v8, v8, v221
    v_cvt_pk_bf16_f32 v214, v220, v221
    s_waitcnt lgkmcnt(4)
    v_mfma_f32_32x32x16_bf16 v[176:191], v[32:35], v[128:131], v[176:191]
    ds_read_b128 v[24:27], v1 offset:576
    v_exp_f32 v224, v224
    v_add_f32 v7, v7, v222
    v_exp_f32 v225, v225
    v_mfma_f32_32x32x16_bf16 v[176:191], v[36:39], v[132:135], v[176:191]
    ds_read_b128 v[28:31], v1 offset:608
    v_add_f32 v8, v8, v223
    v_cvt_pk_bf16_f32 v215, v222, v223
    v_exp_f32 v226, v226
    v_add_f32 v7, v7, v224
    s_waitcnt lgkmcnt(4)
    v_mfma_f32_32x32x16_bf16 v[176:191], v[40:43], v[136:139], v[176:191]
    ds_read_b128 v[32:35], v1 offset:640
    v_exp_f32 v227, v227
    v_add_f32 v8, v8, v225
    v_cvt_pk_bf16_f32 v216, v224, v225
    v_mfma_f32_32x32x16_bf16 v[176:191], v[44:47], v[140:143], v[176:191]
    v_exp_f32 v228, v228
    v_add_f32 v7, v7, v226
    v_exp_f32 v229, v229
    v_add_f32 v8, v8, v227
    s_waitcnt lgkmcnt(3)
    v_mfma_f32_32x32x16_bf16 v[192:207], v[16:19], v[112:115], v[240:255]
    ds_read_b128 v[36:39], v1 offset:672
    v_cvt_pk_bf16_f32 v217, v226, v227
    v_exp_f32 v230, v230
    v_add_f32 v7, v7, v228
    v_mfma_f32_32x32x16_bf16 v[192:207], v[20:23], v[116:119], v[192:207]
    ds_read_b128 v[40:43], v1 offset:704
    v_exp_f32 v231, v231
    v_add_f32 v8, v8, v229
    v_cvt_pk_bf16_f32 v218, v228, v229
    s_waitcnt lgkmcnt(3)
    v_mfma_f32_32x32x16_bf16 v[192:207], v[24:27], v[120:123], v[192:207]
    ds_read_b128 v[44:47], v1 offset:736
    v_exp_f32 v232, v232
    v_add_f32 v7, v7, v230
    v_exp_f32 v233, v233
    v_mfma_f32_32x32x16_bf16 v[192:207], v[28:31], v[124:127], v[192:207]
    v_add_f32 v8, v8, v231
    v_cvt_pk_bf16_f32 v219, v230, v231
    v_exp_f32 v234, v234
    v_add_f32 v7, v7, v232
    s_waitcnt lgkmcnt(2)
    v_mfma_f32_32x32x16_bf16 v[192:207], v[32:35], v[128:131], v[192:207]
    v_exp_f32 v235, v235
    v_add_f32 v8, v8, v233
    v_cvt_pk_bf16_f32 v220, v232, v233
    v_exp_f32 v236, v236
    s_waitcnt lgkmcnt(0)
    s_waitcnt vmcnt(8)
    s_barrier
    ds_read_b64_tr_b16 v[16:17], v2 offset:16640
    ds_read_b64_tr_b16 v[18:19], v2 offset:18720
    ds_read_b64_tr_b16 v[20:21], v2 offset:16704
    ds_read_b64_tr_b16 v[22:23], v2 offset:18784
    ds_read_b64_tr_b16 v[24:25], v2 offset:16768
    ds_read_b64_tr_b16 v[26:27], v2 offset:18848
    v_mfma_f32_32x32x16_bf16 v[192:207], v[36:39], v[132:135], v[192:207]
    ds_read_b64_tr_b16 v[28:29], v2 offset:16832
    ds_read_b64_tr_b16 v[30:31], v2 offset:18912
    v_add_f32 v7, v7, v234
    v_exp_f32 v237, v237
    v_add_f32 v8, v8, v235
    v_mfma_f32_32x32x16_bf16 v[192:207], v[40:43], v[136:139], v[192:207]
    ds_read_b64_tr_b16 v[32:33], v2 offset:16896
    ds_read_b64_tr_b16 v[34:35], v2 offset:18976
    v_cvt_pk_bf16_f32 v221, v234, v235
    v_exp_f32 v238, v238
    v_add_f32 v7, v7, v236
    v_mfma_f32_32x32x16_bf16 v[192:207], v[44:47], v[140:143], v[192:207]
    ds_read_b64_tr_b16 v[36:37], v2 offset:16960
    ds_read_b64_tr_b16 v[38:39], v2 offset:19040
    v_exp_f32 v239, v239
    v_add_f32 v8, v8, v237
    v_cvt_pk_bf16_f32 v222, v236, v237
    s_waitcnt lgkmcnt(8)
    v_mfma_f32_32x32x16_bf16 v[48:63], v[16:19], v[208:211], v[48:63]
    ds_read_b64_tr_b16 v[40:41], v2 offset:17024
    ds_read_b64_tr_b16 v[42:43], v2 offset:19104
    v_add_f32 v7, v7, v238
    v_add_f32 v8, v8, v239
    v_cvt_pk_bf16_f32 v223, v238, v239
    v_max3_f32 v11, v176, v177, v178
    v_mfma_f32_32x32x16_bf16 v[64:79], v[20:23], v[208:211], v[64:79]
    ds_read_b64_tr_b16 v[44:45], v2 offset:17088
    ds_read_b64_tr_b16 v[46:47], v2 offset:19168
    v_max3_f32 v12, v184, v185, v186
    s_cmp_le_i32 s40, 28
    s_cselect_b32 s10, 0x80000, 0
    s_cselect_b32 s37, s36, s39
    s_waitcnt lgkmcnt(8)
    v_mfma_f32_32x32x16_bf16 v[80:95], v[24:27], v[208:211], v[80:95]
    ds_read_b64_tr_b16 v[16:17], v2 offset:17152
    ds_read_b64_tr_b16 v[18:19], v2 offset:19232
    v_max3_f32 v13, v192, v193, v194
    v_max3_f32 v14, v200, v201, v202
    s_add_u32 m0, s37, 0
    v_max3_f32 v11, v11, v179, v180
    v_mfma_f32_32x32x16_bf16 v[96:111], v[28:31], v[208:211], v[96:111]
    ds_read_b64_tr_b16 v[20:21], v2 offset:17216
    ds_read_b64_tr_b16 v[22:23], v2 offset:19296
    v_max3_f32 v12, v12, v187, v188
    buffer_load_dwordx4 v5, s[8:11], s41 offen nt lds
    s_waitcnt lgkmcnt(8)
    v_mfma_f32_32x32x16_bf16 v[48:63], v[32:35], v[212:215], v[48:63]
    ds_read_b64_tr_b16 v[24:25], v2 offset:17280
    ds_read_b64_tr_b16 v[26:27], v2 offset:19360
    v_max3_f32 v13, v13, v195, v196
    v_max3_f32 v14, v14, v203, v204
    s_add_u32 m0, s37, 16
    v_max3_f32 v11, v11, v181, v182
    v_mfma_f32_32x32x16_bf16 v[64:79], v[36:39], v[212:215], v[64:79]
    ds_read_b64_tr_b16 v[28:29], v2 offset:17344
    ds_read_b64_tr_b16 v[30:31], v2 offset:19424
    v_max3_f32 v12, v12, v189, v190
    buffer_load_dwordx4 v5, s[8:11], s41 offen offset:1024 nt lds
    s_waitcnt lgkmcnt(8)
    v_mfma_f32_32x32x16_bf16 v[80:95], v[40:43], v[212:215], v[80:95]
    ds_read_b64_tr_b16 v[32:33], v2 offset:17408
    ds_read_b64_tr_b16 v[34:35], v2 offset:19488
    v_max3_f32 v13, v13, v197, v198
    v_max3_f32 v14, v14, v205, v206
    s_add_u32 m0, s37, 32
    v_max3_f32 v11, v11, v183, v12
    v_mfma_f32_32x32x16_bf16 v[96:111], v[44:47], v[212:215], v[96:111]
    v_max3_f32 v13, v13, v199, v14
    buffer_load_dwordx4 v5, s[8:11], s41 offen offset:2048 nt lds
    v_max3_f32 v11, v11, v191, v207
    v_max_f32 v11, v11, v13
    s_waitcnt lgkmcnt(6)
    v_mfma_f32_32x32x16_bf16 v[48:63], v[16:19], v[216:219], v[48:63]
    ds_read_b64_tr_b16 v[36:37], v2 offset:17472
    ds_read_b64_tr_b16 v[38:39], v2 offset:19552
    s_add_u32 m0, s37, 48
    v_mov_b32 v12, v11
    s_nop 1
    v_permlane32_swap_b32 v11, v12
    v_mfma_f32_32x32x16_bf16 v[64:79], v[20:23], v[216:219], v[64:79]
    ds_read_b64_tr_b16 v[40:41], v2 offset:17536
    ds_read_b64_tr_b16 v[42:43], v2 offset:19616
    buffer_load_dwordx4 v5, s[8:11], s41 offen offset:3072 nt lds
    v_max_f32 v10, v11, v12
    s_waitcnt lgkmcnt(6)
    v_mfma_f32_32x32x16_bf16 v[80:95], v[24:27], v[216:219], v[80:95]
    ds_read_b64_tr_b16 v[44:45], v2 offset:17600
    ds_read_b64_tr_b16 v[46:47], v2 offset:19680
    s_add_u32 s41, s41, 16384
    s_and_b32 s41, s41, 0x7ffff
    s_add_u32 s40, s40, 1
    v_mfma_f32_32x32x16_bf16 v[96:111], v[28:31], v[216:219], v[96:111]
    s_waitcnt lgkmcnt(4)
    v_mfma_f32_32x32x16_bf16 v[48:63], v[32:35], v[220:223], v[48:63]
    s_waitcnt lgkmcnt(0)
    s_waitcnt vmcnt(8)
    s_barrier
    ds_read_b64_tr_b16 v[16:17], v3 offset:0
    ds_read_b64_tr_b16 v[18:19], v3 offset:2080
    ds_read_b64_tr_b16 v[20:21], v3 offset:64
    ds_read_b64_tr_b16 v[22:23], v3 offset:2144
    ds_read_b64_tr_b16 v[24:25], v3 offset:128
    ds_read_b64_tr_b16 v[26:27], v3 offset:2208
    v_mfma_f32_32x32x16_bf16 v[64:79], v[36:39], v[220:223], v[64:79]
    ds_read_b64_tr_b16 v[28:29], v3 offset:192
    ds_read_b64_tr_b16 v[30:31], v3 offset:2272
    v_mfma_f32_32x32x16_bf16 v[80:95], v[40:43], v[220:223], v[80:95]
    ds_read_b64_tr_b16 v[32:33], v3 offset:256
    ds_read_b64_tr_b16 v[34:35], v3 offset:2336
    v_mfma_f32_32x32x16_bf16 v[96:111], v[44:47], v[220:223], v[96:111]
    ds_read_b64_tr_b16 v[36:37], v3 offset:320
    ds_read_b64_tr_b16 v[38:39], v3 offset:2400
    s_waitcnt lgkmcnt(8)
    v_mfma_f32_32x32x16_bf16 a[0:15], v[16:19], v[152:155], a[0:15]
    ds_read_b64_tr_b16 v[40:41], v3 offset:384
    ds_read_b64_tr_b16 v[42:43], v3 offset:2464
    v_mfma_f32_32x32x16_bf16 a[16:31], v[20:23], v[152:155], a[16:31]
    ds_read_b64_tr_b16 v[44:45], v3 offset:448
    ds_read_b64_tr_b16 v[46:47], v3 offset:2528
    v_cmp_lt_f32 vcc, s34, v10
    s_cbranch_vccnz L_rare_2
L_back_2:
    v_exp_f32 v176, v176
    s_waitcnt lgkmcnt(8)
    v_mfma_f32_32x32x16_bf16 a[32:47], v[24:27], v[152:155], a[32:47]
    ds_read_b64_tr_b16 v[16:17], v3 offset:512
    ds_read_b64_tr_b16 v[18:19], v3 offset:2592
    v_exp_f32 v177, v177
    v_exp_f32 v178, v178
    v_mfma_f32_32x32x16_bf16 a[48:63], v[28:31], v[152:155], a[48:63]
    ds_read_b64_tr_b16 v[20:21], v3 offset:576
    ds_read_b64_tr_b16 v[22:23], v3 offset:2656
    s_cmp_le_i32 s40, 30
    s_cselect_b32 s14, 0x80000, 0
    s_cselect_b32 s38, s36, s39
    v_add_f32 v7, v7, v176
    s_waitcnt lgkmcnt(8)
    v_mfma_f32_32x32x16_bf16 a[64:79], v[32:35], v[152:155], a[64:79]
    ds_read_b64_tr_b16 v[24:25], v3 offset:640
    ds_read_b64_tr_b16 v[26:27], v3 offset:2720
    v_exp_f32 v179, v179
    v_add_f32 v8, v8, v177
    s_add_u32 m0, s38, 49920
    v_mfma_f32_32x32x16_bf16 a[80:95], v[36:39], v[152:155], a[80:95]
    ds_read_b64_tr_b16 v[28:29], v3 offset:704
    ds_read_b64_tr_b16 v[30:31], v3 offset:2784
    v_cvt_pk_bf16_f32 v176, v176, v177
    v_exp_f32 v180, v180
    v_add_f32 v7, v7, v178
    s_waitcnt lgkmcnt(8)
    v_mfma_f32_32x32x16_bf16 a[96:111], v[40:43], v[152:155], a[96:111]
    ds_read_b64_tr_b16 v[32:33], v3 offset:768
    ds_read_b64_tr_b16 v[34:35], v3 offset:2848
    buffer_load_dwordx4 v5, s[12:15], s42 offen nt lds
    v_mfma_f32_32x32x16_bf16 a[112:127], v[44:47], v[152:155], a[112:127]
    ds_read_b64_tr_b16 v[36:37], v3 offset:832
    ds_read_b64_tr_b16 v[38:39], v3 offset:2912
    v_exp_f32 v181, v181
    v_add_f32 v8, v8, v179
    v_cvt_pk_bf16_f32 v177, v178, v179
    s_waitcnt lgkmcnt(8)
    v_mfma_f32_32x32x16_bf16 a[128:143], v[16:19], v[152:155], a[128:143]
    ds_read_b64_tr_b16 v[40:41], v3 offset:896
    ds_read_b64_tr_b16 v[42:43], v3 offset:2976
    s_add_u32 m0, s38, 49936
    v_exp_f32 v182, v182
    v_add_f32 v7, v7, v180
    v_mfma_f32_32x32x16_bf16 a[144:159], v[20:23], v[152:155], a[144:159]
    ds_read_b64_tr_b16 v[44:45], v3 offset:960
    ds_read_b64_tr_b16 v[46:47], v3 offset:3040
    v_exp_f32 v183, v183
    s_waitcnt lgkmcnt(8)
    v_mfma_f32_32x32x16_bf16 a[160:175], v[24:27], v[152:155], a[160:175]
    ds_read_b128 v[16:19], v1 offset:16640
    buffer_load_dwordx4 v5, s[12:15], s42 offen offset:1024 nt lds
    v_add_f32 v8, v8, v181
    v_cvt_pk_bf16_f32 v178, v180, v181
    v_mfma_f32_32x32x16_bf16 a[176:191], v[28:31], v[152:155], a[176:191]
    ds_read_b128 v[20:23], v1 offset:16672
    v_exp_f32 v184, v184
    s_add_u32 m0, s38, 49952
    v_add_f32 v7, v7, v182
    s_waitcnt lgkmcnt(6)
    v_mfma_f32_32x32x16_bf16 a[192:207], v[32:35], v[152:155], a[192:207]
    ds_read_b128 v[24:27], v1 offset:16704
    v_exp_f32 v185, v185
    v_add_f32 v8, v8, v183
    v_mfma_f32_32x32x16_bf16 a[208:223], v[36:39], v[152:155], a[208:223]
    ds_read_b128 v[28:31], v1 offset:16736
    buffer_load_dwordx4 v5, s[12:15], s42 offen offset:2048 nt lds
    v_cvt_pk_bf16_f32 v179, v182, v183
    s_waitcnt lgkmcnt(4)
    v_mfma_f32_32x32x16_bf16 a[224:239], v[40:43], v[152:155], a[224:239]
    ds_read_b128 v[32:35], v1 offset:16768
    v_exp_f32 v186, v186
    v_add_f32 v7, v7, v184
    s_add_u32 m0, s38, 49968
    v_mfma_f32_32x32x16_bf16 a[240:255], v[44:47], v[152:155], a[240:255]
    ds_read_b128 v[36:39], v1 offset:16800
    v_exp_f32 v187, v187
    v_add_f32 v8, v8, v185
    v_cvt_pk_bf16_f32 v180, v184, v185
    s_waitcnt lgkmcnt(4)
    v_mfma_f32_32x32x16_bf16 v[208:223], v[16:19], v[112:115], v[240:255]
    ds_read_b128 v[40:43], v1 offset:16832
    buffer_load_dwordx4 v5, s[12:15], s42 offen offset:3072 nt lds
    v_exp_f32 v188, v188
    v_mfma_f32_32x32x16_bf16 v[208:223], v[20:23], v[116:119], v[208:223]
    ds_read_b128 v[44:47], v1 offset:16864
    v_add_f32 v7, v7, v186
    v_exp_f32 v189, v189
    s_add_u32 s42, s42, 16384
    s_and_b32 s42, s42, 0x7ffff
    s_waitcnt lgkmcnt(4)
    v_mfma_f32_32x32x16_bf16 v[208:223], v[24:27], v[120:123], v[208:223]
    ds_read_b128 v[16:19], v1 offset:17152
    v_add_f32 v8, v8, v187
    v_cvt_pk_bf16_f32 v181, v186, v187
    v_exp_f32 v190, v190
    v_add_f32 v7, v7, v188
    v_mfma_f32_32x32x16_bf16 v[208:223], v[28:31], v[124:127], v[208:223]
    ds_read_b128 v[20:23], v1 offset:17184
    v_exp_f32 v191, v191
    v_add_f32 v8, v8, v189
    v_cvt_pk_bf16_f32 v182, v188, v189
    s_waitcnt lgkmcnt(4)
    v_mfma_f32_32x32x16_bf16 v[208:223], v[32:35], v[128:131], v[208:223]
    ds_read_b128 v[24:27], v1 offset:17216
    v_exp_f32 v192, v192
    v_add_f32 v7, v7, v190
    v_exp_f32 v193, v193
    v_mfma_f32_32x32x16_bf16 v[208:223], v[36:39], v[132:135], v[208:223]
    ds_read_b128 v[28:31], v1 offset:17248
    v_add_f32 v8, v8, v191
    v_cvt_pk_bf16_f32 v183, v190, v191
    v_exp_f32 v194, v194
    v_add_f32 v7, v7, v192
    s_waitcnt lgkmcnt(4)
    v_mfma_f32_32x32x16_bf16 v[208:223], v[40:43], v[136:139], v[208:223]
    ds_read_b128 v[32:35], v1 offset:17280
    v_exp_f32 v195, v195
    v_add_f32 v8, v8, v193
    v_cvt_pk_bf16_f32 v184, v192, v193
    v_mfma_f32_32x32x16_bf16 v[208:223], v[44:47], v[140:143], v[208:223]
    v_exp_f32 v196, v196
    v_add_f32 v7, v7, v194
    v_exp_f32 v197, v197
    v_add_f32 v8, v8, v195
    s_waitcnt lgkmcnt(3)
    v_mfma_f32_32x32x16_bf16 v[224:239], v[16:19], v[112:115], v[240:255]
    ds_read_b128 v[36:39], v1 offset:17312
    v_cvt_pk_bf16_f32 v185, v194, v195
    v_exp_f32 v198, v198
    v_add_f32 v7, v7, v196
    v_mfma_f32_32x32x16_bf16 v[224:239], v[20:23], v[116:119], v[224:239]
    ds_read_b128 v[40:43], v1 offset:17344
    v_exp_f32 v199, v199
    v_add_f32 v8, v8, v197
    v_cvt_pk_bf16_f32 v186, v196, v197
    s_waitcnt lgkmcnt(3)
    v_mfma_f32_32x32x16_bf16 v[224:239], v[24:27], v[120:123], v[224:239]
    ds_read_b128 v[44:47], v1 offset:17376
    v_exp_f32 v200, v200
    v_add_f32 v7, v7, v198
    v_exp_f32 v201, v201
    v_mfma_f32_32x32x16_bf16 v[224:239], v[28:31], v[124:127], v[224:239]
    v_add_f32 v8, v8, v199
    v_cvt_pk_bf16_f32 v187, v198, v199
    v_exp_f32 v202, v202
    v_add_f32 v7, v7, v200
    s_waitcnt lgkmcnt(2)
    v_mfma_f32_32x32x16_bf16 v[224:239], v[32:35], v[128:131], v[224:239]
    v_exp_f32 v203, v203
    v_add_f32 v8, v8, v201
    v_cvt_pk_bf16_f32 v188, v200, v201
    v_exp_f32 v204, v204
    s_waitcnt lgkmcnt(0)
    s_waitcnt vmcnt(8)
    s_barrier
    ds_read_b64_tr_b16 v[16:17], v2 offset:0
    ds_read_b64_tr_b16 v[18:19], v2 offset:2080
    ds_read_b64_tr_b16 v[20:21], v2 offset:64
    ds_read_b64_tr_b16 v[22:23], v2 offset:2144
    ds_read_b64_tr_b16 v[24:25], v2 offset:128
    ds_read_b64_tr_b16 v[26:27], v2 offset:2208
    v_mfma_f32_32x32x16_bf16 v[224:239], v[36:39], v[132:135], v[224:239]
    ds_read_b64_tr_b16 v[28:29], v2 offset:192
    ds_read_b64_tr_b16 v[30:31], v2 offset:2272
    v_add_f32 v7, v7, v202
    v_exp_f32 v205, v205
    v_add_f32 v8, v8, v203
    v_mfma_f32_32x32x16_bf16 v[224:239], v[40:43], v[136:139], v[224:239]
    ds_read_b64_tr_b16 v[32:33], v2 offset:256
    ds_read_b64_tr_b16 v[34:35], v2 offset:2336
    v_cvt_pk_bf16_f32 v189, v202, v203
    v_exp_f32 v206, v206
    v_add_f32 v7, v7, v204
    v_mfma_f32_32x32x16_bf16 v[224:239], v[44:47], v[140:143], v[224:239]
    ds_read_b64_tr_b16 v[36:37], v2 offset:320
    ds_read_b64_tr_b16 v[38:39], v2 offset:2400
    v_exp_f32 v207, v207
    v_add_f32 v8, v8, v205
    v_cvt_pk_bf16_f32 v190, v204, v205
    s_waitcnt lgkmcnt(8)
    v_mfma_f32_32x32x16_bf16 v[48:63], v[16:19], v[176:179], v[48:63]
    ds_read_b64_tr_b16 v[40:41], v2 offset:384
    ds_read_b64_tr_b16 v[42:43], v2 offset:2464
    v_add_f32 v7, v7, v206
    v_add_f32 v8, v8, v207
    v_cvt_pk_bf16_f32 v191, v206, v207
    v_max3_f32 v11, v208, v209, v210
    v_mfma_f32_32x32x16_bf16 v[64:79], v[20:23], v[176:179], v[64:79]
    ds_read_b64_tr_b16 v[44:45], v2 offset:448
    ds_read_b64_tr_b16 v[46:47], v2 offset:2528
    v_max3_f32 v12, v216, v217, v218
    s_cmp_le_i32 s40, 28
    s_cselect_b32 s10, 0x80000, 0
    s_cselect_b32 s37, s36, s39
    s_waitcnt lgkmcnt(8)
    v_mfma_f32_32x32x16_bf16 v[80:95], v[24:27], v[176:179], v[80:95]
    ds_read_b64_tr_b16 v[16:17], v2 offset:512
    ds_read_b64_tr_b16 v[18:19], v2 offset:2592
    v_max3_f32 v13, v224, v225, v226
    v_max3_f32 v14, v232, v233, v234
    s_add_u32 m0, s37, 16640
    v_max3_f32 v11, v11, v211, v212
    v_mfma_f32_32x32x16_bf16 v[96:111], v[28:31], v[176:179], v[96:111]
    ds_read_b64_tr_b16 v[20:21], v2 offset:576
    ds_read_b64_tr_b16 v[22:23], v2 offset:2656
    v_max3_f32 v12, v12, v219, v220
    buffer_load_dwordx4 v5, s[8:11], s41 offen nt lds
    s_waitcnt lgkmcnt(8)
    v_mfma_f32_32x32x16_bf16 v[48:63], v[32:35], v[180:183], v[48:63]
    ds_read_b64_tr_b16 v[24:25], v2 offset:640
    ds_read_b64_tr_b16 v[26:27], v2 offset:2720
    v_max3_f32 v13, v13, v227, v228
    v_max3_f32 v14, v14, v235, v236
    s_add_u32 m0, s37, 16656
    v_max3_f32 v11, v11, v213, v214
    v_mfma_f32_32x32x16_bf16 v[64:79], v[36:39], v[180:183], v[64:79]
    ds_read_b64_tr_b16 v[28:29], v2 offset:704
    ds_read_b64_tr_b16 v[30:31], v2 offset:2784
    v_max3_f32 v12, v12, v221, v222
    buffer_load_dwordx4 v5, s[8:11], s41 offen offset:1024 nt lds
    s_waitcnt lgkmcnt(8)
    v_mfma_f32_32x32x16_bf16 v[80:95], v[40:43], v[180:183], v[80:95]
    ds_read_b64_tr_b16 v[32:33], v2 offset:768
    ds_read_b64_tr_b16 v[34:35], v2 offset:2848
    v_max3_f32 v13, v13, v229, v230
    v_max3_f32 v14, v14, v237, v238
    s_add_u32 m0, s37, 16672
    v_max3_f32 v11, v11, v215, v12
    v_mfma_f32_32x32x16_bf16 v[96:111], v[44:47], v[180:183], v[96:111]
    v_max3_f32 v13, v13, v231, v14
    buffer_load_dwordx4 v5, s[8:11], s41 offen offset:2048 nt lds
    v_max3_f32 v11, v11, v223, v239
    v_max_f32 v11, v11, v13
    s_waitcnt lgkmcnt(6)
    v_mfma_f32_32x32x16_bf16 v[48:63], v[16:19], v[184:187], v[48:63]
    ds_read_b64_tr_b16 v[36:37], v2 offset:832
    ds_read_b64_tr_b16 v[38:39], v2 offset:2912
    s_add_u32 m0, s37, 16688
    v_mov_b32 v12, v11
    s_nop 1
    v_permlane32_swap_b32 v11, v12
    v_mfma_f32_32x32x16_bf16 v[64:79], v[20:23], v[184:187], v[64:79]
    ds_read_b64_tr_b16 v[40:41], v2 offset:896
    ds_read_b64_tr_b16 v[42:43], v2 offset:2976
    buffer_load_dwordx4 v5, s[8:11], s41 offen offset:3072 nt lds
    v_max_f32 v10, v11, v12
    s_waitcnt lgkmcnt(6)
    v_mfma_f32_32x32x16_bf16 v[80:95], v[24:27], v[184:187], v[80:95]
    ds_read_b64_tr_b16 v[44:45], v2 offset:960
    ds_read_b64_tr_b16 v[46:47], v2 offset:3040
    s_add_u32 s41, s41, 16384
    s_and_b32 s41, s41, 0x7ffff
    s_add_u32 s40, s40, 1
    v_mfma_f32_32x32x16_bf16 v[96:111], v[28:31], v[184:187], v[96:111]
    s_waitcnt lgkmcnt(4)
    v_mfma_f32_32x32x16_bf16 v[48:63], v[32:35], v[188:191], v[48:63]
    s_waitcnt lgkmcnt(0)
    s_waitcnt vmcnt(8)
    s_barrier
    ds_read_b64_tr_b16 v[16:17], v3 offset:16640
    ds_read_b64_tr_b16 v[18:19], v3 offset:18720
    ds_read_b64_tr_b16 v[20:21], v3 offset:16704
    ds_read_b64_tr_b16 v[22:23], v3 offset:18784
    ds_read_b64_tr_b16 v[24:25], v3 offset:16768
    ds_read_b64_tr_b16 v[26:27], v3 offset:18848
    v_mfma_f32_32x32x16_bf16 v[64:79], v[36:39], v[188:191], v[64:79]
    ds_read_b64_tr_b16 v[28:29], v3 offset:16832
    ds_read_b64_tr_b16 v[30:31], v3 offset:18912
    v_mfma_f32_32x32x16_bf16 v[80:95], v[40:43], v[188:191], v[80:95]
    ds_read_b64_tr_b16 v[32:33], v3 offset:16896
    ds_read_b64_tr_b16 v[34:35], v3 offset:18976
    v_mfma_f32_32x32x16_bf16 v[96:111], v[44:47], v[188:191], v[96:111]
    ds_read_b64_tr_b16 v[36:37], v3 offset:16960
    ds_read_b64_tr_b16 v[38:39], v3 offset:19040
    s_waitcnt lgkmcnt(8)
    v_mfma_f32_32x32x16_bf16 a[0:15], v[16:19], v[156:159], a[0:15]
    ds_read_b64_tr_b16 v[40:41], v3 offset:17024
    ds_read_b64_tr_b16 v[42:43], v3 offset:19104
    v_mfma_f32_32x32x16_bf16 a[16:31], v[20:23], v[156:159], a[16:31]
    ds_read_b64_tr_b16 v[44:45], v3 offset:17088
    ds_read_b64_tr_b16 v[46:47], v3 offset:19168
    v_cmp_lt_f32 vcc, s34, v10
    s_cbranch_vccnz L_rare_3
L_back_3:
    v_exp_f32 v208, v208
    s_waitcnt lgkmcnt(8)
    v_mfma_f32_32x32x16_bf16 a[32:47], v[24:27], v[156:159], a[32:47]
    ds_read_b64_tr_b16 v[16:17], v3 offset:17152
    ds_read_b64_tr_b16 v[18:19], v3 offset:19232
    v_exp_f32 v209, v209
    v_exp_f32 v210, v210
    v_mfma_f32_32x32x16_bf16 a[48:63], v[28:31], v[156:159], a[48:63]
    ds_read_b64_tr_b16 v[20:21], v3 offset:17216
    ds_read_b64_tr_b16 v[22:23], v3 offset:19296
    s_cmp_le_i32 s40, 30
    s_cselect_b32 s14, 0x80000, 0
    s_cselect_b32 s38, s36, s39
    v_add_f32 v7, v7, v208
    s_waitcnt lgkmcnt(8)
    v_mfma_f32_32x32x16_bf16 a[64:79], v[32:35], v[156:159], a[64:79]
    ds_read_b64_tr_b16 v[24:25], v3 offset:17280
    ds_read_b64_tr_b16 v[26:27], v3 offset:19360
    v_exp_f32 v211, v211
    v_add_f32 v8, v8, v209
    s_add_u32 m0, s38, 33280
    v_mfma_f32_32x32x16_bf16 a[80:95], v[36:39], v[156:159], a[80:95]
    ds_read_b64_tr_b16 v[28:29], v3 offset:17344
    ds_read_b64_tr_b16 v[30:31], v3 offset:19424
    v_cvt_pk_bf16_f32 v208, v208, v209
    v_exp_f32 v212, v212
    v_add_f32 v7, v7, v210
    s_waitcnt lgkmcnt(8)
    v_mfma_f32_32x32x16_bf16 a[96:111], v[40:43], v[156:159], a[96:111]
    ds_read_b64_tr_b16 v[32:33], v3 offset:17408
    ds_read_b64_tr_b16 v[34:35], v3 offset:19488
    buffer_load_dwordx4 v5, s[12:15], s42 offen nt lds
    v_mfma_f32_32x32x16_bf16 a[112:127], v[44:47], v[156:159], a[112:127]
    ds_read_b64_tr_b16 v[36:37], v3 offset:17472
    ds_read_b64_tr_b16 v[38:39], v3 offset:19552
    v_exp_f32 v213, v213
    v_add_f32 v8, v8, v211
    v_cvt_pk_bf16_f32 v209, v210, v211
    s_waitcnt lgkmcnt(8)
    v_mfma_f32_32x32x16_bf16 a[128:143], v[16:19], v[156:159], a[128:143]
    ds_read_b64_tr_b16 v[40:41], v3 offset:17536
    ds_read_b64_tr_b16 v[42:43], v3 offset:19616
    s_add_u32 m0, s38, 33296
    v_exp_f32 v214, v214
    v_add_f32 v7, v7, v212
    v_mfma_f32_32x32x16_bf16 a[144:159], v[20:23], v[156:159], a[144:159]
    ds_read_b64_tr_b16 v[44:45], v3 offset:17600
    ds_read_b64_tr_b16 v[46:47], v3 offset:19680
    v_exp_f32 v215, v215
    s_waitcnt lgkmcnt(8)
    v_mfma_f32_32x32x16_bf16 a[160:175], v[24:27], v[156:159], a[160:175]
    ds_read_b128 v[16:19], v1 offset:0
    buffer_load_dwordx4 v5, s[12:15], s42 offen offset:1024 nt lds
    v_add_f32 v8, v8, v213
    v_cvt_pk_bf16_f32 v210, v212, v213
    v_mfma_f32_32x32x16_bf16 a[176:191], v[28:31], v[156:159], a[176:191]
    ds_read_b128 v[20:23], v1 offset:32
    v_exp_f32 v216, v216
    s_add_u32 m0, s38, 33312
    v_add_f32 v7, v7, v214
    s_waitcnt lgkmcnt(6)
    v_mfma_f32_32x32x16_bf16 a[192:207], v[32:35], v[156:159], a[192:207]
    ds_read_b128 v[24:27], v1 offset:64
    v_exp_f32 v217, v217
    v_add_f32 v8, v8, v215
    v_mfma_f32_32x32x16_bf16 a[208:223], v[36:39], v[156:159], a[208:223]
    ds_read_b128 v[28:31], v1 offset:96
    buffer_load_dwordx4 v5, s[12:15], s42 offen offset:2048 nt lds
    v_cvt_pk_bf16_f32 v211, v214, v215
    s_waitcnt lgkmcnt(4)
    v_mfma_f32_32x32x16_bf16 a[224:239], v[40:43], v[156:159], a[224:239]
    ds_read_b128 v[32:35], v1 offset:128
    v_exp_f32 v218, v218
    v_add_f32 v7, v7, v216
    s_add_u32 m0, s38, 33328
    v_mfma_f32_32x32x16_bf16 a[240:255], v[44:47], v[156:159], a[240:255]
    ds_read_b128 v[36:39], v1 offset:160
    v_exp_f32 v219, v219
    v_add_f32 v8, v8, v217
    v_cvt_pk_bf16_f32 v212, v216, v217
    s_waitcnt lgkmcnt(4)
    v_mfma_f32_32x32x16_bf16 v[176:191], v[16:19], v[112:115], v[240:255]
    ds_read_b128 v[40:43], v1 offset:192
    buffer_load_dwordx4 v5, s[12:15], s42 offen offset:3072 nt lds
    v_exp_f32 v220, v220
    v_mfma_f32_32x32x16_bf16 v[176:191], v[20:23], v[116:119], v[176:191]
    ds_read_b128 v[44:47], v1 offset:224
    v_add_f32 v7, v7, v218
    v_exp_f32 v221, v221
    s_add_u32 s42, s42, 16384
    s_and_b32 s42, s42, 0x7ffff
    s_waitcnt lgkmcnt(4)
    v_mfma_f32_32x32x16_bf16 v[176:191], v[24:27], v[120:123], v[176:191]
    ds_read_b128 v[16:19], v1 offset:512
    v_add_f32 v8, v8, v219
    v_cvt_pk_bf16_f32 v213, v218, v219
    v_exp_f32 v222, v222
    v_add_f32 v7, v7, v220
    v_mfma_f32_32x32x16_bf16 v[176:191], v[28:31], v[124:127], v[176:191]
    ds_read_b128 v[20:23], v1 offset:544
    v_exp_f32 v223, v223
    v_add_f32 v8, v8, v221
    v_cvt_pk_bf16_f32 v214, v220, v221
    s_waitcnt lgkmcnt(4)
    v_mfma_f32_32x32x16_bf16 v[176:191], v[32:35], v[128:131], v[176:191]
    ds_read_b128 v[24:27], v1 offset:576
    v_exp_f32 v224, v224
    v_add_f32 v7, v7, v222
    v_exp_f32 v225, v225
    v_mfma_f32_32x32x16_bf16 v[176:191], v[36:39], v[132:135], v[176:191]
    ds_read_b128 v[28:31], v1 offset:608
    v_add_f32 v8, v8, v223
    v_cvt_pk_bf16_f32 v215, v222, v223
    v_exp_f32 v226, v226
    v_add_f32 v7, v7, v224
    s_waitcnt lgkmcnt(4)
    v_mfma_f32_32x32x16_bf16 v[176:191], v[40:43], v[136:139], v[176:191]
    ds_read_b128 v[32:35], v1 offset:640
    v_exp_f32 v227, v227
    v_add_f32 v8, v8, v225
    v_cvt_pk_bf16_f32 v216, v224, v225
    v_mfma_f32_32x32x16_bf16 v[176:191], v[44:47], v[140:143], v[176:191]
    v_exp_f32 v228, v228
    v_add_f32 v7, v7, v226
    v_exp_f32 v229, v229
    v_add_f32 v8, v8, v227
    s_waitcnt lgkmcnt(3)
    v_mfma_f32_32x32x16_bf16 v[192:207], v[16:19], v[112:115], v[240:255]
    ds_read_b128 v[36:39], v1 offset:672
    v_cvt_pk_bf16_f32 v217, v226, v227
    v_exp_f32 v230, v230
    v_add_f32 v7, v7, v228
    v_mfma_f32_32x32x16_bf16 v[192:207], v[20:23], v[116:119], v[192:207]
    ds_read_b128 v[40:43], v1 offset:704
    v_exp_f32 v231, v231
    v_add_f32 v8, v8, v229
    v_cvt_pk_bf16_f32 v218, v228, v229
    s_waitcnt lgkmcnt(3)
    v_mfma_f32_32x32x16_bf16 v[192:207], v[24:27], v[120:123], v[192:207]
    ds_read_b128 v[44:47], v1 offset:736
    v_exp_f32 v232, v232
    v_add_f32 v7, v7, v230
    v_exp_f32 v233, v233
    v_mfma_f32_32x32x16_bf16 v[192:207], v[28:31], v[124:127], v[192:207]
    v_add_f32 v8, v8, v231
    v_cvt_pk_bf16_f32 v219, v230, v231
    v_exp_f32 v234, v234
    v_add_f32 v7, v7, v232
    s_waitcnt lgkmcnt(2)
    v_mfma_f32_32x32x16_bf16 v[192:207], v[32:35], v[128:131], v[192:207]
    v_exp_f32 v235, v235
    v_add_f32 v8, v8, v233
    v_cvt_pk_bf16_f32 v220, v232, v233
    v_exp_f32 v236, v236
    s_waitcnt lgkmcnt(0)
    s_waitcnt vmcnt(8)
    s_barrier
    ds_read_b64_tr_b16 v[16:17], v2 offset:16640
    ds_read_b64_tr_b16 v[18:19], v2 offset:18720
    ds_read_b64_tr_b16 v[20:21], v2 offset:16704
    ds_read_b64_tr_b16 v[22:23], v2 offset:18784
    ds_read_b64_tr_b16 v[24:25], v2 offset:16768
    ds_read_b64_tr_b16 v[26:27], v2 offset:18848
    v_mfma_f32_32x32x16_bf16 v[192:207], v[36:39], v[132:135], v[192:207]
    ds_read_b64_tr_b16 v[28:29], v2 offset:16832
    ds_read_b64_tr_b16 v[30:31], v2 offset:18912
    v_add_f32 v7, v7, v234
    v_exp_f32 v237, v237
    v_add_f32 v8, v8, v235
    v_mfma_f32_32x32x16_bf16 v[192:207], v[40:43], v[136:139], v[192:207]
    ds_read_b64_tr_b16 v[32:33], v2 offset:16896
    ds_read_b64_tr_b16 v[34:35], v2 offset:18976
    v_cvt_pk_bf16_f32 v221, v234, v235
    v_exp_f32 v238, v238
    v_add_f32 v7, v7, v236
    v_mfma_f32_32x32x16_bf16 v[192:207], v[44:47], v[140:143], v[192:207]
    ds_read_b64_tr_b16 v[36:37], v2 offset:16960
    ds_read_b64_tr_b16 v[38:39], v2 offset:19040
    v_exp_f32 v239, v239
    v_add_f32 v8, v8, v237
    v_cvt_pk_bf16_f32 v222, v236, v237
    s_waitcnt lgkmcnt(8)
    v_mfma_f32_32x32x16_bf16 v[48:63], v[16:19], v[208:211], v[48:63]
    ds_read_b64_tr_b16 v[40:41], v2 offset:17024
    ds_read_b64_tr_b16 v[42:43], v2 offset:19104
    v_add_f32 v7, v7, v238
    v_add_f32 v8, v8, v239
    v_cvt_pk_bf16_f32 v223, v238, v239
    v_max3_f32 v11, v176, v177, v178
    v_mfma_f32_32x32x16_bf16 v[64:79], v[20:23], v[208:211], v[64:79]
    ds_read_b64_tr_b16 v[44:45], v2 offset:17088
    ds_read_b64_tr_b16 v[46:47], v2 offset:19168
    v_max3_f32 v12, v184, v185, v186
    s_cmp_le_i32 s40, 28
    s_cselect_b32 s10, 0x80000, 0
    s_cselect_b32 s37, s36, s39
    s_waitcnt lgkmcnt(8)
    v_mfma_f32_32x32x16_bf16 v[80:95], v[24:27], v[208:211], v[80:95]
    ds_read_b64_tr_b16 v[16:17], v2 offset:17152
    ds_read_b64_tr_b16 v[18:19], v2 offset:19232
    v_max3_f32 v13, v192, v193, v194
    v_max3_f32 v14, v200, v201, v202
    s_add_u32 m0, s37, 0
    v_max3_f32 v11, v11, v179, v180
    v_mfma_f32_32x32x16_bf16 v[96:111], v[28:31], v[208:211], v[96:111]
    ds_read_b64_tr_b16 v[20:21], v2 offset:17216
    ds_read_b64_tr_b16 v[22:23], v2 offset:19296
    v_max3_f32 v12, v12, v187, v188
    buffer_load_dwordx4 v5, s[8:11], s41 offen nt lds
    s_waitcnt lgkmcnt(8)
    v_mfma_f32_32x32x16_bf16 v[48:63], v[32:35], v[212:215], v[48:63]
    ds_read_b64_tr_b16 v[24:25], v2 offset:17280
    ds_read_b64_tr_b16 v[26:27], v2 offset:19360
    v_max3_f32 v13, v13, v195, v196
    v_max3_f32 v14, v14, v203, v204
    s_add_u32 m0, s37, 16
    v_max3_f32 v11, v11, v181, v182
    v_mfma_f32_32x32x16_bf16 v[64:79], v[36:39], v[212:215], v[64:79]
    ds_read_b64_tr_b16 v[28:29], v2 offset:17344
    ds_read_b64_tr_b16 v[30:31], v2 offset:19424
    v_max3_f32 v12, v12, v189, v190
    buffer_load_dwordx4 v5, s[8:11], s41 offen offset:1024 nt lds
    s_waitcnt lgkmcnt(8)
    v_mfma_f32_32x32x16_bf16 v[80:95], v[40:43], v[212:215], v[80:95]
    ds_read_b64_tr_b16 v[32:33], v2 offset:17408
    ds_read_b64_tr_b16 v[34:35], v2 offset:19488
    v_max3_f32 v13, v13, v197, v198
    v_max3_f32 v14, v14, v205, v206
    s_add_u32 m0, s37, 32
    v_max3_f32 v11, v11, v183, v12
    v_mfma_f32_32x32x16_bf16 v[96:111], v[44:47], v[212:215], v[96:111]
    v_max3_f32 v13, v13, v199, v14
    buffer_load_dwordx4 v5, s[8:11], s41 offen offset:2048 nt lds
    v_max3_f32 v11, v11, v191, v207
    v_max_f32 v11, v11, v13
    s_waitcnt lgkmcnt(6)
    v_mfma_f32_32x32x16_bf16 v[48:63], v[16:19], v[216:219], v[48:63]
    ds_read_b64_tr_b16 v[36:37], v2 offset:17472
    ds_read_b64_tr_b16 v[38:39], v2 offset:19552
    s_add_u32 m0, s37, 48
    v_mov_b32 v12, v11
    s_nop 1
    v_permlane32_swap_b32 v11, v12
    v_mfma_f32_32x32x16_bf16 v[64:79], v[20:23], v[216:219], v[64:79]
    ds_read_b64_tr_b16 v[40:41], v2 offset:17536
    ds_read_b64_tr_b16 v[42:43], v2 offset:19616
    buffer_load_dwordx4 v5, s[8:11], s41 offen offset:3072 nt lds
    v_max_f32 v10, v11, v12
    s_waitcnt lgkmcnt(6)
    v_mfma_f32_32x32x16_bf16 v[80:95], v[24:27], v[216:219], v[80:95]
    ds_read_b64_tr_b16 v[44:45], v2 offset:17600
    ds_read_b64_tr_b16 v[46:47], v2 offset:19680
    s_add_u32 s41, s41, 16384
    s_and_b32 s41, s41, 0x7ffff
    s_add_u32 s40, s40, 1
    v_mfma_f32_32x32x16_bf16 v[96:111], v[28:31], v[216:219], v[96:111]
    s_waitcnt lgkmcnt(4)
    v_mfma_f32_32x32x16_bf16 v[48:63], v[32:35], v[220:223], v[48:63]
    s_waitcnt lgkmcnt(0)
    s_waitcnt vmcnt(8)
    s_barrier
    ds_read_b64_tr_b16 v[16:17], v3 offset:0
    ds_read_b64_tr_b16 v[18:19], v3 offset:2080
    ds_read_b64_tr_b16 v[20:21], v3 offset:64
    ds_read_b64_tr_b16 v[22:23], v3 offset:2144
    ds_read_b64_tr_b16 v[24:25], v3 offset:128
    ds_read_b64_tr_b16 v[26:27], v3 offset:2208
    v_mfma_f32_32x32x16_bf16 v[64:79], v[36:39], v[220:223], v[64:79]
    ds_read_b64_tr_b16 v[28:29], v3 offset:192
    ds_read_b64_tr_b16 v[30:31], v3 offset:2272
    v_mfma_f32_32x32x16_bf16 v[80:95], v[40:43], v[220:223], v[80:95]
    ds_read_b64_tr_b16 v[32:33], v3 offset:256
    ds_read_b64_tr_b16 v[34:35], v3 offset:2336
    v_mfma_f32_32x32x16_bf16 v[96:111], v[44:47], v[220:223], v[96:111]
    ds_read_b64_tr_b16 v[36:37], v3 offset:320
    ds_read_b64_tr_b16 v[38:39], v3 offset:2400
    s_waitcnt lgkmcnt(8)
    v_mfma_f32_32x32x16_bf16 a[0:15], v[16:19], v[160:163], a[0:15]
    ds_read_b64_tr_b16 v[40:41], v3 offset:384
    ds_read_b64_tr_b16 v[42:43], v3 offset:2464
    v_mfma_f32_32x32x16_bf16 a[16:31], v[20:23], v[160:163], a[16:31]
    ds_read_b64_tr_b16 v[44:45], v3 offset:448
    ds_read_b64_tr_b16 v[46:47], v3 offset:2528
    v_cmp_lt_f32 vcc, s34, v10
    s_cbranch_vccnz L_rare_4
L_back_4:
    v_exp_f32 v176, v176
    s_waitcnt lgkmcnt(8)
    v_mfma_f32_32x32x16_bf16 a[32:47], v[24:27], v[160:163], a[32:47]
    ds_read_b64_tr_b16 v[16:17], v3 offset:512
    ds_read_b64_tr_b16 v[18:19], v3 offset:2592
    v_exp_f32 v177, v177
    v_exp_f32 v178, v178
    v_mfma_f32_32x32x16_bf16 a[48:63], v[28:31], v[160:163], a[48:63]
    ds_read_b64_tr_b16 v[20:21], v3 offset:576
    ds_read_b64_tr_b16 v[22:23], v3 offset:2656
    s_cmp_le_i32 s40, 30
    s_cselect_b32 s14, 0x80000, 0
    s_cselect_b32 s38, s36, s39
    v_add_f32 v7, v7, v176
    s_waitcnt lgkmcnt(8)
    v_mfma_f32_32x32x16_bf16 a[64:79], v[32:35], v[160:163], a[64:79]
    ds_read_b64_tr_b16 v[24:25], v3 offset:640
    ds_read_b64_tr_b16 v[26:27], v3 offset:2720
    v_exp_f32 v179, v179
    v_add_f32 v8, v8, v177
    s_add_u32 m0, s38, 49920
    v_mfma_f32_32x32x16_bf16 a[80:95], v[36:39], v[160:163], a[80:95]
    ds_read_b64_tr_b16 v[28:29], v3 offset:704
    ds_read_b64_tr_b16 v[30:31], v3 offset:2784
    v_cvt_pk_bf16_f32 v176, v176, v177
    v_exp_f32 v180, v180
    v_add_f32 v7, v7, v178
    s_waitcnt lgkmcnt(8)
    v_mfma_f32_32x32x16_bf16 a[96:111], v[40:43], v[160:163], a[96:111]
    ds_read_b64_tr_b16 v[32:33], v3 offset:768
    ds_read_b64_tr_b16 v[34:35], v3 offset:2848
    buffer_load_dwordx4 v5, s[12:15], s42 offen nt lds
    v_mfma_f32_32x32x16_bf16 a[112:127], v[44:47], v[160:163], a[112:127]
    ds_read_b64_tr_b16 v[36:37], v3 offset:832
    ds_read_b64_tr_b16 v[38:39], v3 offset:2912
    v_exp_f32 v181, v181
    v_add_f32 v8, v8, v179
    v_cvt_pk_bf16_f32 v177, v178, v179
    s_waitcnt lgkmcnt(8)
    v_mfma_f32_32x32x16_bf16 a[128:143], v[16:19], v[160:163], a[128:143]
    ds_read_b64_tr_b16 v[40:41], v3 offset:896
    ds_read_b64_tr_b16 v[42:43], v3 offset:2976
    s_add_u32 m0, s38, 49936
    v_exp_f32 v182, v182
    v_add_f32 v7, v7, v180
    v_mfma_f32_32x32x16_bf16 a[144:159], v[20:23], v[160:163], a[144:159]
    ds_read_b64_tr_b16 v[44:45], v3 offset:960
    ds_read_b64_tr_b16 v[46:47], v3 offset:3040
    v_exp_f32 v183, v183
    s_waitcnt lgkmcnt(8)
    v_mfma_f32_32x32x16_bf16 a[160:175], v[24:27], v[160:163], a[160:175]
    ds_read_b128 v[16:19], v1 offset:16640
    buffer_load_dwordx4 v5, s[12:15], s42 offen offset:1024 nt lds
    v_add_f32 v8, v8, v181
    v_cvt_pk_bf16_f32 v178, v180, v181
    v_mfma_f32_32x32x16_bf16 a[176:191], v[28:31], v[160:163], a[176:191]
    ds_read_b128 v[20:23], v1 offset:16672
    v_exp_f32 v184, v184
    s_add_u32 m0, s38, 49952
    v_add_f32 v7, v7, v182
    s_waitcnt lgkmcnt(6)
    v_mfma_f32_32x32x16_bf16 a[192:207], v[32:35], v[160:163], a[192:207]
    ds_read_b128 v[24:27], v1 offset:16704
    v_exp_f32 v185, v185
    v_add_f32 v8, v8, v183
    v_mfma_f32_32x32x16_bf16 a[208:223], v[36:39], v[160:163], a[208:223]
    ds_read_b128 v[28:31], v1 offset:16736
    buffer_load_dwordx4 v5, s[12:15], s42 offen offset:2048 nt lds
    v_cvt_pk_bf16_f32 v179, v182, v183
    s_waitcnt lgkmcnt(4)
    v_mfma_f32_32x32x16_bf16 a[224:239], v[40:43], v[160:163], a[224:239]
    ds_read_b128 v[32:35], v1 offset:16768
    v_exp_f32 v186, v186
    v_add_f32 v7, v7, v184
    s_add_u32 m0, s38, 49968
    v_mfma_f32_32x32x16_bf16 a[240:255], v[44:47], v[160:163], a[240:255]
    ds_read_b128 v[36:39], v1 offset:16800
    v_exp_f32 v187, v187
    v_add_f32 v8, v8, v185
    v_cvt_pk_bf16_f32 v180, v184, v185
    s_waitcnt lgkmcnt(4)
    v_mfma_f32_32x32x16_bf16 v[208:223], v[16:19], v[112:115], v[240:255]
    ds_read_b128 v[40:43], v1 offset:16832
    buffer_load_dwordx4 v5, s[12:15], s42 offen offset:3072 nt lds
    v_exp_f32 v188, v188
    v_mfma_f32_32x32x16_bf16 v[208:223], v[20:23], v[116:119], v[208:223]
    ds_read_b128 v[44:47], v1 offset:16864
    v_add_f32 v7, v7, v186
    v_exp_f32 v189, v189
    s_add_u32 s42, s42, 16384
    s_and_b32 s42, s42, 0x7ffff
    s_waitcnt lgkmcnt(4)
    v_mfma_f32_32x32x16_bf16 v[208:223], v[24:27], v[120:123], v[208:223]
    ds_read_b128 v[16:19], v1 offset:17152
    v_add_f32 v8, v8, v187
    v_cvt_pk_bf16_f32 v181, v186, v187
    v_exp_f32 v190, v190
    v_add_f32 v7, v7, v188
    v_mfma_f32_32x32x16_bf16 v[208:223], v[28:31], v[124:127], v[208:223]
    ds_read_b128 v[20:23], v1 offset:17184
    v_exp_f32 v191, v191
    v_add_f32 v8, v8, v189
    v_cvt_pk_bf16_f32 v182, v188, v189
    s_waitcnt lgkmcnt(4)
    v_mfma_f32_32x32x16_bf16 v[208:223], v[32:35], v[128:131], v[208:223]
    ds_read_b128 v[24:27], v1 offset:17216
    v_exp_f32 v192, v192
    v_add_f32 v7, v7, v190
    v_exp_f32 v193, v193
    v_mfma_f32_32x32x16_bf16 v[208:223], v[36:39], v[132:135], v[208:223]
    ds_read_b128 v[28:31], v1 offset:17248
    v_add_f32 v8, v8, v191
    v_cvt_pk_bf16_f32 v183, v190, v191
    v_exp_f32 v194, v194
    v_add_f32 v7, v7, v192
    s_waitcnt lgkmcnt(4)
    v_mfma_f32_32x32x16_bf16 v[208:223], v[40:43], v[136:139], v[208:223]
    ds_read_b128 v[32:35], v1 offset:17280
    v_exp_f32 v195, v195
    v_add_f32 v8, v8, v193
    v_cvt_pk_bf16_f32 v184, v192, v193
    v_mfma_f32_32x32x16_bf16 v[208:223], v[44:47], v[140:143], v[208:223]
    v_exp_f32 v196, v196
    v_add_f32 v7, v7, v194
    v_exp_f32 v197, v197
    v_add_f32 v8, v8, v195
    s_waitcnt lgkmcnt(3)
    v_mfma_f32_32x32x16_bf16 v[224:239], v[16:19], v[112:115], v[240:255]
    ds_read_b128 v[36:39], v1 offset:17312
    v_cvt_pk_bf16_f32 v185, v194, v195
    v_exp_f32 v198, v198
    v_add_f32 v7, v7, v196
    v_mfma_f32_32x32x16_bf16 v[224:239], v[20:23], v[116:119], v[224:239]
    ds_read_b128 v[40:43], v1 offset:17344
    v_exp_f32 v199, v199
    v_add_f32 v8, v8, v197
    v_cvt_pk_bf16_f32 v186, v196, v197
    s_waitcnt lgkmcnt(3)
    v_mfma_f32_32x32x16_bf16 v[224:239], v[24:27], v[120:123], v[224:239]
    ds_read_b128 v[44:47], v1 offset:17376
    v_exp_f32 v200, v200
    v_add_f32 v7, v7, v198
    v_exp_f32 v201, v201
    v_mfma_f32_32x32x16_bf16 v[224:239], v[28:31], v[124:127], v[224:239]
    v_add_f32 v8, v8, v199
    v_cvt_pk_bf16_f32 v187, v198, v199
    v_exp_f32 v202, v202
    v_add_f32 v7, v7, v200
    s_waitcnt lgkmcnt(2)
    v_mfma_f32_32x32x16_bf16 v[224:239], v[32:35], v[128:131], v[224:239]
    v_exp_f32 v203, v203
    v_add_f32 v8, v8, v201
    v_cvt_pk_bf16_f32 v188, v200, v201
    v_exp_f32 v204, v204
    s_waitcnt lgkmcnt(0)
    s_waitcnt vmcnt(8)
    s_barrier
    ds_read_b64_tr_b16 v[16:17], v2 offset:0
    ds_read_b64_tr_b16 v[18:19], v2 offset:2080
    ds_read_b64_tr_b16 v[20:21], v2 offset:64
    ds_read_b64_tr_b16 v[22:23], v2 offset:2144
    ds_read_b64_tr_b16 v[24:25], v2 offset:128
    ds_read_b64_tr_b16 v[26:27], v2 offset:2208
    v_mfma_f32_32x32x16_bf16 v[224:239], v[36:39], v[132:135], v[224:239]
    ds_read_b64_tr_b16 v[28:29], v2 offset:192
    ds_read_b64_tr_b16 v[30:31], v2 offset:2272
    v_add_f32 v7, v7, v202
    v_exp_f32 v205, v205
    v_add_f32 v8, v8, v203
    v_mfma_f32_32x32x16_bf16 v[224:239], v[40:43], v[136:139], v[224:239]
    ds_read_b64_tr_b16 v[32:33], v2 offset:256
    ds_read_b64_tr_b16 v[34:35], v2 offset:2336
    v_cvt_pk_bf16_f32 v189, v202, v203
    v_exp_f32 v206, v206
    v_add_f32 v7, v7, v204
    v_mfma_f32_32x32x16_bf16 v[224:239], v[44:47], v[140:143], v[224:239]
    ds_read_b64_tr_b16 v[36:37], v2 offset:320
    ds_read_b64_tr_b16 v[38:39], v2 offset:2400
    v_exp_f32 v207, v207
    v_add_f32 v8, v8, v205
    v_cvt_pk_bf16_f32 v190, v204, v205
    s_waitcnt lgkmcnt(8)
    v_mfma_f32_32x32x16_bf16 v[48:63], v[16:19], v[176:179], v[48:63]
    ds_read_b64_tr_b16 v[40:41], v2 offset:384
    ds_read_b64_tr_b16 v[42:43], v2 offset:2464
    v_add_f32 v7, v7, v206
    v_add_f32 v8, v8, v207
    v_cvt_pk_bf16_f32 v191, v206, v207
    v_max3_f32 v11, v208, v209, v210
    v_mfma_f32_32x32x16_bf16 v[64:79], v[20:23], v[176:179], v[64:79]
    ds_read_b64_tr_b16 v[44:45], v2 offset:448
    ds_read_b64_tr_b16 v[46:47], v2 offset:2528
    v_max3_f32 v12, v216, v217, v218
    s_cmp_le_i32 s40, 28
    s_cselect_b32 s10, 0x80000, 0
    s_cselect_b32 s37, s36, s39
    s_waitcnt lgkmcnt(8)
    v_mfma_f32_32x32x16_bf16 v[80:95], v[24:27], v[176:179], v[80:95]
    ds_read_b64_tr_b16 v[16:17], v2 offset:512
    ds_read_b64_tr_b16 v[18:19], v2 offset:2592
    v_max3_f32 v13, v224, v225, v226
    v_max3_f32 v14, v232, v233, v234
    s_add_u32 m0, s37, 16640
    v_max3_f32 v11, v11, v211, v212
    v_mfma_f32_32x32x16_bf16 v[96:111], v[28:31], v[176:179], v[96:111]
    ds_read_b64_tr_b16 v[20:21], v2 offset:576
    ds_read_b64_tr_b16 v[22:23], v2 offset:2656
    v_max3_f32 v12, v12, v219, v220
    buffer_load_dwordx4 v5, s[8:11], s41 offen nt lds
    s_waitcnt lgkmcnt(8)
    v_mfma_f32_32x32x16_bf16 v[48:63], v[32:35], v[180:183], v[48:63]
    ds_read_b64_tr_b16 v[24:25], v2 offset:640
    ds_read_b64_tr_b16 v[26:27], v2 offset:2720
    v_max3_f32 v13, v13, v227, v228
    v_max3_f32 v14, v14, v235, v236
    s_add_u32 m0, s37, 16656
    v_max3_f32 v11, v11, v213, v214
    v_mfma_f32_32x32x16_bf16 v[64:79], v[36:39], v[180:183], v[64:79]
    ds_read_b64_tr_b16 v[28:29], v2 offset:704
    ds_read_b64_tr_b16 v[30:31], v2 offset:2784
    v_max3_f32 v12, v12, v221, v222
    buffer_load_dwordx4 v5, s[8:11], s41 offen offset:1024 nt lds
    s_waitcnt lgkmcnt(8)
    v_mfma_f32_32x32x16_bf16 v[80:95], v[40:43], v[180:183], v[80:95]
    ds_read_b64_tr_b16 v[32:33], v2 offset:768
    ds_read_b64_tr_b16 v[34:35], v2 offset:2848
    v_max3_f32 v13, v13, v229, v230
    v_max3_f32 v14, v14, v237, v238
    s_add_u32 m0, s37, 16672
    v_max3_f32 v11, v11, v215, v12
    v_mfma_f32_32x32x16_bf16 v[96:111], v[44:47], v[180:183], v[96:111]
    v_max3_f32 v13, v13, v231, v14
    buffer_load_dwordx4 v5, s[8:11], s41 offen offset:2048 nt lds
    v_max3_f32 v11, v11, v223, v239
    v_max_f32 v11, v11, v13
    s_waitcnt lgkmcnt(6)
    v_mfma_f32_32x32x16_bf16 v[48:63], v[16:19], v[184:187], v[48:63]
    ds_read_b64_tr_b16 v[36:37], v2 offset:832
    ds_read_b64_tr_b16 v[38:39], v2 offset:2912
    s_add_u32 m0, s37, 16688
    v_mov_b32 v12, v11
    s_nop 1
    v_permlane32_swap_b32 v11, v12
    v_mfma_f32_32x32x16_bf16 v[64:79], v[20:23], v[184:187], v[64:79]
    ds_read_b64_tr_b16 v[40:41], v2 offset:896
    ds_read_b64_tr_b16 v[42:43], v2 offset:2976
    buffer_load_dwordx4 v5, s[8:11], s41 offen offset:3072 nt lds
    v_max_f32 v10, v11, v12
    s_waitcnt lgkmcnt(6)
    v_mfma_f32_32x32x16_bf16 v[80:95], v[24:27], v[184:187], v[80:95]
    ds_read_b64_tr_b16 v[44:45], v2 offset:960
    ds_read_b64_tr_b16 v[46:47], v2 offset:3040
    s_add_u32 s41, s41, 16384
    s_and_b32 s41, s41, 0x7ffff
    s_add_u32 s40, s40, 1
    v_mfma_f32_32x32x16_bf16 v[96:111], v[28:31], v[184:187], v[96:111]
    s_waitcnt lgkmcnt(4)
    v_mfma_f32_32x32x16_bf16 v[48:63], v[32:35], v[188:191], v[48:63]
    s_waitcnt lgkmcnt(0)
    s_waitcnt vmcnt(8)
    s_barrier
    ds_read_b64_tr_b16 v[16:17], v3 offset:16640
    ds_read_b64_tr_b16 v[18:19], v3 offset:18720
    ds_read_b64_tr_b16 v[20:21], v3 offset:16704
    ds_read_b64_tr_b16 v[22:23], v3 offset:18784
    ds_read_b64_tr_b16 v[24:25], v3 offset:16768
    ds_read_b64_tr_b16 v[26:27], v3 offset:18848
    v_mfma_f32_32x32x16_bf16 v[64:79], v[36:39], v[188:191], v[64:79]
    ds_read_b64_tr_b16 v[28:29], v3 offset:16832
    ds_read_b64_tr_b16 v[30:31], v3 offset:18912
    v_mfma_f32_32x32x16_bf16 v[80:95], v[40:43], v[188:191], v[80:95]
    ds_read_b64_tr_b16 v[32:33], v3 offset:16896
    ds_read_b64_tr_b16 v[34:35], v3 offset:18976
    v_mfma_f32_32x32x16_bf16 v[96:111], v[44:47], v[188:191], v[96:111]
    ds_read_b64_tr_b16 v[36:37], v3 offset:16960
    ds_read_b64_tr_b16 v[38:39], v3 offset:19040
    s_waitcnt lgkmcnt(8)
    v_mfma_f32_32x32x16_bf16 a[0:15], v[16:19], v[164:167], a[0:15]
    ds_read_b64_tr_b16 v[40:41], v3 offset:17024
    ds_read_b64_tr_b16 v[42:43], v3 offset:19104
    v_mfma_f32_32x32x16_bf16 a[16:31], v[20:23], v[164:167], a[16:31]
    ds_read_b64_tr_b16 v[44:45], v3 offset:17088
    ds_read_b64_tr_b16 v[46:47], v3 offset:19168
    v_cmp_lt_f32 vcc, s34, v10
    s_cbranch_vccnz L_rare_5
L_back_5:
    v_exp_f32 v208, v208
    s_waitcnt lgkmcnt(8)
    v_mfma_f32_32x32x16_bf16 a[32:47], v[24:27], v[164:167], a[32:47]
    ds_read_b64_tr_b16 v[16:17], v3 offset:17152
    ds_read_b64_tr_b16 v[18:19], v3 offset:19232
    v_exp_f32 v209, v209
    v_exp_f32 v210, v210
    v_mfma_f32_32x32x16_bf16 a[48:63], v[28:31], v[164:167], a[48:63]
    ds_read_b64_tr_b16 v[20:21], v3 offset:17216
    ds_read_b64_tr_b16 v[22:23], v3 offset:19296
    s_cmp_le_i32 s40, 30
    s_cselect_b32 s14, 0x80000, 0
    s_cselect_b32 s38, s36, s39
    v_add_f32 v7, v7, v208
    s_waitcnt lgkmcnt(8)
    v_mfma_f32_32x32x16_bf16 a[64:79], v[32:35], v[164:167], a[64:79]
    ds_read_b64_tr_b16 v[24:25], v3 offset:17280
    ds_read_b64_tr_b16 v[26:27], v3 offset:19360
    v_exp_f32 v211, v211
    v_add_f32 v8, v8, v209
    s_add_u32 m0, s38, 33280
    v_mfma_f32_32x32x16_bf16 a[80:95], v[36:39], v[164:167], a[80:95]
    ds_read_b64_tr_b16 v[28:29], v3 offset:17344
    ds_read_b64_tr_b16 v[30:31], v3 offset:19424
    v_cvt_pk_bf16_f32 v208, v208, v209
    v_exp_f32 v212, v212
    v_add_f32 v7, v7, v210
    s_waitcnt lgkmcnt(8)
    v_mfma_f32_32x32x16_bf16 a[96:111], v[40:43], v[164:167], a[96:111]
    ds_read_b64_tr_b16 v[32:33], v3 offset:17408
    ds_read_b64_tr_b16 v[34:35], v3 offset:19488
    buffer_load_dwordx4 v5, s[12:15], s42 offen nt lds
    v_mfma_f32_32x32x16_bf16 a[112:127], v[44:47], v[164:167], a[112:127]
    ds_read_b64_tr_b16 v[36:37], v3 offset:17472
    ds_read_b64_tr_b16 v[38:39], v3 offset:19552
    v_exp_f32 v213, v213
    v_add_f32 v8, v8, v211
    v_cvt_pk_bf16_f32 v209, v210, v211
    s_waitcnt lgkmcnt(8)
    v_mfma_f32_32x32x16_bf16 a[128:143], v[16:19], v[164:167], a[128:143]
    ds_read_b64_tr_b16 v[40:41], v3 offset:17536
    ds_read_b64_tr_b16 v[42:43], v3 offset:19616
    s_add_u32 m0, s38, 33296
    v_exp_f32 v214, v214
    v_add_f32 v7, v7, v212
    v_mfma_f32_32x32x16_bf16 a[144:159], v[20:23], v[164:167], a[144:159]
    ds_read_b64_tr_b16 v[44:45], v3 offset:17600
    ds_read_b64_tr_b16 v[46:47], v3 offset:19680
    v_exp_f32 v215, v215
    s_waitcnt lgkmcnt(8)
    v_mfma_f32_32x32x16_bf16 a[160:175], v[24:27], v[164:167], a[160:175]
    ds_read_b128 v[16:19], v1 offset:0
    buffer_load_dwordx4 v5, s[12:15], s42 offen offset:1024 nt lds
    v_add_f32 v8, v8, v213
    v_cvt_pk_bf16_f32 v210, v212, v213
    v_mfma_f32_32x32x16_bf16 a[176:191], v[28:31], v[164:167], a[176:191]
    ds_read_b128 v[20:23], v1 offset:32
    v_exp_f32 v216, v216
    s_add_u32 m0, s38, 33312
    v_add_f32 v7, v7, v214
    s_waitcnt lgkmcnt(6)
    v_mfma_f32_32x32x16_bf16 a[192:207], v[32:35], v[164:167], a[192:207]
    ds_read_b128 v[24:27], v1 offset:64
    v_exp_f32 v217, v217
    v_add_f32 v8, v8, v215
    v_mfma_f32_32x32x16_bf16 a[208:223], v[36:39], v[164:167], a[208:223]
    ds_read_b128 v[28:31], v1 offset:96
    buffer_load_dwordx4 v5, s[12:15], s42 offen offset:2048 nt lds
    v_cvt_pk_bf16_f32 v211, v214, v215
    s_waitcnt lgkmcnt(4)
    v_mfma_f32_32x32x16_bf16 a[224:239], v[40:43], v[164:167], a[224:239]
    ds_read_b128 v[32:35], v1 offset:128
    v_exp_f32 v218, v218
    v_add_f32 v7, v7, v216
    s_add_u32 m0, s38, 33328
    v_mfma_f32_32x32x16_bf16 a[240:255], v[44:47], v[164:167], a[240:255]
    ds_read_b128 v[36:39], v1 offset:160
    v_exp_f32 v219, v219
    v_add_f32 v8, v8, v217
    v_cvt_pk_bf16_f32 v212, v216, v217
    s_waitcnt lgkmcnt(4)
    v_mfma_f32_32x32x16_bf16 v[176:191], v[16:19], v[112:115], v[240:255]
    ds_read_b128 v[40:43], v1 offset:192
    buffer_load_dwordx4 v5, s[12:15], s42 offen offset:3072 nt lds
    v_exp_f32 v220, v220
    v_mfma_f32_32x32x16_bf16 v[176:191], v[20:23], v[116:119], v[176:191]
    ds_read_b128 v[44:47], v1 offset:224
    v_add_f32 v7, v7, v218
    v_exp_f32 v221, v221
    s_add_u32 s42, s42, 16384
    s_and_b32 s42, s42, 0x7ffff
    s_waitcnt lgkmcnt(4)
    v_mfma_f32_32x32x16_bf16 v[176:191], v[24:27], v[120:123], v[176:191]
    ds_read_b128 v[16:19], v1 offset:512
    v_add_f32 v8, v8, v219
    v_cvt_pk_bf16_f32 v213, v218, v219
    v_exp_f32 v222, v222
    v_add_f32 v7, v7, v220
    v_mfma_f32_32x32x16_bf16 v[176:191], v[28:31], v[124:127], v[176:191]
    ds_read_b128 v[20:23], v1 offset:544
    v_exp_f32 v223, v223
    v_add_f32 v8, v8, v221
    v_cvt_pk_bf16_f32 v214, v220, v221
    s_waitcnt lgkmcnt(4)
    v_mfma_f32_32x32x16_bf16 v[176:191], v[32:35], v[128:131], v[176:191]
    ds_read_b128 v[24:27], v1 offset:576
    v_exp_f32 v224, v224
    v_add_f32 v7, v7, v222
    v_exp_f32 v225, v225
    v_mfma_f32_32x32x16_bf16 v[176:191], v[36:39], v[132:135], v[176:191]
    ds_read_b128 v[28:31], v1 offset:608
    v_add_f32 v8, v8, v223
    v_cvt_pk_bf16_f32 v215, v222, v223
    v_exp_f32 v226, v226
    v_add_f32 v7, v7, v224
    s_waitcnt lgkmcnt(4)
    v_mfma_f32_32x32x16_bf16 v[176:191], v[40:43], v[136:139], v[176:191]
    ds_read_b128 v[32:35], v1 offset:640
    v_exp_f32 v227, v227
    v_add_f32 v8, v8, v225
    v_cvt_pk_bf16_f32 v216, v224, v225
    v_mfma_f32_32x32x16_bf16 v[176:191], v[44:47], v[140:143], v[176:191]
    v_exp_f32 v228, v228
    v_add_f32 v7, v7, v226
    v_exp_f32 v229, v229
    v_add_f32 v8, v8, v227
    s_waitcnt lgkmcnt(3)
    v_mfma_f32_32x32x16_bf16 v[192:207], v[16:19], v[112:115], v[240:255]
    ds_read_b128 v[36:39], v1 offset:672
    v_cvt_pk_bf16_f32 v217, v226, v227
    v_exp_f32 v230, v230
    v_add_f32 v7, v7, v228
    v_mfma_f32_32x32x16_bf16 v[192:207], v[20:23], v[116:119], v[192:207]
    ds_read_b128 v[40:43], v1 offset:704
    v_exp_f32 v231, v231
    v_add_f32 v8, v8, v229
    v_cvt_pk_bf16_f32 v218, v228, v229
    s_waitcnt lgkmcnt(3)
    v_mfma_f32_32x32x16_bf16 v[192:207], v[24:27], v[120:123], v[192:207]
    ds_read_b128 v[44:47], v1 offset:736
    v_exp_f32 v232, v232
    v_add_f32 v7, v7, v230
    v_exp_f32 v233, v233
    v_mfma_f32_32x32x16_bf16 v[192:207], v[28:31], v[124:127], v[192:207]
    v_add_f32 v8, v8, v231
    v_cvt_pk_bf16_f32 v219, v230, v231
    v_exp_f32 v234, v234
    v_add_f32 v7, v7, v232
    s_waitcnt lgkmcnt(2)
    v_mfma_f32_32x32x16_bf16 v[192:207], v[32:35], v[128:131], v[192:207]
    v_exp_f32 v235, v235
    v_add_f32 v8, v8, v233
    v_cvt_pk_bf16_f32 v220, v232, v233
    v_exp_f32 v236, v236
    s_waitcnt lgkmcnt(0)
    s_waitcnt vmcnt(8)
    s_barrier
    ds_read_b64_tr_b16 v[16:17], v2 offset:16640
    ds_read_b64_tr_b16 v[18:19], v2 offset:18720
    ds_read_b64_tr_b16 v[20:21], v2 offset:16704
    ds_read_b64_tr_b16 v[22:23], v2 offset:18784
    ds_read_b64_tr_b16 v[24:25], v2 offset:16768
    ds_read_b64_tr_b16 v[26:27], v2 offset:18848
    v_mfma_f32_32x32x16_bf16 v[192:207], v[36:39], v[132:135], v[192:207]
    ds_read_b64_tr_b16 v[28:29], v2 offset:16832
    ds_read_b64_tr_b16 v[30:31], v2 offset:18912
    v_add_f32 v7, v7, v234
    v_exp_f32 v237, v237
    v_add_f32 v8, v8, v235
    v_mfma_f32_32x32x16_bf16 v[192:207], v[40:43], v[136:139], v[192:207]
    ds_read_b64_tr_b16 v[32:33], v2 offset:16896
    ds_read_b64_tr_b16 v[34:35], v2 offset:18976
    v_cvt_pk_bf16_f32 v221, v234, v235
    v_exp_f32 v238, v238
    v_add_f32 v7, v7, v236
    v_mfma_f32_32x32x16_bf16 v[192:207], v[44:47], v[140:143], v[192:207]
    ds_read_b64_tr_b16 v[36:37], v2 offset:16960
    ds_read_b64_tr_b16 v[38:39], v2 offset:19040
    v_exp_f32 v239, v239
    v_add_f32 v8, v8, v237
    v_cvt_pk_bf16_f32 v222, v236, v237
    s_waitcnt lgkmcnt(8)
    v_mfma_f32_32x32x16_bf16 v[48:63], v[16:19], v[208:211], v[48:63]
    ds_read_b64_tr_b16 v[40:41], v2 offset:17024
    ds_read_b64_tr_b16 v[42:43], v2 offset:19104
    v_add_f32 v7, v7, v238
    v_add_f32 v8, v8, v239
    v_cvt_pk_bf16_f32 v223, v238, v239
    v_max3_f32 v11, v176, v177, v178
    v_mfma_f32_32x32x16_bf16 v[64:79], v[20:23], v[208:211], v[64:79]
    ds_read_b64_tr_b16 v[44:45], v2 offset:17088
    ds_read_b64_tr_b16 v[46:47], v2 offset:19168
    v_max3_f32 v12, v184, v185, v186
    s_cmp_le_i32 s40, 28
    s_cselect_b32 s10, 0x80000, 0
    s_cselect_b32 s37, s36, s39
    s_waitcnt lgkmcnt(8)
    v_mfma_f32_32x32x16_bf16 v[80:95], v[24:27], v[208:211], v[80:95]
    ds_read_b64_tr_b16 v[16:17], v2 offset:17152
    ds_read_b64_tr_b16 v[18:19], v2 offset:19232
    v_max3_f32 v13, v192, v193, v194
    v_max3_f32 v14, v200, v201, v202
    s_add_u32 m0, s37, 0
    v_max3_f32 v11, v11, v179, v180
    v_mfma_f32_32x32x16_bf16 v[96:111], v[28:31], v[208:211], v[96:111]
    ds_read_b64_tr_b16 v[20:21], v2 offset:17216
    ds_read_b64_tr_b16 v[22:23], v2 offset:19296
    v_max3_f32 v12, v12, v187, v188
    buffer_load_dwordx4 v5, s[8:11], s41 offen nt lds
    s_waitcnt lgkmcnt(8)
    v_mfma_f32_32x32x16_bf16 v[48:63], v[32:35], v[212:215], v[48:63]
    ds_read_b64_tr_b16 v[24:25], v2 offset:17280
    ds_read_b64_tr_b16 v[26:27], v2 offset:19360
    v_max3_f32 v13, v13, v195, v196
    v_max3_f32 v14, v14, v203, v204
    s_add_u32 m0, s37, 16
    v_max3_f32 v11, v11, v181, v182
    v_mfma_f32_32x32x16_bf16 v[64:79], v[36:39], v[212:215], v[64:79]
    ds_read_b64_tr_b16 v[28:29], v2 offset:17344
    ds_read_b64_tr_b16 v[30:31], v2 offset:19424
    v_max3_f32 v12, v12, v189, v190
    buffer_load_dwordx4 v5, s[8:11], s41 offen offset:1024 nt lds
    s_waitcnt lgkmcnt(8)
    v_mfma_f32_32x32x16_bf16 v[80:95], v[40:43], v[212:215], v[80:95]
    ds_read_b64_tr_b16 v[32:33], v2 offset:17408
    ds_read_b64_tr_b16 v[34:35], v2 offset:19488
    v_max3_f32 v13, v13, v197, v198
    v_max3_f32 v14, v14, v205, v206
    s_add_u32 m0, s37, 32
    v_max3_f32 v11, v11, v183, v12
    v_mfma_f32_32x32x16_bf16 v[96:111], v[44:47], v[212:215], v[96:111]
    v_max3_f32 v13, v13, v199, v14
    buffer_load_dwordx4 v5, s[8:11], s41 offen offset:2048 nt lds
    v_max3_f32 v11, v11, v191, v207
    v_max_f32 v11, v11, v13
    s_waitcnt lgkmcnt(6)
    v_mfma_f32_32x32x16_bf16 v[48:63], v[16:19], v[216:219], v[48:63]
    ds_read_b64_tr_b16 v[36:37], v2 offset:17472
    ds_read_b64_tr_b16 v[38:39], v2 offset:19552
    s_add_u32 m0, s37, 48
    v_mov_b32 v12, v11
    s_nop 1
    v_permlane32_swap_b32 v11, v12
    v_mfma_f32_32x32x16_bf16 v[64:79], v[20:23], v[216:219], v[64:79]
    ds_read_b64_tr_b16 v[40:41], v2 offset:17536
    ds_read_b64_tr_b16 v[42:43], v2 offset:19616
    buffer_load_dwordx4 v5, s[8:11], s41 offen offset:3072 nt lds
    v_max_f32 v10, v11, v12
    s_waitcnt lgkmcnt(6)
    v_mfma_f32_32x32x16_bf16 v[80:95], v[24:27], v[216:219], v[80:95]
    ds_read_b64_tr_b16 v[44:45], v2 offset:17600
    ds_read_b64_tr_b16 v[46:47], v2 offset:19680
    s_add_u32 s41, s41, 16384
    s_and_b32 s41, s41, 0x7ffff
    s_add_u32 s40, s40, 1
    v_mfma_f32_32x32x16_bf16 v[96:111], v[28:31], v[216:219], v[96:111]
    s_waitcnt lgkmcnt(4)
    v_mfma_f32_32x32x16_bf16 v[48:63], v[32:35], v[220:223], v[48:63]
    s_waitcnt lgkmcnt(0)
    s_waitcnt vmcnt(8)
    s_barrier
    ds_read_b64_tr_b16 v[16:17], v3 offset:0
    ds_read_b64_tr_b16 v[18:19], v3 offset:2080
    ds_read_b64_tr_b16 v[20:21], v3 offset:64
    ds_read_b64_tr_b16 v[22:23], v3 offset:2144
    ds_read_b64_tr_b16 v[24:25], v3 offset:128
    ds_read_b64_tr_b16 v[26:27], v3 offset:2208
    v_mfma_f32_32x32x16_bf16 v[64:79], v[36:39], v[220:223], v[64:79]
    ds_read_b64_tr_b16 v[28:29], v3 offset:192
    ds_read_b64_tr_b16 v[30:31], v3 offset:2272
    v_mfma_f32_32x32x16_bf16 v[80:95], v[40:43], v[220:223], v[80:95]
    ds_read_b64_tr_b16 v[32:33], v3 offset:256
    ds_read_b64_tr_b16 v[34:35], v3 offset:2336
    v_mfma_f32_32x32x16_bf16 v[96:111], v[44:47], v[220:223], v[96:111]
    ds_read_b64_tr_b16 v[36:37], v3 offset:320
    ds_read_b64_tr_b16 v[38:39], v3 offset:2400
    s_waitcnt lgkmcnt(8)
    v_mfma_f32_32x32x16_bf16 a[0:15], v[16:19], v[168:171], a[0:15]
    ds_read_b64_tr_b16 v[40:41], v3 offset:384
    ds_read_b64_tr_b16 v[42:43], v3 offset:2464
    v_mfma_f32_32x32x16_bf16 a[16:31], v[20:23], v[168:171], a[16:31]
    ds_read_b64_tr_b16 v[44:45], v3 offset:448
    ds_read_b64_tr_b16 v[46:47], v3 offset:2528
    v_cmp_lt_f32 vcc, s34, v10
    s_cbranch_vccnz L_rare_6
L_back_6:
    v_exp_f32 v176, v176
    s_waitcnt lgkmcnt(8)
    v_mfma_f32_32x32x16_bf16 a[32:47], v[24:27], v[168:171], a[32:47]
    ds_read_b64_tr_b16 v[16:17], v3 offset:512
    ds_read_b64_tr_b16 v[18:19], v3 offset:2592
    v_exp_f32 v177, v177
    v_exp_f32 v178, v178
    v_mfma_f32_32x32x16_bf16 a[48:63], v[28:31], v[168:171], a[48:63]
    ds_read_b64_tr_b16 v[20:21], v3 offset:576
    ds_read_b64_tr_b16 v[22:23], v3 offset:2656
    s_cmp_le_i32 s40, 30
    s_cselect_b32 s14, 0x80000, 0
    s_cselect_b32 s38, s36, s39
    v_add_f32 v7, v7, v176
    s_waitcnt lgkmcnt(8)
    v_mfma_f32_32x32x16_bf16 a[64:79], v[32:35], v[168:171], a[64:79]
    ds_read_b64_tr_b16 v[24:25], v3 offset:640
    ds_read_b64_tr_b16 v[26:27], v3 offset:2720
    v_exp_f32 v179, v179
    v_add_f32 v8, v8, v177
    s_add_u32 m0, s38, 49920
    v_mfma_f32_32x32x16_bf16 a[80:95], v[36:39], v[168:171], a[80:95]
    ds_read_b64_tr_b16 v[28:29], v3 offset:704
    ds_read_b64_tr_b16 v[30:31], v3 offset:2784
    v_cvt_pk_bf16_f32 v176, v176, v177
    v_exp_f32 v180, v180
    v_add_f32 v7, v7, v178
    s_waitcnt lgkmcnt(8)
    v_mfma_f32_32x32x16_bf16 a[96:111], v[40:43], v[168:171], a[96:111]
    ds_read_b64_tr_b16 v[32:33], v3 offset:768
    ds_read_b64_tr_b16 v[34:35], v3 offset:2848
    buffer_load_dwordx4 v5, s[12:15], s42 offen nt lds
    v_mfma_f32_32x32x16_bf16 a[112:127], v[44:47], v[168:171], a[112:127]
    ds_read_b64_tr_b16 v[36:37], v3 offset:832
    ds_read_b64_tr_b16 v[38:39], v3 offset:2912
    v_exp_f32 v181, v181
    v_add_f32 v8, v8, v179
    v_cvt_pk_bf16_f32 v177, v178, v179
    s_waitcnt lgkmcnt(8)
    v_mfma_f32_32x32x16_bf16 a[128:143], v[16:19], v[168:171], a[128:143]
    ds_read_b64_tr_b16 v[40:41], v3 offset:896
    ds_read_b64_tr_b16 v[42:43], v3 offset:2976
    s_add_u32 m0, s38, 49936
    v_exp_f32 v182, v182
    v_add_f32 v7, v7, v180
    v_mfma_f32_32x32x16_bf16 a[144:159], v[20:23], v[168:171], a[144:159]
    ds_read_b64_tr_b16 v[44:45], v3 offset:960
    ds_read_b64_tr_b16 v[46:47], v3 offset:3040
    v_exp_f32 v183, v183
    s_waitcnt lgkmcnt(8)
    v_mfma_f32_32x32x16_bf16 a[160:175], v[24:27], v[168:171], a[160:175]
    ds_read_b128 v[16:19], v1 offset:16640
    buffer_load_dwordx4 v5, s[12:15], s42 offen offset:1024 nt lds
    v_add_f32 v8, v8, v181
    v_cvt_pk_bf16_f32 v178, v180, v181
    v_mfma_f32_32x32x16_bf16 a[176:191], v[28:31], v[168:171], a[176:191]
    ds_read_b128 v[20:23], v1 offset:16672
    v_exp_f32 v184, v184
    s_add_u32 m0, s38, 49952
    v_add_f32 v7, v7, v182
    s_waitcnt lgkmcnt(6)
    v_mfma_f32_32x32x16_bf16 a[192:207], v[32:35], v[168:171], a[192:207]
    ds_read_b128 v[24:27], v1 offset:16704
    v_exp_f32 v185, v185
    v_add_f32 v8, v8, v183
    v_mfma_f32_32x32x16_bf16 a[208:223], v[36:39], v[168:171], a[208:223]
    ds_read_b128 v[28:31], v1 offset:16736
    buffer_load_dwordx4 v5, s[12:15], s42 offen offset:2048 nt lds
    v_cvt_pk_bf16_f32 v179, v182, v183
    s_waitcnt lgkmcnt(4)
    v_mfma_f32_32x32x16_bf16 a[224:239], v[40:43], v[168:171], a[224:239]
    ds_read_b128 v[32:35], v1 offset:16768
    v_exp_f32 v186, v186
    v_add_f32 v7, v7, v184
    s_add_u32 m0, s38, 49968
    v_mfma_f32_32x32x16_bf16 a[240:255], v[44:47], v[168:171], a[240:255]
    ds_read_b128 v[36:39], v1 offset:16800
    v_exp_f32 v187, v187
    v_add_f32 v8, v8, v185
    v_cvt_pk_bf16_f32 v180, v184, v185
    s_waitcnt lgkmcnt(4)
    v_mfma_f32_32x32x16_bf16 v[208:223], v[16:19], v[112:115], v[240:255]
    ds_read_b128 v[40:43], v1 offset:16832
    buffer_load_dwordx4 v5, s[12:15], s42 offen offset:3072 nt lds
    v_exp_f32 v188, v188
    v_mfma_f32_32x32x16_bf16 v[208:223], v[20:23], v[116:119], v[208:223]
    ds_read_b128 v[44:47], v1 offset:16864
    v_add_f32 v7, v7, v186
    v_exp_f32 v189, v189
    s_add_u32 s42, s42, 16384
    s_and_b32 s42, s42, 0x7ffff
    s_waitcnt lgkmcnt(4)
    v_mfma_f32_32x32x16_bf16 v[208:223], v[24:27], v[120:123], v[208:223]
    ds_read_b128 v[16:19], v1 offset:17152
    v_add_f32 v8, v8, v187
    v_cvt_pk_bf16_f32 v181, v186, v187
    v_exp_f32 v190, v190
    v_add_f32 v7, v7, v188
    v_mfma_f32_32x32x16_bf16 v[208:223], v[28:31], v[124:127], v[208:223]
    ds_read_b128 v[20:23], v1 offset:17184
    v_exp_f32 v191, v191
    v_add_f32 v8, v8, v189
    v_cvt_pk_bf16_f32 v182, v188, v189
    s_waitcnt lgkmcnt(4)
    v_mfma_f32_32x32x16_bf16 v[208:223], v[32:35], v[128:131], v[208:223]
    ds_read_b128 v[24:27], v1 offset:17216
    v_exp_f32 v192, v192
    v_add_f32 v7, v7, v190
    v_exp_f32 v193, v193
    v_mfma_f32_32x32x16_bf16 v[208:223], v[36:39], v[132:135], v[208:223]
    ds_read_b128 v[28:31], v1 offset:17248
    v_add_f32 v8, v8, v191
    v_cvt_pk_bf16_f32 v183, v190, v191
    v_exp_f32 v194, v194
    v_add_f32 v7, v7, v192
    s_waitcnt lgkmcnt(4)
    v_mfma_f32_32x32x16_bf16 v[208:223], v[40:43], v[136:139], v[208:223]
    ds_read_b128 v[32:35], v1 offset:17280
    v_exp_f32 v195, v195
    v_add_f32 v8, v8, v193
    v_cvt_pk_bf16_f32 v184, v192, v193
    v_mfma_f32_32x32x16_bf16 v[208:223], v[44:47], v[140:143], v[208:223]
    v_exp_f32 v196, v196
    v_add_f32 v7, v7, v194
    v_exp_f32 v197, v197
    v_add_f32 v8, v8, v195
    s_waitcnt lgkmcnt(3)
    v_mfma_f32_32x32x16_bf16 v[224:239], v[16:19], v[112:115], v[240:255]
    ds_read_b128 v[36:39], v1 offset:17312
    v_cvt_pk_bf16_f32 v185, v194, v195
    v_exp_f32 v198, v198
    v_add_f32 v7, v7, v196
    v_mfma_f32_32x32x16_bf16 v[224:239], v[20:23], v[116:119], v[224:239]
    ds_read_b128 v[40:43], v1 offset:17344
    v_exp_f32 v199, v199
    v_add_f32 v8, v8, v197
    v_cvt_pk_bf16_f32 v186, v196, v197
    s_waitcnt lgkmcnt(3)
    v_mfma_f32_32x32x16_bf16 v[224:239], v[24:27], v[120:123], v[224:239]
    ds_read_b128 v[44:47], v1 offset:17376
    v_exp_f32 v200, v200
    v_add_f32 v7, v7, v198
    v_exp_f32 v201, v201
    v_mfma_f32_32x32x16_bf16 v[224:239], v[28:31], v[124:127], v[224:239]
    v_add_f32 v8, v8, v199
    v_cvt_pk_bf16_f32 v187, v198, v199
    v_exp_f32 v202, v202
    v_add_f32 v7, v7, v200
    s_waitcnt lgkmcnt(2)
    v_mfma_f32_32x32x16_bf16 v[224:239], v[32:35], v[128:131], v[224:239]
    v_exp_f32 v203, v203
    v_add_f32 v8, v8, v201
    v_cvt_pk_bf16_f32 v188, v200, v201
    v_exp_f32 v204, v204
    s_waitcnt lgkmcnt(0)
    s_waitcnt vmcnt(8)
    s_barrier
    ds_read_b64_tr_b16 v[16:17], v2 offset:0
    ds_read_b64_tr_b16 v[18:19], v2 offset:2080
    ds_read_b64_tr_b16 v[20:21], v2 offset:64
    ds_read_b64_tr_b16 v[22:23], v2 offset:2144
    ds_read_b64_tr_b16 v[24:25], v2 offset:128
    ds_read_b64_tr_b16 v[26:27], v2 offset:2208
    v_mfma_f32_32x32x16_bf16 v[224:239], v[36:39], v[132:135], v[224:239]
    ds_read_b64_tr_b16 v[28:29], v2 offset:192
    ds_read_b64_tr_b16 v[30:31], v2 offset:2272
    v_add_f32 v7, v7, v202
    v_exp_f32 v205, v205
    v_add_f32 v8, v8, v203
    v_mfma_f32_32x32x16_bf16 v[224:239], v[40:43], v[136:139], v[224:239]
    ds_read_b64_tr_b16 v[32:33], v2 offset:256
    ds_read_b64_tr_b16 v[34:35], v2 offset:2336
    v_cvt_pk_bf16_f32 v189, v202, v203
    v_exp_f32 v206, v206
    v_add_f32 v7, v7, v204
    v_mfma_f32_32x32x16_bf16 v[224:239], v[44:47], v[140:143], v[224:239]
    ds_read_b64_tr_b16 v[36:37], v2 offset:320
    ds_read_b64_tr_b16 v[38:39], v2 offset:2400
    v_exp_f32 v207, v207
    v_add_f32 v8, v8, v205
    v_cvt_pk_bf16_f32 v190, v204, v205
    s_waitcnt lgkmcnt(8)
    v_mfma_f32_32x32x16_bf16 v[48:63], v[16:19], v[176:179], v[48:63]
    ds_read_b64_tr_b16 v[40:41], v2 offset:384
    ds_read_b64_tr_b16 v[42:43], v2 offset:2464
    v_add_f32 v7, v7, v206
    v_add_f32 v8, v8, v207
    v_cvt_pk_bf16_f32 v191, v206, v207
    v_max3_f32 v11, v208, v209, v210
    v_mfma_f32_32x32x16_bf16 v[64:79], v[20:23], v[176:179], v[64:79]
    ds_read_b64_tr_b16 v[44:45], v2 offset:448
    ds_read_b64_tr_b16 v[46:47], v2 offset:2528
    v_max3_f32 v12, v216, v217, v218
    s_cmp_le_i32 s40, 28
    s_cselect_b32 s10, 0x80000, 0
    s_cselect_b32 s37, s36, s39
    s_waitcnt lgkmcnt(8)
    v_mfma_f32_32x32x16_bf16 v[80:95], v[24:27], v[176:179], v[80:95]
    ds_read_b64_tr_b16 v[16:17], v2 offset:512
    ds_read_b64_tr_b16 v[18:19], v2 offset:2592
    v_max3_f32 v13, v224, v225, v226
    v_max3_f32 v14, v232, v233, v234
    s_add_u32 m0, s37, 16640
    v_max3_f32 v11, v11, v211, v212
    v_mfma_f32_32x32x16_bf16 v[96:111], v[28:31], v[176:179], v[96:111]
    ds_read_b64_tr_b16 v[20:21], v2 offset:576
    ds_read_b64_tr_b16 v[22:23], v2 offset:2656
    v_max3_f32 v12, v12, v219, v220
    buffer_load_dwordx4 v5, s[8:11], s41 offen nt lds
    s_waitcnt lgkmcnt(8)
    v_mfma_f32_32x32x16_bf16 v[48:63], v[32:35], v[180:183], v[48:63]
    ds_read_b64_tr_b16 v[24:25], v2 offset:640
    ds_read_b64_tr_b16 v[26:27], v2 offset:2720
    v_max3_f32 v13, v13, v227, v228
    v_max3_f32 v14, v14, v235, v236
    s_add_u32 m0, s37, 16656
    v_max3_f32 v11, v11, v213, v214
    v_mfma_f32_32x32x16_bf16 v[64:79], v[36:39], v[180:183], v[64:79]
    ds_read_b64_tr_b16 v[28:29], v2 offset:704
    ds_read_b64_tr_b16 v[30:31], v2 offset:2784
    v_max3_f32 v12, v12, v221, v222
    buffer_load_dwordx4 v5, s[8:11], s41 offen offset:1024 nt lds
    s_waitcnt lgkmcnt(8)
    v_mfma_f32_32x32x16_bf16 v[80:95], v[40:43], v[180:183], v[80:95]
    ds_read_b64_tr_b16 v[32:33], v2 offset:768
    ds_read_b64_tr_b16 v[34:35], v2 offset:2848
    v_max3_f32 v13, v13, v229, v230
    v_max3_f32 v14, v14, v237, v238
    s_add_u32 m0, s37, 16672
    v_max3_f32 v11, v11, v215, v12
    v_mfma_f32_32x32x16_bf16 v[96:111], v[44:47], v[180:183], v[96:111]
    v_max3_f32 v13, v13, v231, v14
    buffer_load_dwordx4 v5, s[8:11], s41 offen offset:2048 nt lds
    v_max3_f32 v11, v11, v223, v239
    v_max_f32 v11, v11, v13
    s_waitcnt lgkmcnt(6)
    v_mfma_f32_32x32x16_bf16 v[48:63], v[16:19], v[184:187], v[48:63]
    ds_read_b64_tr_b16 v[36:37], v2 offset:832
    ds_read_b64_tr_b16 v[38:39], v2 offset:2912
    s_add_u32 m0, s37, 16688
    v_mov_b32 v12, v11
    s_nop 1
    v_permlane32_swap_b32 v11, v12
    v_mfma_f32_32x32x16_bf16 v[64:79], v[20:23], v[184:187], v[64:79]
    ds_read_b64_tr_b16 v[40:41], v2 offset:896
    ds_read_b64_tr_b16 v[42:43], v2 offset:2976
    buffer_load_dwordx4 v5, s[8:11], s41 offen offset:3072 nt lds
    v_max_f32 v10, v11, v12
    s_waitcnt lgkmcnt(6)
    v_mfma_f32_32x32x16_bf16 v[80:95], v[24:27], v[184:187], v[80:95]
    ds_read_b64_tr_b16 v[44:45], v2 offset:960
    ds_read_b64_tr_b16 v[46:47], v2 offset:3040
    s_add_u32 s41, s41, 16384
    s_and_b32 s41, s41, 0x7ffff
    s_add_u32 s40, s40, 1
    v_mfma_f32_32x32x16_bf16 v[96:111], v[28:31], v[184:187], v[96:111]
    s_waitcnt lgkmcnt(4)
    v_mfma_f32_32x32x16_bf16 v[48:63], v[32:35], v[188:191], v[48:63]
    s_waitcnt lgkmcnt(0)
    s_waitcnt vmcnt(8)
    s_barrier
    ds_read_b64_tr_b16 v[16:17], v3 offset:16640
    ds_read_b64_tr_b16 v[18:19], v3 offset:18720
    ds_read_b64_tr_b16 v[20:21], v3 offset:16704
    ds_read_b64_tr_b16 v[22:23], v3 offset:18784
    ds_read_b64_tr_b16 v[24:25], v3 offset:16768
    ds_read_b64_tr_b16 v[26:27], v3 offset:18848
    v_mfma_f32_32x32x16_bf16 v[64:79], v[36:39], v[188:191], v[64:79]
    ds_read_b64_tr_b16 v[28:29], v3 offset:16832
    ds_read_b64_tr_b16 v[30:31], v3 offset:18912
    v_mfma_f32_32x32x16_bf16 v[80:95], v[40:43], v[188:191], v[80:95]
    ds_read_b64_tr_b16 v[32:33], v3 offset:16896
    ds_read_b64_tr_b16 v[34:35], v3 offset:18976
    v_mfma_f32_32x32x16_bf16 v[96:111], v[44:47], v[188:191], v[96:111]
    ds_read_b64_tr_b16 v[36:37], v3 offset:16960
    ds_read_b64_tr_b16 v[38:39], v3 offset:19040
    s_waitcnt lgkmcnt(8)
    v_mfma_f32_32x32x16_bf16 a[0:15], v[16:19], v[172:175], a[0:15]
    ds_read_b64_tr_b16 v[40:41], v3 offset:17024
    ds_read_b64_tr_b16 v[42:43], v3 offset:19104
    v_mfma_f32_32x32x16_bf16 a[16:31], v[20:23], v[172:175], a[16:31]
    ds_read_b64_tr_b16 v[44:45], v3 offset:17088
    ds_read_b64_tr_b16 v[46:47], v3 offset:19168
    v_cmp_lt_f32 vcc, s34, v10
    s_cbranch_vccnz L_rare_7
L_back_7:
    ds_read_b128 v[112:115], v4 offset:0
    ds_read_b128 v[116:119], v4 offset:1024
    ds_read_b128 v[120:123], v4 offset:2048
    s_waitcnt lgkmcnt(11)
    v_mfma_f32_32x32x16_bf16 a[32:47], v[24:27], v[172:175], a[32:47]
    ds_read_b64_tr_b16 v[16:17], v3 offset:17152
    ds_read_b64_tr_b16 v[18:19], v3 offset:19232
    ds_read_b128 v[124:127], v4 offset:3072
    ds_read_b128 v[128:131], v4 offset:4096
    ds_read_b128 v[132:135], v4 offset:5120
    ds_read_b128 v[136:139], v4 offset:6144
    ds_read_b128 v[140:143], v4 offset:7168
    v_mfma_f32_32x32x16_bf16 a[48:63], v[28:31], v[172:175], a[48:63]
    ds_read_b64_tr_b16 v[20:21], v3 offset:17216
    ds_read_b64_tr_b16 v[22:23], v3 offset:19296
    v_exp_f32 v208, v208
    v_exp_f32 v209, v209
    s_waitcnt lgkmcnt(15)
    v_mfma_f32_32x32x16_bf16 a[64:79], v[32:35], v[172:175], a[64:79]
    ds_read_b64_tr_b16 v[24:25], v3 offset:17280
    ds_read_b64_tr_b16 v[26:27], v3 offset:19360
    v_exp_f32 v210, v210
    s_cmp_le_i32 s40, 30
    s_cselect_b32 s14, 0x80000, 0
    s_cselect_b32 s38, s36, s39
    v_mfma_f32_32x32x16_bf16 a[80:95], v[36:39], v[172:175], a[80:95]
    ds_read_b64_tr_b16 v[28:29], v3 offset:17344
    ds_read_b64_tr_b16 v[30:31], v3 offset:19424
    v_add_f32 v7, v7, v208
    v_exp_f32 v211, v211
    v_add_f32 v8, v8, v209
    s_add_u32 m0, s38, 33280
    s_waitcnt lgkmcnt(15)
    v_mfma_f32_32x32x16_bf16 a[96:111], v[40:43], v[172:175], a[96:111]
    ds_read_b64_tr_b16 v[32:33], v3 offset:17408
    ds_read_b64_tr_b16 v[34:35], v3 offset:19488
    v_cvt_pk_bf16_f32 v208, v208, v209
    v_exp_f32 v212, v212
    v_add_f32 v7, v7, v210
    v_mfma_f32_32x32x16_bf16 a[112:127], v[44:47], v[172:175], a[112:127]
    ds_read_b64_tr_b16 v[36:37], v3 offset:17472
    ds_read_b64_tr_b16 v[38:39], v3 offset:19552
    buffer_load_dwordx4 v5, s[12:15], s42 offen nt lds
    v_exp_f32 v213, v213
    s_waitcnt lgkmcnt(8)
    v_mfma_f32_32x32x16_bf16 a[128:143], v[16:19], v[172:175], a[128:143]
    ds_read_b64_tr_b16 v[40:41], v3 offset:17536
    ds_read_b64_tr_b16 v[42:43], v3 offset:19616
    v_add_f32 v8, v8, v211
    v_cvt_pk_bf16_f32 v209, v210, v211
    s_add_u32 m0, s38, 33296
    v_exp_f32 v214, v214
    v_mfma_f32_32x32x16_bf16 a[144:159], v[20:23], v[172:175], a[144:159]
    ds_read_b64_tr_b16 v[44:45], v3 offset:17600
    ds_read_b64_tr_b16 v[46:47], v3 offset:19680
    v_add_f32 v7, v7, v212
    v_exp_f32 v215, v215
    s_waitcnt lgkmcnt(8)
    v_mfma_f32_32x32x16_bf16 a[160:175], v[24:27], v[172:175], a[160:175]
    ds_read_b128 v[16:19], v1 offset:0
    buffer_load_dwordx4 v5, s[12:15], s42 offen offset:1024 nt lds
    v_add_f32 v8, v8, v213
    v_cvt_pk_bf16_f32 v210, v212, v213
    v_mfma_f32_32x32x16_bf16 a[176:191], v[28:31], v[172:175], a[176:191]
    ds_read_b128 v[20:23], v1 offset:32
    v_exp_f32 v216, v216
    s_add_u32 m0, s38, 33312
    v_add_f32 v7, v7, v214
    s_waitcnt lgkmcnt(6)
    v_mfma_f32_32x32x16_bf16 a[192:207], v[32:35], v[172:175], a[192:207]
    ds_read_b128 v[24:27], v1 offset:64
    v_exp_f32 v217, v217
    v_add_f32 v8, v8, v215
    v_mfma_f32_32x32x16_bf16 a[208:223], v[36:39], v[172:175], a[208:223]
    ds_read_b128 v[28:31], v1 offset:96
    buffer_load_dwordx4 v5, s[12:15], s42 offen offset:2048 nt lds
    v_cvt_pk_bf16_f32 v211, v214, v215
    s_waitcnt lgkmcnt(4)
    v_mfma_f32_32x32x16_bf16 a[224:239], v[40:43], v[172:175], a[224:239]
    ds_read_b128 v[32:35], v1 offset:128
    v_exp_f32 v218, v218
    v_add_f32 v7, v7, v216
    s_add_u32 m0, s38, 33328
    v_mfma_f32_32x32x16_bf16 a[240:255], v[44:47], v[172:175], a[240:255]
    ds_read_b128 v[36:39], v1 offset:160
    v_exp_f32 v219, v219
    v_add_f32 v8, v8, v217
    v_cvt_pk_bf16_f32 v212, v216, v217
    s_waitcnt lgkmcnt(4)
    v_mfma_f32_32x32x16_bf16 v[176:191], v[16:19], v[112:115], 0
    ds_read_b128 v[40:43], v1 offset:192
    buffer_load_dwordx4 v5, s[12:15], s42 offen offset:3072 nt lds
    v_exp_f32 v220, v220
    v_mfma_f32_32x32x16_bf16 v[176:191], v[20:23], v[116:119], v[176:191]
    ds_read_b128 v[44:47], v1 offset:224
    v_add_f32 v7, v7, v218
    v_exp_f32 v221, v221
    s_add_u32 s42, s42, 16384
    s_and_b32 s42, s42, 0x7ffff
    s_waitcnt lgkmcnt(4)
    v_mfma_f32_32x32x16_bf16 v[176:191], v[24:27], v[120:123], v[176:191]
    ds_read_b128 v[16:19], v1 offset:512
    v_add_f32 v8, v8, v219
    v_cvt_pk_bf16_f32 v213, v218, v219
    v_exp_f32 v222, v222
    v_add_f32 v7, v7, v220
    v_mfma_f32_32x32x16_bf16 v[176:191], v[28:31], v[124:127], v[176:191]
    ds_read_b128 v[20:23], v1 offset:544
    v_exp_f32 v223, v223
    v_add_f32 v8, v8, v221
    v_cvt_pk_bf16_f32 v214, v220, v221
    s_waitcnt lgkmcnt(4)
    v_mfma_f32_32x32x16_bf16 v[176:191], v[32:35], v[128:131], v[176:191]
    ds_read_b128 v[24:27], v1 offset:576
    v_exp_f32 v224, v224
    v_add_f32 v7, v7, v222
    v_exp_f32 v225, v225
    v_mfma_f32_32x32x16_bf16 v[176:191], v[36:39], v[132:135], v[176:191]
    ds_read_b128 v[28:31], v1 offset:608
    v_add_f32 v8, v8, v223
    v_cvt_pk_bf16_f32 v215, v222, v223
    v_exp_f32 v226, v226
    v_add_f32 v7, v7, v224
    s_waitcnt lgkmcnt(4)
    v_mfma_f32_32x32x16_bf16 v[176:191], v[40:43], v[136:139], v[176:191]
    ds_read_b128 v[32:35], v1 offset:640
    v_exp_f32 v227, v227
    v_add_f32 v8, v8, v225
    v_cvt_pk_bf16_f32 v216, v224, v225
    v_mfma_f32_32x32x16_bf16 v[176:191], v[44:47], v[140:143], v[176:191]
    ds_read_b128 v[36:39], v1 offset:672
    v_exp_f32 v228, v228
    v_add_f32 v7, v7, v226
    v_exp_f32 v229, v229
    s_waitcnt lgkmcnt(4)
    v_mfma_f32_32x32x16_bf16 v[192:207], v[16:19], v[112:115], 0
    ds_read_b128 v[40:43], v1 offset:704
    v_add_f32 v8, v8, v227
    v_cvt_pk_bf16_f32 v217, v226, v227
    v_exp_f32 v230, v230
    v_add_f32 v7, v7, v228
    v_mfma_f32_32x32x16_bf16 v[192:207], v[20:23], v[116:119], v[192:207]
    ds_read_b128 v[44:47], v1 offset:736
    v_exp_f32 v231, v231
    v_add_f32 v8, v8, v229
    v_cvt_pk_bf16_f32 v218, v228, v229
    s_waitcnt lgkmcnt(4)
    v_mfma_f32_32x32x16_bf16 v[192:207], v[24:27], v[120:123], v[192:207]
    v_exp_f32 v232, v232
    v_add_f32 v7, v7, v230
    v_exp_f32 v233, v233
    v_add_f32 v8, v8, v231
    v_mfma_f32_32x32x16_bf16 v[192:207], v[28:31], v[124:127], v[192:207]
    v_cvt_pk_bf16_f32 v219, v230, v231
    v_exp_f32 v234, v234
    v_add_f32 v7, v7, v232
    v_exp_f32 v235, v235
    s_waitcnt lgkmcnt(2)
    v_mfma_f32_32x32x16_bf16 v[192:207], v[32:35], v[128:131], v[192:207]
    v_add_f32 v8, v8, v233
    v_cvt_pk_bf16_f32 v220, v232, v233
    v_exp_f32 v236, v236
    v_add_f32 v7, v7, v234
    v_mfma_f32_32x32x16_bf16 v[192:207], v[36:39], v[132:135], v[192:207]
    v_exp_f32 v237, v237
    v_add_f32 v8, v8, v235
    v_cvt_pk_bf16_f32 v221, v234, v235
    v_exp_f32 v238, v238
    s_waitcnt lgkmcnt(0)
    v_mfma_f32_32x32x16_bf16 v[192:207], v[40:43], v[136:139], v[192:207]
    v_add_f32 v7, v7, v236
    v_exp_f32 v239, v239
    v_add_f32 v8, v8, v237
    v_cvt_pk_bf16_f32 v222, v236, v237
    v_add_f32 v7, v7, v238
    v_mfma_f32_32x32x16_bf16 v[192:207], v[44:47], v[140:143], v[192:207]
    v_add_f32 v8, v8, v239
    v_cvt_pk_bf16_f32 v223, v238, v239
    s_sub_u32 s35, s35, 1
    s_cmp_lg_u32 s35, 0
    s_waitcnt lgkmcnt(0)
    s_nop 11
    s_cbranch_scc1 L_att_loop
    s_waitcnt vmcnt(0)
    s_barrier
    ds_read_b64_tr_b16 v[16:17], v2 offset:16640
    ds_read_b64_tr_b16 v[18:19], v2 offset:18720
    ds_read_b64_tr_b16 v[20:21], v2 offset:16704
    ds_read_b64_tr_b16 v[22:23], v2 offset:18784
    ds_read_b64_tr_b16 v[24:25], v2 offset:16768
    ds_read_b64_tr_b16 v[26:27], v2 offset:18848
    ds_read_b64_tr_b16 v[28:29], v2 offset:16832
    ds_read_b64_tr_b16 v[30:31], v2 offset:18912
    ds_read_b64_tr_b16 v[32:33], v2 offset:16896
    ds_read_b64_tr_b16 v[34:35], v2 offset:18976
    ds_read_b64_tr_b16 v[36:37], v2 offset:16960
    ds_read_b64_tr_b16 v[38:39], v2 offset:19040
    s_waitcnt lgkmcnt(8)
    v_mfma_f32_32x32x16_bf16 v[48:63], v[16:19], v[208:211], v[48:63]
    ds_read_b64_tr_b16 v[40:41], v2 offset:17024
    ds_read_b64_tr_b16 v[42:43], v2 offset:19104
    v_subrev_u32 v11, 66560, v3
    v_add_u32 v10, 66560, v3
    v_lshlrev_b32 v12, 4, v0
    s_lshl_b32 s3, s32, 15
    v_mfma_f32_32x32x16_bf16 v[64:79], v[20:23], v[208:211], v[64:79]
    ds_read_b64_tr_b16 v[44:45], v2 offset:17088
    ds_read_b64_tr_b16 v[46:47], v2 offset:19168
    v_add_f32 v13, v7, v8
    v_mov_b32 v14, v13
    s_nop 1
    v_permlane32_swap_b32 v13, v14
    v_add_f32 v13, v13, v14
    s_waitcnt lgkmcnt(8)
    v_mfma_f32_32x32x16_bf16 v[80:95], v[24:27], v[208:211], v[80:95]
    ds_read_b64_tr_b16 v[16:17], v2 offset:17152
    ds_read_b64_tr_b16 v[18:19], v2 offset:19232
    v_rcp_f32 v15, v13
    v_mfma_f32_32x32x16_bf16 v[96:111], v[28:31], v[208:211], v[96:111]
    ds_read_b64_tr_b16 v[20:21], v2 offset:17216
    ds_read_b64_tr_b16 v[22:23], v2 offset:19296
    s_waitcnt lgkmcnt(8)
    v_mfma_f32_32x32x16_bf16 v[48:63], v[32:35], v[212:215], v[48:63]
    ds_read_b64_tr_b16 v[24:25], v2 offset:17280
    ds_read_b64_tr_b16 v[26:27], v2 offset:19360
    v_mfma_f32_32x32x16_bf16 v[64:79], v[36:39], v[212:215], v[64:79]
    ds_read_b64_tr_b16 v[28:29], v2 offset:17344
    ds_read_b64_tr_b16 v[30:31], v2 offset:19424
    s_waitcnt lgkmcnt(8)
    v_mfma_f32_32x32x16_bf16 v[80:95], v[40:43], v[212:215], v[80:95]
    ds_read_b64_tr_b16 v[32:33], v2 offset:17408
    ds_read_b64_tr_b16 v[34:35], v2 offset:19488
    v_mfma_f32_32x32x16_bf16 v[96:111], v[44:47], v[212:215], v[96:111]
    s_waitcnt lgkmcnt(6)
    v_mfma_f32_32x32x16_bf16 v[48:63], v[16:19], v[216:219], v[48:63]
    ds_read_b64_tr_b16 v[36:37], v2 offset:17472
    ds_read_b64_tr_b16 v[38:39], v2 offset:19552
    v_mfma_f32_32x32x16_bf16 v[64:79], v[20:23], v[216:219], v[64:79]
    ds_read_b64_tr_b16 v[40:41], v2 offset:17536
    ds_read_b64_tr_b16 v[42:43], v2 offset:19616
    s_waitcnt lgkmcnt(6)
    v_mfma_f32_32x32x16_bf16 v[80:95], v[24:27], v[216:219], v[80:95]
    ds_read_b64_tr_b16 v[44:45], v2 offset:17600
    ds_read_b64_tr_b16 v[46:47], v2 offset:19680
    v_mfma_f32_32x32x16_bf16 v[96:111], v[28:31], v[216:219], v[96:111]
    s_waitcnt lgkmcnt(4)
    v_mfma_f32_32x32x16_bf16 v[48:63], v[32:35], v[220:223], v[48:63]
    s_waitcnt lgkmcnt(0)
    s_barrier
    ds_read_b64_tr_b16 v[16:17], v3 offset:0
    ds_read_b64_tr_b16 v[18:19], v3 offset:2080
    ds_read_b64_tr_b16 v[20:21], v3 offset:16640
    ds_read_b64_tr_b16 v[22:23], v3 offset:18720
    ds_read_b64_tr_b16 v[24:25], v3 offset:33280
    ds_read_b64_tr_b16 v[26:27], v3 offset:35360
    v_mfma_f32_32x32x16_bf16 v[64:79], v[36:39], v[220:223], v[64:79]
    ds_read_b64_tr_b16 v[28:29], v3 offset:49920
    ds_read_b64_tr_b16 v[30:31], v3 offset:52000
    s_nop 0
    v_mul_f32 v48, v15, v48
    v_mul_f32 v49, v15, v49
    v_mul_f32 v50, v15, v50
    v_mul_f32 v51, v15, v51
    v_cvt_pk_bf16_f32 v144, v48, v49
    v_mul_f32 v52, v15, v52
    v_mul_f32 v53, v15, v53
    v_cvt_pk_bf16_f32 v145, v50, v51
    v_mul_f32 v54, v15, v54
    v_mul_f32 v55, v15, v55
    v_mfma_f32_32x32x16_bf16 v[80:95], v[40:43], v[220:223], v[80:95]
    ds_read_b64_tr_b16 v[32:33], v11 offset:0
    ds_read_b64_tr_b16 v[34:35], v11 offset:2080
    v_cvt_pk_bf16_f32 v146, v52, v53
    v_mul_f32 v56, v15, v56
    v_mul_f32 v57, v15, v57
    v_cvt_pk_bf16_f32 v147, v54, v55
    v_mul_f32 v58, v15, v58
    v_mul_f32 v59, v15, v59
    v_cvt_pk_bf16_f32 v148, v56, v57
    v_mul_f32 v60, v15, v60
    v_mul_f32 v61, v15, v61
    v_cvt_pk_bf16_f32 v149, v58, v59
    v_mfma_f32_32x32x16_bf16 v[96:111], v[44:47], v[220:223], v[96:111]
    ds_read_b64_tr_b16 v[36:37], v11 offset:16640
    ds_read_b64_tr_b16 v[38:39], v11 offset:18720
    v_mul_f32 v62, v15, v62
    v_mul_f32 v63, v15, v63
    v_cvt_pk_bf16_f32 v150, v60, v61
    v_mul_f32 v64, v15, v64
    v_mul_f32 v65, v15, v65
    v_cvt_pk_bf16_f32 v151, v62, v63
    v_mul_f32 v66, v15, v66
    v_mul_f32 v67, v15, v67
    v_cvt_pk_bf16_f32 v152, v64, v65
    v_mul_f32 v68, v15, v68
    s_waitcnt lgkmcnt(8)
    v_mfma_f32_32x32x16_bf16 a[0:15], v[16:19], v[144:147], a[0:15]
    ds_read_b64_tr_b16 v[40:41], v11 offset:33280
    ds_read_b64_tr_b16 v[42:43], v11 offset:35360
    v_mul_f32 v69, v15, v69
    v_cvt_pk_bf16_f32 v153, v66, v67
    v_mul_f32 v70, v15, v70
    v_mul_f32 v71, v15, v71
    v_cvt_pk_bf16_f32 v154, v68, v69
    v_mul_f32 v72, v15, v72
    v_mul_f32 v73, v15, v73
    v_cvt_pk_bf16_f32 v155, v70, v71
    v_mul_f32 v74, v15, v74
    v_mfma_f32_32x32x16_bf16 a[0:15], v[20:23], v[148:151], a[0:15]
    ds_read_b64_tr_b16 v[44:45], v10 offset:0
    ds_read_b64_tr_b16 v[46:47], v10 offset:2080
    v_mul_f32 v75, v15, v75
    v_cvt_pk_bf16_f32 v156, v72, v73
    v_mul_f32 v76, v15, v76
    v_mul_f32 v77, v15, v77
    v_cvt_pk_bf16_f32 v157, v74, v75
    v_mul_f32 v78, v15, v78
    v_mul_f32 v79, v15, v79
    v_cvt_pk_bf16_f32 v158, v76, v77
    v_mul_f32 v80, v15, v80
    v_mul_f32 v81, v15, v81
    s_waitcnt lgkmcnt(8)
    v_mfma_f32_32x32x16_bf16 a[0:15], v[24:27], v[152:155], a[0:15]
    ds_read_b64_tr_b16 v[16:17], v3 offset:64
    ds_read_b64_tr_b16 v[18:19], v3 offset:2144
    v_cvt_pk_bf16_f32 v159, v78, v79
    v_mul_f32 v82, v15, v82
    v_mul_f32 v83, v15, v83
    v_cvt_pk_bf16_f32 v160, v80, v81
    v_mul_f32 v84, v15, v84
    v_mul_f32 v85, v15, v85
    v_cvt_pk_bf16_f32 v161, v82, v83
    v_mul_f32 v86, v15, v86
    v_mul_f32 v87, v15, v87
    v_mfma_f32_32x32x16_bf16 a[0:15], v[28:31], v[156:159], a[0:15]
    ds_read_b64_tr_b16 v[20:21], v3 offset:16704
    ds_read_b64_tr_b16 v[22:23], v3 offset:18784
    v_cvt_pk_bf16_f32 v162, v84, v85
    v_mul_f32 v88, v15, v88
    v_mul_f32 v89, v15, v89
    v_cvt_pk_bf16_f32 v163, v86, v87
    v_mul_f32 v90, v15, v90
    v_mul_f32 v91, v15, v91
    v_cvt_pk_bf16_f32 v164, v88, v89
    v_mul_f32 v92, v15, v92
    v_mul_f32 v93, v15, v93
    v_cvt_pk_bf16_f32 v165, v90, v91
    s_waitcnt lgkmcnt(8)
    v_mfma_f32_32x32x16_bf16 a[0:15], v[32:35], v[160:163], a[0:15]
    ds_read_b64_tr_b16 v[24:25], v3 offset:33344
    ds_read_b64_tr_b16 v[26:27], v3 offset:35424
    v_mul_f32 v94, v15, v94
    v_mul_f32 v95, v15, v95
    v_cvt_pk_bf16_f32 v166, v92, v93
    v_mul_f32 v96, v15, v96
    v_mul_f32 v97, v15, v97
    v_cvt_pk_bf16_f32 v167, v94, v95
    v_mul_f32 v98, v15, v98
    v_mul_f32 v99, v15, v99
    v_cvt_pk_bf16_f32 v168, v96, v97
    v_mfma_f32_32x32x16_bf16 a[0:15], v[36:39], v[164:167], a[0:15]
    ds_read_b64_tr_b16 v[28:29], v3 offset:49984
    ds_read_b64_tr_b16 v[30:31], v3 offset:52064
    v_mul_f32 v100, v15, v100
    v_mul_f32 v101, v15, v101
    v_cvt_pk_bf16_f32 v169, v98, v99
    v_mul_f32 v102, v15, v102
    v_mul_f32 v103, v15, v103
    v_cvt_pk_bf16_f32 v170, v100, v101
    v_mul_f32 v104, v15, v104
    v_mul_f32 v105, v15, v105
    v_cvt_pk_bf16_f32 v171, v102, v103
    v_mul_f32 v106, v15, v106
    s_waitcnt lgkmcnt(8)
    v_mfma_f32_32x32x16_bf16 a[0:15], v[40:43], v[168:171], a[0:15]
    ds_read_b64_tr_b16 v[32:33], v11 offset:64
    ds_read_b64_tr_b16 v[34:35], v11 offset:2144
    v_mul_f32 v107, v15, v107
    v_cvt_pk_bf16_f32 v172, v104, v105
    v_mul_f32 v108, v15, v108
    v_mul_f32 v109, v15, v109
    v_cvt_pk_bf16_f32 v173, v106, v107
    v_mul_f32 v110, v15, v110
    v_mul_f32 v111, v15, v111
    v_cvt_pk_bf16_f32 v174, v108, v109
    v_cvt_pk_bf16_f32 v175, v110, v111
    s_nop 1
    v_mfma_f32_32x32x16_bf16 a[0:15], v[44:47], v[172:175], a[0:15]
    ds_read_b64_tr_b16 v[36:37], v11 offset:16704
    ds_read_b64_tr_b16 v[38:39], v11 offset:18784
    s_waitcnt lgkmcnt(8)
    v_mfma_f32_32x32x16_bf16 a[16:31], v[16:19], v[144:147], a[16:31]
    ds_read_b64_tr_b16 v[40:41], v11 offset:33344
    ds_read_b64_tr_b16 v[42:43], v11 offset:35424
    v_mfma_f32_32x32x16_bf16 a[16:31], v[20:23], v[148:151], a[16:31]
    ds_read_b64_tr_b16 v[44:45], v10 offset:64
    ds_read_b64_tr_b16 v[46:47], v10 offset:2144
    s_nop 2
    v_accvgpr_read_b32 v176, a0
    v_accvgpr_read_b32 v177, a1
    v_accvgpr_read_b32 v178, a2
    v_accvgpr_read_b32 v179, a3
    s_waitcnt lgkmcnt(8)
    v_mfma_f32_32x32x16_bf16 a[16:31], v[24:27], v[152:155], a[16:31]
    ds_read_b64_tr_b16 v[16:17], v3 offset:128
    ds_read_b64_tr_b16 v[18:19], v3 offset:2208
    v_accvgpr_read_b32 v180, a4
    v_accvgpr_read_b32 v181, a5
    v_accvgpr_read_b32 v182, a6
    v_accvgpr_read_b32 v183, a7
    v_mfma_f32_32x32x16_bf16 a[16:31], v[28:31], v[156:159], a[16:31]
    ds_read_b64_tr_b16 v[20:21], v3 offset:16768
    ds_read_b64_tr_b16 v[22:23], v3 offset:18848
    v_accvgpr_read_b32 v184, a8
    v_accvgpr_read_b32 v185, a9
    v_accvgpr_read_b32 v186, a10
    v_accvgpr_read_b32 v187, a11
    s_waitcnt lgkmcnt(8)
    v_mfma_f32_32x32x16_bf16 a[16:31], v[32:35], v[160:163], a[16:31]
    ds_read_b64_tr_b16 v[24:25], v3 offset:33408
    ds_read_b64_tr_b16 v[26:27], v3 offset:35488
    v_accvgpr_read_b32 v188, a12
    v_accvgpr_read_b32 v189, a13
    v_accvgpr_read_b32 v190, a14
    v_accvgpr_read_b32 v191, a15
    v_mfma_f32_32x32x16_bf16 a[16:31], v[36:39], v[164:167], a[16:31]
    ds_read_b64_tr_b16 v[28:29], v3 offset:50048
    ds_read_b64_tr_b16 v[30:31], v3 offset:52128
    v_cvt_pk_bf16_f32 v176, v176, v177
    v_cvt_pk_bf16_f32 v177, v178, v179
    v_cvt_pk_bf16_f32 v178, v180, v181
    v_cvt_pk_bf16_f32 v179, v182, v183
    s_waitcnt lgkmcnt(8)
    v_mfma_f32_32x32x16_bf16 a[16:31], v[40:43], v[168:171], a[16:31]
    ds_read_b64_tr_b16 v[32:33], v11 offset:128
    ds_read_b64_tr_b16 v[34:35], v11 offset:2208
    v_cvt_pk_bf16_f32 v180, v184, v185
    v_cvt_pk_bf16_f32 v181, v186, v187
    v_cvt_pk_bf16_f32 v182, v188, v189
    v_cvt_pk_bf16_f32 v183, v190, v191
    v_mfma_f32_32x32x16_bf16 a[16:31], v[44:47], v[172:175], a[16:31]
    ds_read_b64_tr_b16 v[36:37], v11 offset:16768
    ds_read_b64_tr_b16 v[38:39], v11 offset:18848
    s_add_u32 s4, s3, 0
    buffer_store_dwordx4 v[176:179], v12, s[28:31], s4 offen offset:0 sc1
    buffer_store_dwordx4 v[180:183], v12, s[28:31], s4 offen offset:1024 sc1
    s_waitcnt lgkmcnt(8)
    v_mfma_f32_32x32x16_bf16 a[32:47], v[16:19], v[144:147], a[32:47]
    ds_read_b64_tr_b16 v[40:41], v11 offset:33408
    ds_read_b64_tr_b16 v[42:43], v11 offset:35488
    v_mfma_f32_32x32x16_bf16 a[32:47], v[20:23], v[148:151], a[32:47]
    ds_read_b64_tr_b16 v[44:45], v10 offset:128
    ds_read_b64_tr_b16 v[46:47], v10 offset:2208
    v_accvgpr_read_b32 v192, a16
    v_accvgpr_read_b32 v193, a17
    v_accvgpr_read_b32 v194, a18
    v_accvgpr_read_b32 v195, a19
    s_waitcnt lgkmcnt(8)
    v_mfma_f32_32x32x16_bf16 a[32:47], v[24:27], v[152:155], a[32:47]
    ds_read_b64_tr_b16 v[16:17], v3 offset:192
    ds_read_b64_tr_b16 v[18:19], v3 offset:2272
    v_accvgpr_read_b32 v196, a20
    v_accvgpr_read_b32 v197, a21
    v_accvgpr_read_b32 v198, a22
    v_accvgpr_read_b32 v199, a23
    v_mfma_f32_32x32x16_bf16 a[32:47], v[28:31], v[156:159], a[32:47]
    ds_read_b64_tr_b16 v[20:21], v3 offset:16832
    ds_read_b64_tr_b16 v[22:23], v3 offset:18912
    v_accvgpr_read_b32 v200, a24
    v_accvgpr_read_b32 v201, a25
    v_accvgpr_read_b32 v202, a26
    v_accvgpr_read_b32 v203, a27
    s_waitcnt lgkmcnt(8)
    v_mfma_f32_32x32x16_bf16 a[32:47], v[32:35], v[160:163], a[32:47]
    ds_read_b64_tr_b16 v[24:25], v3 offset:33472
    ds_read_b64_tr_b16 v[26:27], v3 offset:35552
    v_accvgpr_read_b32 v204, a28
    v_accvgpr_read_b32 v205, a29
    v_accvgpr_read_b32 v206, a30
    v_accvgpr_read_b32 v207, a31
    v_mfma_f32_32x32x16_bf16 a[32:47], v[36:39], v[164:167], a[32:47]
    ds_read_b64_tr_b16 v[28:29], v3 offset:50112
    ds_read_b64_tr_b16 v[30:31], v3 offset:52192
    v_cvt_pk_bf16_f32 v192, v192, v193
    v_cvt_pk_bf16_f32 v193, v194, v195
    v_cvt_pk_bf16_f32 v194, v196, v197
    v_cvt_pk_bf16_f32 v195, v198, v199
    s_waitcnt lgkmcnt(8)
    v_mfma_f32_32x32x16_bf16 a[32:47], v[40:43], v[168:171], a[32:47]
    ds_read_b64_tr_b16 v[32:33], v11 offset:192
    ds_read_b64_tr_b16 v[34:35], v11 offset:2272
    v_cvt_pk_bf16_f32 v196, v200, v201
    v_cvt_pk_bf16_f32 v197, v202, v203
    v_cvt_pk_bf16_f32 v198, v204, v205
    v_cvt_pk_bf16_f32 v199, v206, v207
    v_mfma_f32_32x32x16_bf16 a[32:47], v[44:47], v[172:175], a[32:47]
    ds_read_b64_tr_b16 v[36:37], v11 offset:16832
    ds_read_b64_tr_b16 v[38:39], v11 offset:18912
    buffer_store_dwordx4 v[192:195], v12, s[28:31], s4 offen offset:2048 sc1
    buffer_store_dwordx4 v[196:199], v12, s[28:31], s4 offen offset:3072 sc1
    s_waitcnt lgkmcnt(8)
    v_mfma_f32_32x32x16_bf16 a[48:63], v[16:19], v[144:147], a[48:63]
    ds_read_b64_tr_b16 v[40:41], v11 offset:33472
    ds_read_b64_tr_b16 v[42:43], v11 offset:35552
    v_mfma_f32_32x32x16_bf16 a[48:63], v[20:23], v[148:151], a[48:63]
    ds_read_b64_tr_b16 v[44:45], v10 offset:192
    ds_read_b64_tr_b16 v[46:47], v10 offset:2272
    s_nop 0
    v_accvgpr_read_b32 v208, a32
    v_accvgpr_read_b32 v209, a33
    v_accvgpr_read_b32 v210, a34
    v_accvgpr_read_b32 v211, a35
    s_waitcnt lgkmcnt(8)
    v_mfma_f32_32x32x16_bf16 a[48:63], v[24:27], v[152:155], a[48:63]
    ds_read_b64_tr_b16 v[16:17], v3 offset:256
    ds_read_b64_tr_b16 v[18:19], v3 offset:2336
    v_accvgpr_read_b32 v212, a36
    v_accvgpr_read_b32 v213, a37
    v_accvgpr_read_b32 v214, a38
    v_accvgpr_read_b32 v215, a39
    v_mfma_f32_32x32x16_bf16 a[48:63], v[28:31], v[156:159], a[48:63]
    ds_read_b64_tr_b16 v[20:21], v3 offset:16896
    ds_read_b64_tr_b16 v[22:23], v3 offset:18976
    v_accvgpr_read_b32 v216, a40
    v_accvgpr_read_b32 v217, a41
    v_accvgpr_read_b32 v218, a42
    v_accvgpr_read_b32 v219, a43
    s_waitcnt lgkmcnt(8)
    v_mfma_f32_32x32x16_bf16 a[48:63], v[32:35], v[160:163], a[48:63]
    ds_read_b64_tr_b16 v[24:25], v3 offset:33536
    ds_read_b64_tr_b16 v[26:27], v3 offset:35616
    v_accvgpr_read_b32 v220, a44
    v_accvgpr_read_b32 v221, a45
    v_accvgpr_read_b32 v222, a46
    v_accvgpr_read_b32 v223, a47
    v_mfma_f32_32x32x16_bf16 a[48:63], v[36:39], v[164:167], a[48:63]
    ds_read_b64_tr_b16 v[28:29], v3 offset:50176
    ds_read_b64_tr_b16 v[30:31], v3 offset:52256
    v_cvt_pk_bf16_f32 v208, v208, v209
    v_cvt_pk_bf16_f32 v209, v210, v211
    v_cvt_pk_bf16_f32 v210, v212, v213
    v_cvt_pk_bf16_f32 v211, v214, v215
    s_waitcnt lgkmcnt(8)
    v_mfma_f32_32x32x16_bf16 a[48:63], v[40:43], v[168:171], a[48:63]
    ds_read_b64_tr_b16 v[32:33], v11 offset:256
    ds_read_b64_tr_b16 v[34:35], v11 offset:2336
    v_cvt_pk_bf16_f32 v212, v216, v217
    v_cvt_pk_bf16_f32 v213, v218, v219
    v_cvt_pk_bf16_f32 v214, v220, v221
    v_cvt_pk_bf16_f32 v215, v222, v223
    v_mfma_f32_32x32x16_bf16 a[48:63], v[44:47], v[172:175], a[48:63]
    ds_read_b64_tr_b16 v[36:37], v11 offset:16896
    ds_read_b64_tr_b16 v[38:39], v11 offset:18976
    s_add_u32 s4, s3, 4096
    buffer_store_dwordx4 v[208:211], v12, s[28:31], s4 offen offset:0 sc1
    buffer_store_dwordx4 v[212:215], v12, s[28:31], s4 offen offset:1024 sc1
    s_waitcnt lgkmcnt(8)
    v_mfma_f32_32x32x16_bf16 a[64:79], v[16:19], v[144:147], a[64:79]
    ds_read_b64_tr_b16 v[40:41], v11 offset:33536
    ds_read_b64_tr_b16 v[42:43], v11 offset:35616
    v_mfma_f32_32x32x16_bf16 a[64:79], v[20:23], v[148:151], a[64:79]
    ds_read_b64_tr_b16 v[44:45], v10 offset:256
    ds_read_b64_tr_b16 v[46:47], v10 offset:2336
    v_accvgpr_read_b32 v224, a48
    v_accvgpr_read_b32 v225, a49
    v_accvgpr_read_b32 v226, a50
    v_accvgpr_read_b32 v227, a51
    s_waitcnt lgkmcnt(8)
    v_mfma_f32_32x32x16_bf16 a[64:79], v[24:27], v[152:155], a[64:79]
    ds_read_b64_tr_b16 v[16:17], v3 offset:320
    ds_read_b64_tr_b16 v[18:19], v3 offset:2400
    v_accvgpr_read_b32 v228, a52
    v_accvgpr_read_b32 v229, a53
    v_accvgpr_read_b32 v230, a54
    v_accvgpr_read_b32 v231, a55
    v_mfma_f32_32x32x16_bf16 a[64:79], v[28:31], v[156:159], a[64:79]
    ds_read_b64_tr_b16 v[20:21], v3 offset:16960
    ds_read_b64_tr_b16 v[22:23], v3 offset:19040
    v_accvgpr_read_b32 v232, a56
    v_accvgpr_read_b32 v233, a57
    v_accvgpr_read_b32 v234, a58
    v_accvgpr_read_b32 v235, a59
    s_waitcnt lgkmcnt(8)
    v_mfma_f32_32x32x16_bf16 a[64:79], v[32:35], v[160:163], a[64:79]
    ds_read_b64_tr_b16 v[24:25], v3 offset:33600
    ds_read_b64_tr_b16 v[26:27], v3 offset:35680
    v_accvgpr_read_b32 v236, a60
    v_accvgpr_read_b32 v237, a61
    v_accvgpr_read_b32 v238, a62
    v_accvgpr_read_b32 v239, a63
    v_mfma_f32_32x32x16_bf16 a[64:79], v[36:39], v[164:167], a[64:79]
    ds_read_b64_tr_b16 v[28:29], v3 offset:50240
    ds_read_b64_tr_b16 v[30:31], v3 offset:52320
    v_cvt_pk_bf16_f32 v224, v224, v225
    v_cvt_pk_bf16_f32 v225, v226, v227
    v_cvt_pk_bf16_f32 v226, v228, v229
    v_cvt_pk_bf16_f32 v227, v230, v231
    s_waitcnt lgkmcnt(8)
    v_mfma_f32_32x32x16_bf16 a[64:79], v[40:43], v[168:171], a[64:79]
    ds_read_b64_tr_b16 v[32:33], v11 offset:320
    ds_read_b64_tr_b16 v[34:35], v11 offset:2400
    v_cvt_pk_bf16_f32 v228, v232, v233
    v_cvt_pk_bf16_f32 v229, v234, v235
    v_cvt_pk_bf16_f32 v230, v236, v237
    v_cvt_pk_bf16_f32 v231, v238, v239
    v_mfma_f32_32x32x16_bf16 a[64:79], v[44:47], v[172:175], a[64:79]
    ds_read_b64_tr_b16 v[36:37], v11 offset:16960
    ds_read_b64_tr_b16 v[38:39], v11 offset:19040
    buffer_store_dwordx4 v[224:227], v12, s[28:31], s4 offen offset:2048 sc1
    buffer_store_dwordx4 v[228:231], v12, s[28:31], s4 offen offset:3072 sc1
    s_waitcnt lgkmcnt(8)
    v_mfma_f32_32x32x16_bf16 a[80:95], v[16:19], v[144:147], a[80:95]
    ds_read_b64_tr_b16 v[40:41], v11 offset:33600
    ds_read_b64_tr_b16 v[42:43], v11 offset:35680
    v_mfma_f32_32x32x16_bf16 a[80:95], v[20:23], v[148:151], a[80:95]
    ds_read_b64_tr_b16 v[44:45], v10 offset:320
    ds_read_b64_tr_b16 v[46:47], v10 offset:2400
    s_nop 0
    v_accvgpr_read_b32 v176, a64
    v_accvgpr_read_b32 v177, a65
    v_accvgpr_read_b32 v178, a66
    v_accvgpr_read_b32 v179, a67
    s_waitcnt lgkmcnt(8)
    v_mfma_f32_32x32x16_bf16 a[80:95], v[24:27], v[152:155], a[80:95]
    ds_read_b64_tr_b16 v[16:17], v3 offset:384
    ds_read_b64_tr_b16 v[18:19], v3 offset:2464
    v_accvgpr_read_b32 v180, a68
    v_accvgpr_read_b32 v181, a69
    v_accvgpr_read_b32 v182, a70
    v_accvgpr_read_b32 v183, a71
    v_mfma_f32_32x32x16_bf16 a[80:95], v[28:31], v[156:159], a[80:95]
    ds_read_b64_tr_b16 v[20:21], v3 offset:17024
    ds_read_b64_tr_b16 v[22:23], v3 offset:19104
    v_accvgpr_read_b32 v184, a72
    v_accvgpr_read_b32 v185, a73
    v_accvgpr_read_b32 v186, a74
    v_accvgpr_read_b32 v187, a75
    s_waitcnt lgkmcnt(8)
    v_mfma_f32_32x32x16_bf16 a[80:95], v[32:35], v[160:163], a[80:95]
    ds_read_b64_tr_b16 v[24:25], v3 offset:33664
    ds_read_b64_tr_b16 v[26:27], v3 offset:35744
    v_accvgpr_read_b32 v188, a76
    v_accvgpr_read_b32 v189, a77
    v_accvgpr_read_b32 v190, a78
    v_accvgpr_read_b32 v191, a79
    v_mfma_f32_32x32x16_bf16 a[80:95], v[36:39], v[164:167], a[80:95]
    ds_read_b64_tr_b16 v[28:29], v3 offset:50304
    ds_read_b64_tr_b16 v[30:31], v3 offset:52384
    v_cvt_pk_bf16_f32 v176, v176, v177
    v_cvt_pk_bf16_f32 v177, v178, v179
    v_cvt_pk_bf16_f32 v178, v180, v181
    v_cvt_pk_bf16_f32 v179, v182, v183
    s_waitcnt lgkmcnt(8)
    v_mfma_f32_32x32x16_bf16 a[80:95], v[40:43], v[168:171], a[80:95]
    ds_read_b64_tr_b16 v[32:33], v11 offset:384
    ds_read_b64_tr_b16 v[34:35], v11 offset:2464
    v_cvt_pk_bf16_f32 v180, v184, v185
    v_cvt_pk_bf16_f32 v181, v186, v187
    v_cvt_pk_bf16_f32 v182, v188, v189
    v_cvt_pk_bf16_f32 v183, v190, v191
    v_mfma_f32_32x32x16_bf16 a[80:95], v[44:47], v[172:175], a[80:95]
    ds_read_b64_tr_b16 v[36:37], v11 offset:17024
    ds_read_b64_tr_b16 v[38:39], v11 offset:19104
    s_add_u32 s4, s3, 8192
    buffer_store_dwordx4 v[176:179], v12, s[28:31], s4 offen offset:0 sc1
    buffer_store_dwordx4 v[180:183], v12, s[28:31], s4 offen offset:1024 sc1
    s_waitcnt lgkmcnt(8)
    v_mfma_f32_32x32x16_bf16 a[96:111], v[16:19], v[144:147], a[96:111]
    ds_read_b64_tr_b16 v[40:41], v11 offset:33664
    ds_read_b64_tr_b16 v[42:43], v11 offset:35744
    v_mfma_f32_32x32x16_bf16 a[96:111], v[20:23], v[148:151], a[96:111]
    ds_read_b64_tr_b16 v[44:45], v10 offset:384
    ds_read_b64_tr_b16 v[46:47], v10 offset:2464
    v_accvgpr_read_b32 v192, a80
    v_accvgpr_read_b32 v193, a81
    v_accvgpr_read_b32 v194, a82
    v_accvgpr_read_b32 v195, a83
    s_waitcnt lgkmcnt(8)
    v_mfma_f32_32x32x16_bf16 a[96:111], v[24:27], v[152:155], a[96:111]
    ds_read_b64_tr_b16 v[16:17], v3 offset:448
    ds_read_b64_tr_b16 v[18:19], v3 offset:2528
    v_accvgpr_read_b32 v196, a84
    v_accvgpr_read_b32 v197, a85
    v_accvgpr_read_b32 v198, a86
    v_accvgpr_read_b32 v199, a87
    v_mfma_f32_32x32x16_bf16 a[96:111], v[28:31], v[156:159], a[96:111]
    ds_read_b64_tr_b16 v[20:21], v3 offset:17088
    ds_read_b64_tr_b16 v[22:23], v3 offset:19168
    v_accvgpr_read_b32 v200, a88
    v_accvgpr_read_b32 v201, a89
    v_accvgpr_read_b32 v202, a90
    v_accvgpr_read_b32 v203, a91
    s_waitcnt lgkmcnt(8)
    v_mfma_f32_32x32x16_bf16 a[96:111], v[32:35], v[160:163], a[96:111]
    ds_read_b64_tr_b16 v[24:25], v3 offset:33728
    ds_read_b64_tr_b16 v[26:27], v3 offset:35808
    v_accvgpr_read_b32 v204, a92
    v_accvgpr_read_b32 v205, a93
    v_accvgpr_read_b32 v206, a94
    v_accvgpr_read_b32 v207, a95
    v_mfma_f32_32x32x16_bf16 a[96:111], v[36:39], v[164:167], a[96:111]
    ds_read_b64_tr_b16 v[28:29], v3 offset:50368
    ds_read_b64_tr_b16 v[30:31], v3 offset:52448
    v_cvt_pk_bf16_f32 v192, v192, v193
    v_cvt_pk_bf16_f32 v193, v194, v195
    v_cvt_pk_bf16_f32 v194, v196, v197
    v_cvt_pk_bf16_f32 v195, v198, v199
    s_waitcnt lgkmcnt(8)
    v_mfma_f32_32x32x16_bf16 a[96:111], v[40:43], v[168:171], a[96:111]
    ds_read_b64_tr_b16 v[32:33], v11 offset:448
    ds_read_b64_tr_b16 v[34:35], v11 offset:2528
    v_cvt_pk_bf16_f32 v196, v200, v201
    v_cvt_pk_bf16_f32 v197, v202, v203
    v_cvt_pk_bf16_f32 v198, v204, v205
    v_cvt_pk_bf16_f32 v199, v206, v207
    v_mfma_f32_32x32x16_bf16 a[96:111], v[44:47], v[172:175], a[96:111]
    ds_read_b64_tr_b16 v[36:37], v11 offset:17088
    ds_read_b64_tr_b16 v[38:39], v11 offset:19168
    buffer_store_dwordx4 v[192:195], v12, s[28:31], s4 offen offset:2048 sc1
    buffer_store_dwordx4 v[196:199], v12, s[28:31], s4 offen offset:3072 sc1
    s_waitcnt lgkmcnt(8)
    v_mfma_f32_32x32x16_bf16 a[112:127], v[16:19], v[144:147], a[112:127]
    ds_read_b64_tr_b16 v[40:41], v11 offset:33728
    ds_read_b64_tr_b16 v[42:43], v11 offset:35808
    v_mfma_f32_32x32x16_bf16 a[112:127], v[20:23], v[148:151], a[112:127]
    ds_read_b64_tr_b16 v[44:45], v10 offset:448
    ds_read_b64_tr_b16 v[46:47], v10 offset:2528
    s_nop 0
    v_accvgpr_read_b32 v208, a96
    v_accvgpr_read_b32 v209, a97
    v_accvgpr_read_b32 v210, a98
    v_accvgpr_read_b32 v211, a99
    s_waitcnt lgkmcnt(8)
    v_mfma_f32_32x32x16_bf16 a[112:127], v[24:27], v[152:155], a[112:127]
    ds_read_b64_tr_b16 v[16:17], v3 offset:512
    ds_read_b64_tr_b16 v[18:19], v3 offset:2592
    v_accvgpr_read_b32 v212, a100
    v_accvgpr_read_b32 v213, a101
    v_accvgpr_read_b32 v214, a102
    v_accvgpr_read_b32 v215, a103
    v_mfma_f32_32x32x16_bf16 a[112:127], v[28:31], v[156:159], a[112:127]
    ds_read_b64_tr_b16 v[20:21], v3 offset:17152
    ds_read_b64_tr_b16 v[22:23], v3 offset:19232
    v_accvgpr_read_b32 v216, a104
    v_accvgpr_read_b32 v217, a105
    v_accvgpr_read_b32 v218, a106
    v_accvgpr_read_b32 v219, a107
    s_waitcnt lgkmcnt(8)
    v_mfma_f32_32x32x16_bf16 a[112:127], v[32:35], v[160:163], a[112:127]
    ds_read_b64_tr_b16 v[24:25], v3 offset:33792
    ds_read_b64_tr_b16 v[26:27], v3 offset:35872
    v_accvgpr_read_b32 v220, a108
    v_accvgpr_read_b32 v221, a109
    v_accvgpr_read_b32 v222, a110
    v_accvgpr_read_b32 v223, a111
    v_mfma_f32_32x32x16_bf16 a[112:127], v[36:39], v[164:167], a[112:127]
    ds_read_b64_tr_b16 v[28:29], v3 offset:50432
    ds_read_b64_tr_b16 v[30:31], v3 offset:52512
    v_cvt_pk_bf16_f32 v208, v208, v209
    v_cvt_pk_bf16_f32 v209, v210, v211
    v_cvt_pk_bf16_f32 v210, v212, v213
    v_cvt_pk_bf16_f32 v211, v214, v215
    s_waitcnt lgkmcnt(8)
    v_mfma_f32_32x32x16_bf16 a[112:127], v[40:43], v[168:171], a[112:127]
    ds_read_b64_tr_b16 v[32:33], v11 offset:512
    ds_read_b64_tr_b16 v[34:35], v11 offset:2592
    v_cvt_pk_bf16_f32 v212, v216, v217
    v_cvt_pk_bf16_f32 v213, v218, v219
    v_cvt_pk_bf16_f32 v214, v220, v221
    v_cvt_pk_bf16_f32 v215, v222, v223
    v_mfma_f32_32x32x16_bf16 a[112:127], v[44:47], v[172:175], a[112:127]
    ds_read_b64_tr_b16 v[36:37], v11 offset:17152
    ds_read_b64_tr_b16 v[38:39], v11 offset:19232
    s_add_u32 s4, s3, 12288
    buffer_store_dwordx4 v[208:211], v12, s[28:31], s4 offen offset:0 sc1
    buffer_store_dwordx4 v[212:215], v12, s[28:31], s4 offen offset:1024 sc1
    s_waitcnt lgkmcnt(8)
    v_mfma_f32_32x32x16_bf16 a[128:143], v[16:19], v[144:147], a[128:143]
    ds_read_b64_tr_b16 v[40:41], v11 offset:33792
    ds_read_b64_tr_b16 v[42:43], v11 offset:35872
    v_mfma_f32_32x32x16_bf16 a[128:143], v[20:23], v[148:151], a[128:143]
    ds_read_b64_tr_b16 v[44:45], v10 offset:512
    ds_read_b64_tr_b16 v[46:47], v10 offset:2592
    v_accvgpr_read_b32 v224, a112
    v_accvgpr_read_b32 v225, a113
    v_accvgpr_read_b32 v226, a114
    v_accvgpr_read_b32 v227, a115
    s_waitcnt lgkmcnt(8)
    v_mfma_f32_32x32x16_bf16 a[128:143], v[24:27], v[152:155], a[128:143]
    ds_read_b64_tr_b16 v[16:17], v3 offset:576
    ds_read_b64_tr_b16 v[18:19], v3 offset:2656
    v_accvgpr_read_b32 v228, a116
    v_accvgpr_read_b32 v229, a117
    v_accvgpr_read_b32 v230, a118
    v_accvgpr_read_b32 v231, a119
    v_mfma_f32_32x32x16_bf16 a[128:143], v[28:31], v[156:159], a[128:143]
    ds_read_b64_tr_b16 v[20:21], v3 offset:17216
    ds_read_b64_tr_b16 v[22:23], v3 offset:19296
    v_accvgpr_read_b32 v232, a120
    v_accvgpr_read_b32 v233, a121
    v_accvgpr_read_b32 v234, a122
    v_accvgpr_read_b32 v235, a123
    s_waitcnt lgkmcnt(8)
    v_mfma_f32_32x32x16_bf16 a[128:143], v[32:35], v[160:163], a[128:143]
    ds_read_b64_tr_b16 v[24:25], v3 offset:33856
    ds_read_b64_tr_b16 v[26:27], v3 offset:35936
    v_accvgpr_read_b32 v236, a124
    v_accvgpr_read_b32 v237, a125
    v_accvgpr_read_b32 v238, a126
    v_accvgpr_read_b32 v239, a127
    v_mfma_f32_32x32x16_bf16 a[128:143], v[36:39], v[164:167], a[128:143]
    ds_read_b64_tr_b16 v[28:29], v3 offset:50496
    ds_read_b64_tr_b16 v[30:31], v3 offset:52576
    v_cvt_pk_bf16_f32 v224, v224, v225
    v_cvt_pk_bf16_f32 v225, v226, v227
    v_cvt_pk_bf16_f32 v226, v228, v229
    v_cvt_pk_bf16_f32 v227, v230, v231
    s_waitcnt lgkmcnt(8)
    v_mfma_f32_32x32x16_bf16 a[128:143], v[40:43], v[168:171], a[128:143]
    ds_read_b64_tr_b16 v[32:33], v11 offset:576
    ds_read_b64_tr_b16 v[34:35], v11 offset:2656
    v_cvt_pk_bf16_f32 v228, v232, v233
    v_cvt_pk_bf16_f32 v229, v234, v235
    v_cvt_pk_bf16_f32 v230, v236, v237
    v_cvt_pk_bf16_f32 v231, v238, v239
    v_mfma_f32_32x32x16_bf16 a[128:143], v[44:47], v[172:175], a[128:143]
    ds_read_b64_tr_b16 v[36:37], v11 offset:17216
    ds_read_b64_tr_b16 v[38:39], v11 offset:19296
    buffer_store_dwordx4 v[224:227], v12, s[28:31], s4 offen offset:2048 sc1
    buffer_store_dwordx4 v[228:231], v12, s[28:31], s4 offen offset:3072 sc1
    s_waitcnt lgkmcnt(8)
    v_mfma_f32_32x32x16_bf16 a[144:159], v[16:19], v[144:147], a[144:159]
    ds_read_b64_tr_b16 v[40:41], v11 offset:33856
    ds_read_b64_tr_b16 v[42:43], v11 offset:35936
    v_mfma_f32_32x32x16_bf16 a[144:159], v[20:23], v[148:151], a[144:159]
    ds_read_b64_tr_b16 v[44:45], v10 offset:576
    ds_read_b64_tr_b16 v[46:47], v10 offset:2656
    s_nop 0
    v_accvgpr_read_b32 v176, a128
    v_accvgpr_read_b32 v177, a129
    v_accvgpr_read_b32 v178, a130
    v_accvgpr_read_b32 v179, a131
    s_waitcnt lgkmcnt(8)
    v_mfma_f32_32x32x16_bf16 a[144:159], v[24:27], v[152:155], a[144:159]
    ds_read_b64_tr_b16 v[16:17], v3 offset:640
    ds_read_b64_tr_b16 v[18:19], v3 offset:2720
    v_accvgpr_read_b32 v180, a132
    v_accvgpr_read_b32 v181, a133
    v_accvgpr_read_b32 v182, a134
    v_accvgpr_read_b32 v183, a135
    v_mfma_f32_32x32x16_bf16 a[144:159], v[28:31], v[156:159], a[144:159]
    ds_read_b64_tr_b16 v[20:21], v3 offset:17280
    ds_read_b64_tr_b16 v[22:23], v3 offset:19360
    v_accvgpr_read_b32 v184, a136
    v_accvgpr_read_b32 v185, a137
    v_accvgpr_read_b32 v186, a138
    v_accvgpr_read_b32 v187, a139
    s_waitcnt lgkmcnt(8)
    v_mfma_f32_32x32x16_bf16 a[144:159], v[32:35], v[160:163], a[144:159]
    ds_read_b64_tr_b16 v[24:25], v3 offset:33920
    ds_read_b64_tr_b16 v[26:27], v3 offset:36000
    v_accvgpr_read_b32 v188, a140
    v_accvgpr_read_b32 v189, a141
    v_accvgpr_read_b32 v190, a142
    v_accvgpr_read_b32 v191, a143
    v_mfma_f32_32x32x16_bf16 a[144:159], v[36:39], v[164:167], a[144:159]
    ds_read_b64_tr_b16 v[28:29], v3 offset:50560
    ds_read_b64_tr_b16 v[30:31], v3 offset:52640
    v_cvt_pk_bf16_f32 v176, v176, v177
    v_cvt_pk_bf16_f32 v177, v178, v179
    v_cvt_pk_bf16_f32 v178, v180, v181
    v_cvt_pk_bf16_f32 v179, v182, v183
    s_waitcnt lgkmcnt(8)
    v_mfma_f32_32x32x16_bf16 a[144:159], v[40:43], v[168:171], a[144:159]
    ds_read_b64_tr_b16 v[32:33], v11 offset:640
    ds_read_b64_tr_b16 v[34:35], v11 offset:2720
    v_cvt_pk_bf16_f32 v180, v184, v185
    v_cvt_pk_bf16_f32 v181, v186, v187
    v_cvt_pk_bf16_f32 v182, v188, v189
    v_cvt_pk_bf16_f32 v183, v190, v191
    v_mfma_f32_32x32x16_bf16 a[144:159], v[44:47], v[172:175], a[144:159]
    ds_read_b64_tr_b16 v[36:37], v11 offset:17280
    ds_read_b64_tr_b16 v[38:39], v11 offset:19360
    s_add_u32 s4, s3, 16384
    buffer_store_dwordx4 v[176:179], v12, s[28:31], s4 offen offset:0 sc1
    buffer_store_dwordx4 v[180:183], v12, s[28:31], s4 offen offset:1024 sc1
    s_waitcnt lgkmcnt(8)
    v_mfma_f32_32x32x16_bf16 a[160:175], v[16:19], v[144:147], a[160:175]
    ds_read_b64_tr_b16 v[40:41], v11 offset:33920
    ds_read_b64_tr_b16 v[42:43], v11 offset:36000
    v_mfma_f32_32x32x16_bf16 a[160:175], v[20:23], v[148:151], a[160:175]
    ds_read_b64_tr_b16 v[44:45], v10 offset:640
    ds_read_b64_tr_b16 v[46:47], v10 offset:2720
    v_accvgpr_read_b32 v192, a144
    v_accvgpr_read_b32 v193, a145
    v_accvgpr_read_b32 v194, a146
    v_accvgpr_read_b32 v195, a147
    s_waitcnt lgkmcnt(8)
    v_mfma_f32_32x32x16_bf16 a[160:175], v[24:27], v[152:155], a[160:175]
    ds_read_b64_tr_b16 v[16:17], v3 offset:704
    ds_read_b64_tr_b16 v[18:19], v3 offset:2784
    v_accvgpr_read_b32 v196, a148
    v_accvgpr_read_b32 v197, a149
    v_accvgpr_read_b32 v198, a150
    v_accvgpr_read_b32 v199, a151
    v_mfma_f32_32x32x16_bf16 a[160:175], v[28:31], v[156:159], a[160:175]
    ds_read_b64_tr_b16 v[20:21], v3 offset:17344
    ds_read_b64_tr_b16 v[22:23], v3 offset:19424
    v_accvgpr_read_b32 v200, a152
    v_accvgpr_read_b32 v201, a153
    v_accvgpr_read_b32 v202, a154
    v_accvgpr_read_b32 v203, a155
    s_waitcnt lgkmcnt(8)
    v_mfma_f32_32x32x16_bf16 a[160:175], v[32:35], v[160:163], a[160:175]
    ds_read_b64_tr_b16 v[24:25], v3 offset:33984
    ds_read_b64_tr_b16 v[26:27], v3 offset:36064
    v_accvgpr_read_b32 v204, a156
    v_accvgpr_read_b32 v205, a157
    v_accvgpr_read_b32 v206, a158
    v_accvgpr_read_b32 v207, a159
    v_mfma_f32_32x32x16_bf16 a[160:175], v[36:39], v[164:167], a[160:175]
    ds_read_b64_tr_b16 v[28:29], v3 offset:50624
    ds_read_b64_tr_b16 v[30:31], v3 offset:52704
    v_cvt_pk_bf16_f32 v192, v192, v193
    v_cvt_pk_bf16_f32 v193, v194, v195
    v_cvt_pk_bf16_f32 v194, v196, v197
    v_cvt_pk_bf16_f32 v195, v198, v199
    s_waitcnt lgkmcnt(8)
    v_mfma_f32_32x32x16_bf16 a[160:175], v[40:43], v[168:171], a[160:175]
    ds_read_b64_tr_b16 v[32:33], v11 offset:704
    ds_read_b64_tr_b16 v[34:35], v11 offset:2784
    v_cvt_pk_bf16_f32 v196, v200, v201
    v_cvt_pk_bf16_f32 v197, v202, v203
    v_cvt_pk_bf16_f32 v198, v204, v205
    v_cvt_pk_bf16_f32 v199, v206, v207
    v_mfma_f32_32x32x16_bf16 a[160:175], v[44:47], v[172:175], a[160:175]
    ds_read_b64_tr_b16 v[36:37], v11 offset:17344
    ds_read_b64_tr_b16 v[38:39], v11 offset:19424
    buffer_store_dwordx4 v[192:195], v12, s[28:31], s4 offen offset:2048 sc1
    buffer_store_dwordx4 v[196:199], v12, s[28:31], s4 offen offset:3072 sc1
    s_waitcnt lgkmcnt(8)
    v_mfma_f32_32x32x16_bf16 a[176:191], v[16:19], v[144:147], a[176:191]
    ds_read_b64_tr_b16 v[40:41], v11 offset:33984
    ds_read_b64_tr_b16 v[42:43], v11 offset:36064
    v_mfma_f32_32x32x16_bf16 a[176:191], v[20:23], v[148:151], a[176:191]
    ds_read_b64_tr_b16 v[44:45], v10 offset:704
    ds_read_b64_tr_b16 v[46:47], v10 offset:2784
    s_nop 0
    v_accvgpr_read_b32 v208, a160
    v_accvgpr_read_b32 v209, a161
    v_accvgpr_read_b32 v210, a162
    v_accvgpr_read_b32 v211, a163
    s_waitcnt lgkmcnt(8)
    v_mfma_f32_32x32x16_bf16 a[176:191], v[24:27], v[152:155], a[176:191]
    ds_read_b64_tr_b16 v[16:17], v3 offset:768
    ds_read_b64_tr_b16 v[18:19], v3 offset:2848
    v_accvgpr_read_b32 v212, a164
    v_accvgpr_read_b32 v213, a165
    v_accvgpr_read_b32 v214, a166
    v_accvgpr_read_b32 v215, a167
    v_mfma_f32_32x32x16_bf16 a[176:191], v[28:31], v[156:159], a[176:191]
    ds_read_b64_tr_b16 v[20:21], v3 offset:17408
    ds_read_b64_tr_b16 v[22:23], v3 offset:19488
    v_accvgpr_read_b32 v216, a168
    v_accvgpr_read_b32 v217, a169
    v_accvgpr_read_b32 v218, a170
    v_accvgpr_read_b32 v219, a171
    s_waitcnt lgkmcnt(8)
    v_mfma_f32_32x32x16_bf16 a[176:191], v[32:35], v[160:163], a[176:191]
    ds_read_b64_tr_b16 v[24:25], v3 offset:34048
    ds_read_b64_tr_b16 v[26:27], v3 offset:36128
    v_accvgpr_read_b32 v220, a172
    v_accvgpr_read_b32 v221, a173
    v_accvgpr_read_b32 v222, a174
    v_accvgpr_read_b32 v223, a175
    v_mfma_f32_32x32x16_bf16 a[176:191], v[36:39], v[164:167], a[176:191]
    ds_read_b64_tr_b16 v[28:29], v3 offset:50688
    ds_read_b64_tr_b16 v[30:31], v3 offset:52768
    v_cvt_pk_bf16_f32 v208, v208, v209
    v_cvt_pk_bf16_f32 v209, v210, v211
    v_cvt_pk_bf16_f32 v210, v212, v213
    v_cvt_pk_bf16_f32 v211, v214, v215
    s_waitcnt lgkmcnt(8)
    v_mfma_f32_32x32x16_bf16 a[176:191], v[40:43], v[168:171], a[176:191]
    ds_read_b64_tr_b16 v[32:33], v11 offset:768
    ds_read_b64_tr_b16 v[34:35], v11 offset:2848
    v_cvt_pk_bf16_f32 v212, v216, v217
    v_cvt_pk_bf16_f32 v213, v218, v219
    v_cvt_pk_bf16_f32 v214, v220, v221
    v_cvt_pk_bf16_f32 v215, v222, v223
    v_mfma_f32_32x32x16_bf16 a[176:191], v[44:47], v[172:175], a[176:191]
    ds_read_b64_tr_b16 v[36:37], v11 offset:17408
    ds_read_b64_tr_b16 v[38:39], v11 offset:19488
    s_add_u32 s4, s3, 20480
    buffer_store_dwordx4 v[208:211], v12, s[28:31], s4 offen offset:0 sc1
    buffer_store_dwordx4 v[212:215], v12, s[28:31], s4 offen offset:1024 sc1
    s_waitcnt lgkmcnt(8)
    v_mfma_f32_32x32x16_bf16 a[192:207], v[16:19], v[144:147], a[192:207]
    ds_read_b64_tr_b16 v[40:41], v11 offset:34048
    ds_read_b64_tr_b16 v[42:43], v11 offset:36128
    v_mfma_f32_32x32x16_bf16 a[192:207], v[20:23], v[148:151], a[192:207]
    ds_read_b64_tr_b16 v[44:45], v10 offset:768
    ds_read_b64_tr_b16 v[46:47], v10 offset:2848
    v_accvgpr_read_b32 v224, a176
    v_accvgpr_read_b32 v225, a177
    v_accvgpr_read_b32 v226, a178
    v_accvgpr_read_b32 v227, a179
    s_waitcnt lgkmcnt(8)
    v_mfma_f32_32x32x16_bf16 a[192:207], v[24:27], v[152:155], a[192:207]
    ds_read_b64_tr_b16 v[16:17], v3 offset:832
    ds_read_b64_tr_b16 v[18:19], v3 offset:2912
    v_accvgpr_read_b32 v228, a180
    v_accvgpr_read_b32 v229, a181
    v_accvgpr_read_b32 v230, a182
    v_accvgpr_read_b32 v231, a183
    v_mfma_f32_32x32x16_bf16 a[192:207], v[28:31], v[156:159], a[192:207]
    ds_read_b64_tr_b16 v[20:21], v3 offset:17472
    ds_read_b64_tr_b16 v[22:23], v3 offset:19552
    v_accvgpr_read_b32 v232, a184
    v_accvgpr_read_b32 v233, a185
    v_accvgpr_read_b32 v234, a186
    v_accvgpr_read_b32 v235, a187
    s_waitcnt lgkmcnt(8)
    v_mfma_f32_32x32x16_bf16 a[192:207], v[32:35], v[160:163], a[192:207]
    ds_read_b64_tr_b16 v[24:25], v3 offset:34112
    ds_read_b64_tr_b16 v[26:27], v3 offset:36192
    v_accvgpr_read_b32 v236, a188
    v_accvgpr_read_b32 v237, a189
    v_accvgpr_read_b32 v238, a190
    v_accvgpr_read_b32 v239, a191
    v_mfma_f32_32x32x16_bf16 a[192:207], v[36:39], v[164:167], a[192:207]
    ds_read_b64_tr_b16 v[28:29], v3 offset:50752
    ds_read_b64_tr_b16 v[30:31], v3 offset:52832
    v_cvt_pk_bf16_f32 v224, v224, v225
    v_cvt_pk_bf16_f32 v225, v226, v227
    v_cvt_pk_bf16_f32 v226, v228, v229
    v_cvt_pk_bf16_f32 v227, v230, v231
    s_waitcnt lgkmcnt(8)
    v_mfma_f32_32x32x16_bf16 a[192:207], v[40:43], v[168:171], a[192:207]
    ds_read_b64_tr_b16 v[32:33], v11 offset:832
    ds_read_b64_tr_b16 v[34:35], v11 offset:2912
    v_cvt_pk_bf16_f32 v228, v232, v233
    v_cvt_pk_bf16_f32 v229, v234, v235
    v_cvt_pk_bf16_f32 v230, v236, v237
    v_cvt_pk_bf16_f32 v231, v238, v239
    v_mfma_f32_32x32x16_bf16 a[192:207], v[44:47], v[172:175], a[192:207]
    ds_read_b64_tr_b16 v[36:37], v11 offset:17472
    ds_read_b64_tr_b16 v[38:39], v11 offset:19552
    buffer_store_dwordx4 v[224:227], v12, s[28:31], s4 offen offset:2048 sc1
    buffer_store_dwordx4 v[228:231], v12, s[28:31], s4 offen offset:3072 sc1
    s_waitcnt lgkmcnt(8)
    v_mfma_f32_32x32x16_bf16 a[208:223], v[16:19], v[144:147], a[208:223]
    ds_read_b64_tr_b16 v[40:41], v11 offset:34112
    ds_read_b64_tr_b16 v[42:43], v11 offset:36192
    v_mfma_f32_32x32x16_bf16 a[208:223], v[20:23], v[148:151], a[208:223]
    ds_read_b64_tr_b16 v[44:45], v10 offset:832
    ds_read_b64_tr_b16 v[46:47], v10 offset:2912
    s_nop 0
    v_accvgpr_read_b32 v176, a192
    v_accvgpr_read_b32 v177, a193
    v_accvgpr_read_b32 v178, a194
    v_accvgpr_read_b32 v179, a195
    v_accvgpr_read_b32 v180, a196
    s_waitcnt lgkmcnt(8)
    v_mfma_f32_32x32x16_bf16 a[208:223], v[24:27], v[152:155], a[208:223]
    ds_read_b64_tr_b16 v[16:17], v3 offset:896
    ds_read_b64_tr_b16 v[18:19], v3 offset:2976
    v_accvgpr_read_b32 v181, a197
    v_accvgpr_read_b32 v182, a198
    v_accvgpr_read_b32 v183, a199
    v_accvgpr_read_b32 v184, a200
    v_accvgpr_read_b32 v185, a201
    v_mfma_f32_32x32x16_bf16 a[208:223], v[28:31], v[156:159], a[208:223]
    ds_read_b64_tr_b16 v[20:21], v3 offset:17536
    ds_read_b64_tr_b16 v[22:23], v3 offset:19616
    v_accvgpr_read_b32 v186, a202
    v_accvgpr_read_b32 v187, a203
    v_accvgpr_read_b32 v188, a204
    v_accvgpr_read_b32 v189, a205
    v_accvgpr_read_b32 v190, a206
    s_waitcnt lgkmcnt(8)
    v_mfma_f32_32x32x16_bf16 a[208:223], v[32:35], v[160:163], a[208:223]
    ds_read_b64_tr_b16 v[24:25], v3 offset:34176
    ds_read_b64_tr_b16 v[26:27], v3 offset:36256
    v_accvgpr_read_b32 v191, a207
    v_cvt_pk_bf16_f32 v176, v176, v177
    v_cvt_pk_bf16_f32 v177, v178, v179
    v_cvt_pk_bf16_f32 v178, v180, v181
    v_cvt_pk_bf16_f32 v179, v182, v183
    v_mfma_f32_32x32x16_bf16 a[208:223], v[36:39], v[164:167], a[208:223]
    ds_read_b64_tr_b16 v[28:29], v3 offset:50816
    ds_read_b64_tr_b16 v[30:31], v3 offset:52896
    v_cvt_pk_bf16_f32 v180, v184, v185
    v_cvt_pk_bf16_f32 v181, v186, v187
    v_cvt_pk_bf16_f32 v182, v188, v189
    v_cvt_pk_bf16_f32 v183, v190, v191
    s_add_u32 s4, s3, 24576
    s_waitcnt lgkmcnt(8)
    v_mfma_f32_32x32x16_bf16 a[208:223], v[40:43], v[168:171], a[208:223]
    ds_read_b64_tr_b16 v[32:33], v11 offset:896
    ds_read_b64_tr_b16 v[34:35], v11 offset:2976
    buffer_store_dwordx4 v[176:179], v12, s[28:31], s4 offen offset:0 sc1
    buffer_store_dwordx4 v[180:183], v12, s[28:31], s4 offen offset:1024 sc1
    v_mfma_f32_32x32x16_bf16 a[208:223], v[44:47], v[172:175], a[208:223]
    ds_read_b64_tr_b16 v[36:37], v11 offset:17536
    ds_read_b64_tr_b16 v[38:39], v11 offset:19616
    s_waitcnt lgkmcnt(8)
    v_mfma_f32_32x32x16_bf16 a[224:239], v[16:19], v[144:147], a[224:239]
    ds_read_b64_tr_b16 v[40:41], v11 offset:34176
    ds_read_b64_tr_b16 v[42:43], v11 offset:36256
    v_mfma_f32_32x32x16_bf16 a[224:239], v[20:23], v[148:151], a[224:239]
    ds_read_b64_tr_b16 v[44:45], v10 offset:896
    ds_read_b64_tr_b16 v[46:47], v10 offset:2976
    s_nop 2
    v_accvgpr_read_b32 v192, a208
    v_accvgpr_read_b32 v193, a209
    v_accvgpr_read_b32 v194, a210
    v_accvgpr_read_b32 v195, a211
    v_accvgpr_read_b32 v196, a212
    s_waitcnt lgkmcnt(8)
    v_mfma_f32_32x32x16_bf16 a[224:239], v[24:27], v[152:155], a[224:239]
    ds_read_b64_tr_b16 v[16:17], v3 offset:960
    ds_read_b64_tr_b16 v[18:19], v3 offset:3040
    v_accvgpr_read_b32 v197, a213
    v_accvgpr_read_b32 v198, a214
    v_accvgpr_read_b32 v199, a215
    v_accvgpr_read_b32 v200, a216
    v_accvgpr_read_b32 v201, a217
    v_mfma_f32_32x32x16_bf16 a[224:239], v[28:31], v[156:159], a[224:239]
    ds_read_b64_tr_b16 v[20:21], v3 offset:17600
    ds_read_b64_tr_b16 v[22:23], v3 offset:19680
    v_accvgpr_read_b32 v202, a218
    v_accvgpr_read_b32 v203, a219
    v_accvgpr_read_b32 v204, a220
    v_accvgpr_read_b32 v205, a221
    v_accvgpr_read_b32 v206, a222
    s_waitcnt lgkmcnt(8)
    v_mfma_f32_32x32x16_bf16 a[224:239], v[32:35], v[160:163], a[224:239]
    ds_read_b64_tr_b16 v[24:25], v3 offset:34240
    ds_read_b64_tr_b16 v[26:27], v3 offset:36320
    v_accvgpr_read_b32 v207, a223
    v_cvt_pk_bf16_f32 v192, v192, v193
    v_cvt_pk_bf16_f32 v193, v194, v195
    v_cvt_pk_bf16_f32 v194, v196, v197
    v_cvt_pk_bf16_f32 v195, v198, v199
    v_mfma_f32_32x32x16_bf16 a[224:239], v[36:39], v[164:167], a[224:239]
    ds_read_b64_tr_b16 v[28:29], v3 offset:50880
    ds_read_b64_tr_b16 v[30:31], v3 offset:52960
    v_cvt_pk_bf16_f32 v196, v200, v201
    v_cvt_pk_bf16_f32 v197, v202, v203
    v_cvt_pk_bf16_f32 v198, v204, v205
    v_cvt_pk_bf16_f32 v199, v206, v207
    buffer_store_dwordx4 v[192:195], v12, s[28:31], s4 offen offset:2048 sc1
    s_waitcnt lgkmcnt(8)
    v_mfma_f32_32x32x16_bf16 a[224:239], v[40:43], v[168:171], a[224:239]
    ds_read_b64_tr_b16 v[32:33], v11 offset:960
    ds_read_b64_tr_b16 v[34:35], v11 offset:3040
    buffer_store_dwordx4 v[196:199], v12, s[28:31], s4 offen offset:3072 sc1
    v_mfma_f32_32x32x16_bf16 a[224:239], v[44:47], v[172:175], a[224:239]
    ds_read_b64_tr_b16 v[36:37], v11 offset:17600
    ds_read_b64_tr_b16 v[38:39], v11 offset:19680
    s_waitcnt lgkmcnt(8)
    v_mfma_f32_32x32x16_bf16 a[240:255], v[16:19], v[144:147], a[240:255]
    ds_read_b64_tr_b16 v[40:41], v11 offset:34240
    ds_read_b64_tr_b16 v[42:43], v11 offset:36320
    v_mfma_f32_32x32x16_bf16 a[240:255], v[20:23], v[148:151], a[240:255]
    ds_read_b64_tr_b16 v[44:45], v10 offset:960
    ds_read_b64_tr_b16 v[46:47], v10 offset:3040
    s_nop 2
    v_accvgpr_read_b32 v208, a224
    v_accvgpr_read_b32 v209, a225
    v_accvgpr_read_b32 v210, a226
    v_accvgpr_read_b32 v211, a227
    v_accvgpr_read_b32 v212, a228
    v_accvgpr_read_b32 v213, a229
    v_accvgpr_read_b32 v214, a230
    v_accvgpr_read_b32 v215, a231
    s_waitcnt lgkmcnt(8)
    v_mfma_f32_32x32x16_bf16 a[240:255], v[24:27], v[152:155], a[240:255]
    v_accvgpr_read_b32 v216, a232
    v_accvgpr_read_b32 v217, a233
    v_accvgpr_read_b32 v218, a234
    v_accvgpr_read_b32 v219, a235
    v_accvgpr_read_b32 v220, a236
    v_accvgpr_read_b32 v221, a237
    v_accvgpr_read_b32 v222, a238
    v_accvgpr_read_b32 v223, a239
    v_mfma_f32_32x32x16_bf16 a[240:255], v[28:31], v[156:159], a[240:255]
    v_cvt_pk_bf16_f32 v208, v208, v209
    v_cvt_pk_bf16_f32 v209, v210, v211
    v_cvt_pk_bf16_f32 v210, v212, v213
    v_cvt_pk_bf16_f32 v211, v214, v215
    v_cvt_pk_bf16_f32 v212, v216, v217
    v_cvt_pk_bf16_f32 v213, v218, v219
    v_cvt_pk_bf16_f32 v214, v220, v221
    s_waitcnt lgkmcnt(4)
    v_mfma_f32_32x32x16_bf16 a[240:255], v[32:35], v[160:163], a[240:255]
    v_cvt_pk_bf16_f32 v215, v222, v223
    s_add_u32 s4, s3, 28672
    buffer_store_dwordx4 v[208:211], v12, s[28:31], s4 offen offset:0 sc1
    buffer_store_dwordx4 v[212:215], v12, s[28:31], s4 offen offset:1024 sc1
    v_mfma_f32_32x32x16_bf16 a[240:255], v[36:39], v[164:167], a[240:255]
    s_waitcnt lgkmcnt(0)
    v_mfma_f32_32x32x16_bf16 a[240:255], v[40:43], v[168:171], a[240:255]
    v_mfma_f32_32x32x16_bf16 a[240:255], v[44:47], v[172:175], a[240:255]
    s_nop 11
    v_accvgpr_read_b32 v224, a240
    v_accvgpr_read_b32 v225, a241
    v_accvgpr_read_b32 v226, a242
    v_accvgpr_read_b32 v227, a243
    v_accvgpr_read_b32 v228, a244
    v_accvgpr_read_b32 v229, a245
    v_accvgpr_read_b32 v230, a246
    v_accvgpr_read_b32 v231, a247
    v_accvgpr_read_b32 v232, a248
    v_accvgpr_read_b32 v233, a249
    v_accvgpr_read_b32 v234, a250
    v_accvgpr_read_b32 v235, a251
    v_accvgpr_read_b32 v236, a252
    v_accvgpr_read_b32 v237, a253
    v_accvgpr_read_b32 v238, a254
    v_accvgpr_read_b32 v239, a255
    v_cvt_pk_bf16_f32 v224, v224, v225
    v_cvt_pk_bf16_f32 v225, v226, v227
    v_cvt_pk_bf16_f32 v226, v228, v229
    v_cvt_pk_bf16_f32 v227, v230, v231
    v_cvt_pk_bf16_f32 v228, v232, v233
    v_cvt_pk_bf16_f32 v229, v234, v235
    v_cvt_pk_bf16_f32 v230, v236, v237
    v_cvt_pk_bf16_f32 v231, v238, v239
    buffer_store_dwordx4 v[224:227], v12, s[28:31], s4 offen offset:2048 sc1
    buffer_store_dwordx4 v[228:231], v12, s[28:31], s4 offen offset:3072 sc1
    s_waitcnt vmcnt(0)
    s_barrier
    s_branch L_red
L_rare_1:
    s_nop 15
    v_max_f32 v10, 0, v10
    v_sub_f32 v11, 0, v10
    v_exp_f32 v11, v11
    v_sub_f32 v208, v208, v10
    v_sub_f32 v209, v209, v10
    v_sub_f32 v210, v210, v10
    v_sub_f32 v211, v211, v10
    v_sub_f32 v212, v212, v10
    v_sub_f32 v213, v213, v10
    v_sub_f32 v214, v214, v10
    v_sub_f32 v215, v215, v10
    v_sub_f32 v216, v216, v10
    v_sub_f32 v217, v217, v10
    v_sub_f32 v218, v218, v10
    v_sub_f32 v219, v219, v10
    v_sub_f32 v220, v220, v10
    v_sub_f32 v221, v221, v10
    v_sub_f32 v222, v222, v10
    v_sub_f32 v223, v223, v10
    v_sub_f32 v224, v224, v10
    v_sub_f32 v225, v225, v10
    v_sub_f32 v226, v226, v10
    v_sub_f32 v227, v227, v10
    v_sub_f32 v228, v228, v10
    v_sub_f32 v229, v229, v10
    v_sub_f32 v230, v230, v10
    v_sub_f32 v231, v231, v10
    v_sub_f32 v232, v232, v10
    v_sub_f32 v233, v233, v10
    v_sub_f32 v234, v234, v10
    v_sub_f32 v235, v235, v10
    v_sub_f32 v236, v236, v10
    v_sub_f32 v237, v237, v10
    v_sub_f32 v238, v238, v10
    v_sub_f32 v239, v239, v10
    v_sub_f32 v240, v240, v10
    v_sub_f32 v241, v241, v10
    v_sub_f32 v242, v242, v10
    v_sub_f32 v243, v243, v10
    v_sub_f32 v244, v244, v10
    v_sub_f32 v245, v245, v10
    v_sub_f32 v246, v246, v10
    v_sub_f32 v247, v247, v10
    v_sub_f32 v248, v248, v10
    v_sub_f32 v249, v249, v10
    v_sub_f32 v250, v250, v10
    v_sub_f32 v251, v251, v10
    v_sub_f32 v252, v252, v10
    v_sub_f32 v253, v253, v10
    v_sub_f32 v254, v254, v10
    v_sub_f32 v255, v255, v10
    v_mul_f32 v48, v11, v48
    v_mul_f32 v49, v11, v49
    v_mul_f32 v50, v11, v50
    v_mul_f32 v51, v11, v51
    v_mul_f32 v52, v11, v52
    v_mul_f32 v53, v11, v53
    v_mul_f32 v54, v11, v54
    v_mul_f32 v55, v11, v55
    v_mul_f32 v56, v11, v56
    v_mul_f32 v57, v11, v57
    v_mul_f32 v58, v11, v58
    v_mul_f32 v59, v11, v59
    v_mul_f32 v60, v11, v60
    v_mul_f32 v61, v11, v61
    v_mul_f32 v62, v11, v62
    v_mul_f32 v63, v11, v63
    v_mul_f32 v64, v11, v64
    v_mul_f32 v65, v11, v65
    v_mul_f32 v66, v11, v66
    v_mul_f32 v67, v11, v67
    v_mul_f32 v68, v11, v68
    v_mul_f32 v69, v11, v69
    v_mul_f32 v70, v11, v70
    v_mul_f32 v71, v11, v71
    v_mul_f32 v72, v11, v72
    v_mul_f32 v73, v11, v73
    v_mul_f32 v74, v11, v74
    v_mul_f32 v75, v11, v75
    v_mul_f32 v76, v11, v76
    v_mul_f32 v77, v11, v77
    v_mul_f32 v78, v11, v78
    v_mul_f32 v79, v11, v79
    v_mul_f32 v80, v11, v80
    v_mul_f32 v81, v11, v81
    v_mul_f32 v82, v11, v82
    v_mul_f32 v83, v11, v83
    v_mul_f32 v84, v11, v84
    v_mul_f32 v85, v11, v85
    v_mul_f32 v86, v11, v86
    v_mul_f32 v87, v11, v87
    v_mul_f32 v88, v11, v88
    v_mul_f32 v89, v11, v89
    v_mul_f32 v90, v11, v90
    v_mul_f32 v91, v11, v91
    v_mul_f32 v92, v11, v92
    v_mul_f32 v93, v11, v93
    v_mul_f32 v94, v11, v94
    v_mul_f32 v95, v11, v95
    v_mul_f32 v96, v11, v96
    v_mul_f32 v97, v11, v97
    v_mul_f32 v98, v11, v98
    v_mul_f32 v99, v11, v99
    v_mul_f32 v100, v11, v100
    v_mul_f32 v101, v11, v101
    v_mul_f32 v102, v11, v102
    v_mul_f32 v103, v11, v103
    v_mul_f32 v104, v11, v104
    v_mul_f32 v105, v11, v105
    v_mul_f32 v106, v11, v106
    v_mul_f32 v107, v11, v107
    v_mul_f32 v108, v11, v108
    v_mul_f32 v109, v11, v109
    v_mul_f32 v110, v11, v110
    v_mul_f32 v111, v11, v111
    v_mul_f32 v7, v11, v7
    v_mul_f32 v8, v11, v8
    s_nop 3
    s_branch L_back_1
L_rare_2:
    s_nop 15
    v_max_f32 v10, 0, v10
    v_sub_f32 v11, 0, v10
    v_exp_f32 v11, v11
    v_sub_f32 v176, v176, v10
    v_sub_f32 v177, v177, v10
    v_sub_f32 v178, v178, v10
    v_sub_f32 v179, v179, v10
    v_sub_f32 v180, v180, v10
    v_sub_f32 v181, v181, v10
    v_sub_f32 v182, v182, v10
    v_sub_f32 v183, v183, v10
    v_sub_f32 v184, v184, v10
    v_sub_f32 v185, v185, v10
    v_sub_f32 v186, v186, v10
    v_sub_f32 v187, v187, v10
    v_sub_f32 v188, v188, v10
    v_sub_f32 v189, v189, v10
    v_sub_f32 v190, v190, v10
    v_sub_f32 v191, v191, v10
    v_sub_f32 v192, v192, v10
    v_sub_f32 v193, v193, v10
    v_sub_f32 v194, v194, v10
    v_sub_f32 v195, v195, v10
    v_sub_f32 v196, v196, v10
    v_sub_f32 v197, v197, v10
    v_sub_f32 v198, v198, v10
    v_sub_f32 v199, v199, v10
    v_sub_f32 v200, v200, v10
    v_sub_f32 v201, v201, v10
    v_sub_f32 v202, v202, v10
    v_sub_f32 v203, v203, v10
    v_sub_f32 v204, v204, v10
    v_sub_f32 v205, v205, v10
    v_sub_f32 v206, v206, v10
    v_sub_f32 v207, v207, v10
    v_sub_f32 v240, v240, v10
    v_sub_f32 v241, v241, v10
    v_sub_f32 v242, v242, v10
    v_sub_f32 v243, v243, v10
    v_sub_f32 v244, v244, v10
    v_sub_f32 v245, v245, v10
    v_sub_f32 v246, v246, v10
    v_sub_f32 v247, v247, v10
    v_sub_f32 v248, v248, v10
    v_sub_f32 v249, v249, v10
    v_sub_f32 v250, v250, v10
    v_sub_f32 v251, v251, v10
    v_sub_f32 v252, v252, v10
    v_sub_f32 v253, v253, v10
    v_sub_f32 v254, v254, v10
    v_sub_f32 v255, v255, v10
    v_mul_f32 v48, v11, v48
    v_mul_f32 v49, v11, v49
    v_mul_f32 v50, v11, v50
    v_mul_f32 v51, v11, v51
    v_mul_f32 v52, v11, v52
    v_mul_f32 v53, v11, v53
    v_mul_f32 v54, v11, v54
    v_mul_f32 v55, v11, v55
    v_mul_f32 v56, v11, v56
    v_mul_f32 v57, v11, v57
    v_mul_f32 v58, v11, v58
    v_mul_f32 v59, v11, v59
    v_mul_f32 v60, v11, v60
    v_mul_f32 v61, v11, v61
    v_mul_f32 v62, v11, v62
    v_mul_f32 v63, v11, v63
    v_mul_f32 v64, v11, v64
    v_mul_f32 v65, v11, v65
    v_mul_f32 v66, v11, v66
    v_mul_f32 v67, v11, v67
    v_mul_f32 v68, v11, v68
    v_mul_f32 v69, v11, v69
    v_mul_f32 v70, v11, v70
    v_mul_f32 v71, v11, v71
    v_mul_f32 v72, v11, v72
    v_mul_f32 v73, v11, v73
    v_mul_f32 v74, v11, v74
    v_mul_f32 v75, v11, v75
    v_mul_f32 v76, v11, v76
    v_mul_f32 v77, v11, v77
    v_mul_f32 v78, v11, v78
    v_mul_f32 v79, v11, v79
    v_mul_f32 v80, v11, v80
    v_mul_f32 v81, v11, v81
    v_mul_f32 v82, v11, v82
    v_mul_f32 v83, v11, v83
    v_mul_f32 v84, v11, v84
    v_mul_f32 v85, v11, v85
    v_mul_f32 v86, v11, v86
    v_mul_f32 v87, v11, v87
    v_mul_f32 v88, v11, v88
    v_mul_f32 v89, v11, v89
    v_mul_f32 v90, v11, v90
    v_mul_f32 v91, v11, v91
    v_mul_f32 v92, v11, v92
    v_mul_f32 v93, v11, v93
    v_mul_f32 v94, v11, v94
    v_mul_f32 v95, v11, v95
    v_mul_f32 v96, v11, v96
    v_mul_f32 v97, v11, v97
    v_mul_f32 v98, v11, v98
    v_mul_f32 v99, v11, v99
    v_mul_f32 v100, v11, v100
    v_mul_f32 v101, v11, v101
    v_mul_f32 v102, v11, v102
    v_mul_f32 v103, v11, v103
    v_mul_f32 v104, v11, v104
    v_mul_f32 v105, v11, v105
    v_mul_f32 v106, v11, v106
    v_mul_f32 v107, v11, v107
    v_mul_f32 v108, v11, v108
    v_mul_f32 v109, v11, v109
    v_mul_f32 v110, v11, v110
    v_mul_f32 v111, v11, v111
    v_mul_f32 v7, v11, v7
    v_mul_f32 v8, v11, v8
    s_nop 3
    s_branch L_back_2
L_rare_3:
    s_nop 15
    v_max_f32 v10, 0, v10
    v_sub_f32 v11, 0, v10
    v_exp_f32 v11, v11
    v_sub_f32 v208, v208, v10
    v_sub_f32 v209, v209, v10
    v_sub_f32 v210, v210, v10
    v_sub_f32 v211, v211, v10
    v_sub_f32 v212, v212, v10
    v_sub_f32 v213, v213, v10
    v_sub_f32 v214, v214, v10
    v_sub_f32 v215, v215, v10
    v_sub_f32 v216, v216, v10
    v_sub_f32 v217, v217, v10
    v_sub_f32 v218, v218, v10
    v_sub_f32 v219, v219, v10
    v_sub_f32 v220, v220, v10
    v_sub_f32 v221, v221, v10
    v_sub_f32 v222, v222, v10
    v_sub_f32 v223, v223, v10
    v_sub_f32 v224, v224, v10
    v_sub_f32 v225, v225, v10
    v_sub_f32 v226, v226, v10
    v_sub_f32 v227, v227, v10
    v_sub_f32 v228, v228, v10
    v_sub_f32 v229, v229, v10
    v_sub_f32 v230, v230, v10
    v_sub_f32 v231, v231, v10
    v_sub_f32 v232, v232, v10
    v_sub_f32 v233, v233, v10
    v_sub_f32 v234, v234, v10
    v_sub_f32 v235, v235, v10
    v_sub_f32 v236, v236, v10
    v_sub_f32 v237, v237, v10
    v_sub_f32 v238, v238, v10
    v_sub_f32 v239, v239, v10
    v_sub_f32 v240, v240, v10
    v_sub_f32 v241, v241, v10
    v_sub_f32 v242, v242, v10
    v_sub_f32 v243, v243, v10
    v_sub_f32 v244, v244, v10
    v_sub_f32 v245, v245, v10
    v_sub_f32 v246, v246, v10
    v_sub_f32 v247, v247, v10
    v_sub_f32 v248, v248, v10
    v_sub_f32 v249, v249, v10
    v_sub_f32 v250, v250, v10
    v_sub_f32 v251, v251, v10
    v_sub_f32 v252, v252, v10
    v_sub_f32 v253, v253, v10
    v_sub_f32 v254, v254, v10
    v_sub_f32 v255, v255, v10
    v_mul_f32 v48, v11, v48
    v_mul_f32 v49, v11, v49
    v_mul_f32 v50, v11, v50
    v_mul_f32 v51, v11, v51
    v_mul_f32 v52, v11, v52
    v_mul_f32 v53, v11, v53
    v_mul_f32 v54, v11, v54
    v_mul_f32 v55, v11, v55
    v_mul_f32 v56, v11, v56
    v_mul_f32 v57, v11, v57
    v_mul_f32 v58, v11, v58
    v_mul_f32 v59, v11, v59
    v_mul_f32 v60, v11, v60
    v_mul_f32 v61, v11, v61
    v_mul_f32 v62, v11, v62
    v_mul_f32 v63, v11, v63
    v_mul_f32 v64, v11, v64
    v_mul_f32 v65, v11, v65
    v_mul_f32 v66, v11, v66
    v_mul_f32 v67, v11, v67
    v_mul_f32 v68, v11, v68
    v_mul_f32 v69, v11, v69
    v_mul_f32 v70, v11, v70
    v_mul_f32 v71, v11, v71
    v_mul_f32 v72, v11, v72
    v_mul_f32 v73, v11, v73
    v_mul_f32 v74, v11, v74
    v_mul_f32 v75, v11, v75
    v_mul_f32 v76, v11, v76
    v_mul_f32 v77, v11, v77
    v_mul_f32 v78, v11, v78
    v_mul_f32 v79, v11, v79
    v_mul_f32 v80, v11, v80
    v_mul_f32 v81, v11, v81
    v_mul_f32 v82, v11, v82
    v_mul_f32 v83, v11, v83
    v_mul_f32 v84, v11, v84
    v_mul_f32 v85, v11, v85
    v_mul_f32 v86, v11, v86
    v_mul_f32 v87, v11, v87
    v_mul_f32 v88, v11, v88
    v_mul_f32 v89, v11, v89
    v_mul_f32 v90, v11, v90
    v_mul_f32 v91, v11, v91
    v_mul_f32 v92, v11, v92
    v_mul_f32 v93, v11, v93
    v_mul_f32 v94, v11, v94
    v_mul_f32 v95, v11, v95
    v_mul_f32 v96, v11, v96
    v_mul_f32 v97, v11, v97
    v_mul_f32 v98, v11, v98
    v_mul_f32 v99, v11, v99
    v_mul_f32 v100, v11, v100
    v_mul_f32 v101, v11, v101
    v_mul_f32 v102, v11, v102
    v_mul_f32 v103, v11, v103
    v_mul_f32 v104, v11, v104
    v_mul_f32 v105, v11, v105
    v_mul_f32 v106, v11, v106
    v_mul_f32 v107, v11, v107
    v_mul_f32 v108, v11, v108
    v_mul_f32 v109, v11, v109
    v_mul_f32 v110, v11, v110
    v_mul_f32 v111, v11, v111
    v_mul_f32 v7, v11, v7
    v_mul_f32 v8, v11, v8
    s_nop 3
    s_branch L_back_3
L_rare_4:
    s_nop 15
    v_max_f32 v10, 0, v10
    v_sub_f32 v11, 0, v10
    v_exp_f32 v11, v11
    v_sub_f32 v176, v176, v10
    v_sub_f32 v177, v177, v10
    v_sub_f32 v178, v178, v10
    v_sub_f32 v179, v179, v10
    v_sub_f32 v180, v180, v10
    v_sub_f32 v181, v181, v10
    v_sub_f32 v182, v182, v10
    v_sub_f32 v183, v183, v10
    v_sub_f32 v184, v184, v10
    v_sub_f32 v185, v185, v10
    v_sub_f32 v186, v186, v10
    v_sub_f32 v187, v187, v10
    v_sub_f32 v188, v188, v10
    v_sub_f32 v189, v189, v10
    v_sub_f32 v190, v190, v10
    v_sub_f32 v191, v191, v10
    v_sub_f32 v192, v192, v10
    v_sub_f32 v193, v193, v10
    v_sub_f32 v194, v194, v10
    v_sub_f32 v195, v195, v10
    v_sub_f32 v196, v196, v10
    v_sub_f32 v197, v197, v10
    v_sub_f32 v198, v198, v10
    v_sub_f32 v199, v199, v10
    v_sub_f32 v200, v200, v10
    v_sub_f32 v201, v201, v10
    v_sub_f32 v202, v202, v10
    v_sub_f32 v203, v203, v10
    v_sub_f32 v204, v204, v10
    v_sub_f32 v205, v205, v10
    v_sub_f32 v206, v206, v10
    v_sub_f32 v207, v207, v10
    v_sub_f32 v240, v240, v10
    v_sub_f32 v241, v241, v10
    v_sub_f32 v242, v242, v10
    v_sub_f32 v243, v243, v10
    v_sub_f32 v244, v244, v10
    v_sub_f32 v245, v245, v10
    v_sub_f32 v246, v246, v10
    v_sub_f32 v247, v247, v10
    v_sub_f32 v248, v248, v10
    v_sub_f32 v249, v249, v10
    v_sub_f32 v250, v250, v10
    v_sub_f32 v251, v251, v10
    v_sub_f32 v252, v252, v10
    v_sub_f32 v253, v253, v10
    v_sub_f32 v254, v254, v10
    v_sub_f32 v255, v255, v10
    v_mul_f32 v48, v11, v48
    v_mul_f32 v49, v11, v49
    v_mul_f32 v50, v11, v50
    v_mul_f32 v51, v11, v51
    v_mul_f32 v52, v11, v52
    v_mul_f32 v53, v11, v53
    v_mul_f32 v54, v11, v54
    v_mul_f32 v55, v11, v55
    v_mul_f32 v56, v11, v56
    v_mul_f32 v57, v11, v57
    v_mul_f32 v58, v11, v58
    v_mul_f32 v59, v11, v59
    v_mul_f32 v60, v11, v60
    v_mul_f32 v61, v11, v61
    v_mul_f32 v62, v11, v62
    v_mul_f32 v63, v11, v63
    v_mul_f32 v64, v11, v64
    v_mul_f32 v65, v11, v65
    v_mul_f32 v66, v11, v66
    v_mul_f32 v67, v11, v67
    v_mul_f32 v68, v11, v68
    v_mul_f32 v69, v11, v69
    v_mul_f32 v70, v11, v70
    v_mul_f32 v71, v11, v71
    v_mul_f32 v72, v11, v72
    v_mul_f32 v73, v11, v73
    v_mul_f32 v74, v11, v74
    v_mul_f32 v75, v11, v75
    v_mul_f32 v76, v11, v76
    v_mul_f32 v77, v11, v77
    v_mul_f32 v78, v11, v78
    v_mul_f32 v79, v11, v79
    v_mul_f32 v80, v11, v80
    v_mul_f32 v81, v11, v81
    v_mul_f32 v82, v11, v82
    v_mul_f32 v83, v11, v83
    v_mul_f32 v84, v11, v84
    v_mul_f32 v85, v11, v85
    v_mul_f32 v86, v11, v86
    v_mul_f32 v87, v11, v87
    v_mul_f32 v88, v11, v88
    v_mul_f32 v89, v11, v89
    v_mul_f32 v90, v11, v90
    v_mul_f32 v91, v11, v91
    v_mul_f32 v92, v11, v92
    v_mul_f32 v93, v11, v93
    v_mul_f32 v94, v11, v94
    v_mul_f32 v95, v11, v95
    v_mul_f32 v96, v11, v96
    v_mul_f32 v97, v11, v97
    v_mul_f32 v98, v11, v98
    v_mul_f32 v99, v11, v99
    v_mul_f32 v100, v11, v100
    v_mul_f32 v101, v11, v101
    v_mul_f32 v102, v11, v102
    v_mul_f32 v103, v11, v103
    v_mul_f32 v104, v11, v104
    v_mul_f32 v105, v11, v105
    v_mul_f32 v106, v11, v106
    v_mul_f32 v107, v11, v107
    v_mul_f32 v108, v11, v108
    v_mul_f32 v109, v11, v109
    v_mul_f32 v110, v11, v110
    v_mul_f32 v111, v11, v111
    v_mul_f32 v7, v11, v7
    v_mul_f32 v8, v11, v8
    s_nop 3
    s_branch L_back_4
L_rare_5:
    s_nop 15
    v_max_f32 v10, 0, v10
    v_sub_f32 v11, 0, v10
    v_exp_f32 v11, v11
    v_sub_f32 v208, v208, v10
    v_sub_f32 v209, v209, v10
    v_sub_f32 v210, v210, v10
    v_sub_f32 v211, v211, v10
    v_sub_f32 v212, v212, v10
    v_sub_f32 v213, v213, v10
    v_sub_f32 v214, v214, v10
    v_sub_f32 v215, v215, v10
    v_sub_f32 v216, v216, v10
    v_sub_f32 v217, v217, v10
    v_sub_f32 v218, v218, v10
    v_sub_f32 v219, v219, v10
    v_sub_f32 v220, v220, v10
    v_sub_f32 v221, v221, v10
    v_sub_f32 v222, v222, v10
    v_sub_f32 v223, v223, v10
    v_sub_f32 v224, v224, v10
    v_sub_f32 v225, v225, v10
    v_sub_f32 v226, v226, v10
    v_sub_f32 v227, v227, v10
    v_sub_f32 v228, v228, v10
    v_sub_f32 v229, v229, v10
    v_sub_f32 v230, v230, v10
    v_sub_f32 v231, v231, v10
    v_sub_f32 v232, v232, v10
    v_sub_f32 v233, v233, v10
    v_sub_f32 v234, v234, v10
    v_sub_f32 v235, v235, v10
    v_sub_f32 v236, v236, v10
    v_sub_f32 v237, v237, v10
    v_sub_f32 v238, v238, v10
    v_sub_f32 v239, v239, v10
    v_sub_f32 v240, v240, v10
    v_sub_f32 v241, v241, v10
    v_sub_f32 v242, v242, v10
    v_sub_f32 v243, v243, v10
    v_sub_f32 v244, v244, v10
    v_sub_f32 v245, v245, v10
    v_sub_f32 v246, v246, v10
    v_sub_f32 v247, v247, v10
    v_sub_f32 v248, v248, v10
    v_sub_f32 v249, v249, v10
    v_sub_f32 v250, v250, v10
    v_sub_f32 v251, v251, v10
    v_sub_f32 v252, v252, v10
    v_sub_f32 v253, v253, v10
    v_sub_f32 v254, v254, v10
    v_sub_f32 v255, v255, v10
    v_mul_f32 v48, v11, v48
    v_mul_f32 v49, v11, v49
    v_mul_f32 v50, v11, v50
    v_mul_f32 v51, v11, v51
    v_mul_f32 v52, v11, v52
    v_mul_f32 v53, v11, v53
    v_mul_f32 v54, v11, v54
    v_mul_f32 v55, v11, v55
    v_mul_f32 v56, v11, v56
    v_mul_f32 v57, v11, v57
    v_mul_f32 v58, v11, v58
    v_mul_f32 v59, v11, v59
    v_mul_f32 v60, v11, v60
    v_mul_f32 v61, v11, v61
    v_mul_f32 v62, v11, v62
    v_mul_f32 v63, v11, v63
    v_mul_f32 v64, v11, v64
    v_mul_f32 v65, v11, v65
    v_mul_f32 v66, v11, v66
    v_mul_f32 v67, v11, v67
    v_mul_f32 v68, v11, v68
    v_mul_f32 v69, v11, v69
    v_mul_f32 v70, v11, v70
    v_mul_f32 v71, v11, v71
    v_mul_f32 v72, v11, v72
    v_mul_f32 v73, v11, v73
    v_mul_f32 v74, v11, v74
    v_mul_f32 v75, v11, v75
    v_mul_f32 v76, v11, v76
    v_mul_f32 v77, v11, v77
    v_mul_f32 v78, v11, v78
    v_mul_f32 v79, v11, v79
    v_mul_f32 v80, v11, v80
    v_mul_f32 v81, v11, v81
    v_mul_f32 v82, v11, v82
    v_mul_f32 v83, v11, v83
    v_mul_f32 v84, v11, v84
    v_mul_f32 v85, v11, v85
    v_mul_f32 v86, v11, v86
    v_mul_f32 v87, v11, v87
    v_mul_f32 v88, v11, v88
    v_mul_f32 v89, v11, v89
    v_mul_f32 v90, v11, v90
    v_mul_f32 v91, v11, v91
    v_mul_f32 v92, v11, v92
    v_mul_f32 v93, v11, v93
    v_mul_f32 v94, v11, v94
    v_mul_f32 v95, v11, v95
    v_mul_f32 v96, v11, v96
    v_mul_f32 v97, v11, v97
    v_mul_f32 v98, v11, v98
    v_mul_f32 v99, v11, v99
    v_mul_f32 v100, v11, v100
    v_mul_f32 v101, v11, v101
    v_mul_f32 v102, v11, v102
    v_mul_f32 v103, v11, v103
    v_mul_f32 v104, v11, v104
    v_mul_f32 v105, v11, v105
    v_mul_f32 v106, v11, v106
    v_mul_f32 v107, v11, v107
    v_mul_f32 v108, v11, v108
    v_mul_f32 v109, v11, v109
    v_mul_f32 v110, v11, v110
    v_mul_f32 v111, v11, v111
    v_mul_f32 v7, v11, v7
    v_mul_f32 v8, v11, v8
    s_nop 3
    s_branch L_back_5
L_rare_6:
    s_nop 15
    v_max_f32 v10, 0, v10
    v_sub_f32 v11, 0, v10
    v_exp_f32 v11, v11
    v_sub_f32 v176, v176, v10
    v_sub_f32 v177, v177, v10
    v_sub_f32 v178, v178, v10
    v_sub_f32 v179, v179, v10
    v_sub_f32 v180, v180, v10
    v_sub_f32 v181, v181, v10
    v_sub_f32 v182, v182, v10
    v_sub_f32 v183, v183, v10
    v_sub_f32 v184, v184, v10
    v_sub_f32 v185, v185, v10
    v_sub_f32 v186, v186, v10
    v_sub_f32 v187, v187, v10
    v_sub_f32 v188, v188, v10
    v_sub_f32 v189, v189, v10
    v_sub_f32 v190, v190, v10
    v_sub_f32 v191, v191, v10
    v_sub_f32 v192, v192, v10
    v_sub_f32 v193, v193, v10
    v_sub_f32 v194, v194, v10
    v_sub_f32 v195, v195, v10
    v_sub_f32 v196, v196, v10
    v_sub_f32 v197, v197, v10
    v_sub_f32 v198, v198, v10
    v_sub_f32 v199, v199, v10
    v_sub_f32 v200, v200, v10
    v_sub_f32 v201, v201, v10
    v_sub_f32 v202, v202, v10
    v_sub_f32 v203, v203, v10
    v_sub_f32 v204, v204, v10
    v_sub_f32 v205, v205, v10
    v_sub_f32 v206, v206, v10
    v_sub_f32 v207, v207, v10
    v_sub_f32 v240, v240, v10
    v_sub_f32 v241, v241, v10
    v_sub_f32 v242, v242, v10
    v_sub_f32 v243, v243, v10
    v_sub_f32 v244, v244, v10
    v_sub_f32 v245, v245, v10
    v_sub_f32 v246, v246, v10
    v_sub_f32 v247, v247, v10
    v_sub_f32 v248, v248, v10
    v_sub_f32 v249, v249, v10
    v_sub_f32 v250, v250, v10
    v_sub_f32 v251, v251, v10
    v_sub_f32 v252, v252, v10
    v_sub_f32 v253, v253, v10
    v_sub_f32 v254, v254, v10
    v_sub_f32 v255, v255, v10
    v_mul_f32 v48, v11, v48
    v_mul_f32 v49, v11, v49
    v_mul_f32 v50, v11, v50
    v_mul_f32 v51, v11, v51
    v_mul_f32 v52, v11, v52
    v_mul_f32 v53, v11, v53
    v_mul_f32 v54, v11, v54
    v_mul_f32 v55, v11, v55
    v_mul_f32 v56, v11, v56
    v_mul_f32 v57, v11, v57
    v_mul_f32 v58, v11, v58
    v_mul_f32 v59, v11, v59
    v_mul_f32 v60, v11, v60
    v_mul_f32 v61, v11, v61
    v_mul_f32 v62, v11, v62
    v_mul_f32 v63, v11, v63
    v_mul_f32 v64, v11, v64
    v_mul_f32 v65, v11, v65
    v_mul_f32 v66, v11, v66
    v_mul_f32 v67, v11, v67
    v_mul_f32 v68, v11, v68
    v_mul_f32 v69, v11, v69
    v_mul_f32 v70, v11, v70
    v_mul_f32 v71, v11, v71
    v_mul_f32 v72, v11, v72
    v_mul_f32 v73, v11, v73
    v_mul_f32 v74, v11, v74
    v_mul_f32 v75, v11, v75
    v_mul_f32 v76, v11, v76
    v_mul_f32 v77, v11, v77
    v_mul_f32 v78, v11, v78
    v_mul_f32 v79, v11, v79
    v_mul_f32 v80, v11, v80
    v_mul_f32 v81, v11, v81
    v_mul_f32 v82, v11, v82
    v_mul_f32 v83, v11, v83
    v_mul_f32 v84, v11, v84
    v_mul_f32 v85, v11, v85
    v_mul_f32 v86, v11, v86
    v_mul_f32 v87, v11, v87
    v_mul_f32 v88, v11, v88
    v_mul_f32 v89, v11, v89
    v_mul_f32 v90, v11, v90
    v_mul_f32 v91, v11, v91
    v_mul_f32 v92, v11, v92
    v_mul_f32 v93, v11, v93
    v_mul_f32 v94, v11, v94
    v_mul_f32 v95, v11, v95
    v_mul_f32 v96, v11, v96
    v_mul_f32 v97, v11, v97
    v_mul_f32 v98, v11, v98
    v_mul_f32 v99, v11, v99
    v_mul_f32 v100, v11, v100
    v_mul_f32 v101, v11, v101
    v_mul_f32 v102, v11, v102
    v_mul_f32 v103, v11, v103
    v_mul_f32 v104, v11, v104
    v_mul_f32 v105, v11, v105
    v_mul_f32 v106, v11, v106
    v_mul_f32 v107, v11, v107
    v_mul_f32 v108, v11, v108
    v_mul_f32 v109, v11, v109
    v_mul_f32 v110, v11, v110
    v_mul_f32 v111, v11, v111
    v_mul_f32 v7, v11, v7
    v_mul_f32 v8, v11, v8
    s_nop 3
    s_branch L_back_6
L_rare_7:
    s_nop 15
    v_max_f32 v10, 0, v10
    v_sub_f32 v11, 0, v10
    v_exp_f32 v11, v11
    v_sub_f32 v208, v208, v10
    v_sub_f32 v209, v209, v10
    v_sub_f32 v210, v210, v10
    v_sub_f32 v211, v211, v10
    v_sub_f32 v212, v212, v10
    v_sub_f32 v213, v213, v10
    v_sub_f32 v214, v214, v10
    v_sub_f32 v215, v215, v10
    v_sub_f32 v216, v216, v10
    v_sub_f32 v217, v217, v10
    v_sub_f32 v218, v218, v10
    v_sub_f32 v219, v219, v10
    v_sub_f32 v220, v220, v10
    v_sub_f32 v221, v221, v10
    v_sub_f32 v222, v222, v10
    v_sub_f32 v223, v223, v10
    v_sub_f32 v224, v224, v10
    v_sub_f32 v225, v225, v10
    v_sub_f32 v226, v226, v10
    v_sub_f32 v227, v227, v10
    v_sub_f32 v228, v228, v10
    v_sub_f32 v229, v229, v10
    v_sub_f32 v230, v230, v10
    v_sub_f32 v231, v231, v10
    v_sub_f32 v232, v232, v10
    v_sub_f32 v233, v233, v10
    v_sub_f32 v234, v234, v10
    v_sub_f32 v235, v235, v10
    v_sub_f32 v236, v236, v10
    v_sub_f32 v237, v237, v10
    v_sub_f32 v238, v238, v10
    v_sub_f32 v239, v239, v10
    v_sub_f32 v240, v240, v10
    v_sub_f32 v241, v241, v10
    v_sub_f32 v242, v242, v10
    v_sub_f32 v243, v243, v10
    v_sub_f32 v244, v244, v10
    v_sub_f32 v245, v245, v10
    v_sub_f32 v246, v246, v10
    v_sub_f32 v247, v247, v10
    v_sub_f32 v248, v248, v10
    v_sub_f32 v249, v249, v10
    v_sub_f32 v250, v250, v10
    v_sub_f32 v251, v251, v10
    v_sub_f32 v252, v252, v10
    v_sub_f32 v253, v253, v10
    v_sub_f32 v254, v254, v10
    v_sub_f32 v255, v255, v10
    v_mul_f32 v48, v11, v48
    v_mul_f32 v49, v11, v49
    v_mul_f32 v50, v11, v50
    v_mul_f32 v51, v11, v51
    v_mul_f32 v52, v11, v52
    v_mul_f32 v53, v11, v53
    v_mul_f32 v54, v11, v54
    v_mul_f32 v55, v11, v55
    v_mul_f32 v56, v11, v56
    v_mul_f32 v57, v11, v57
    v_mul_f32 v58, v11, v58
    v_mul_f32 v59, v11, v59
    v_mul_f32 v60, v11, v60
    v_mul_f32 v61, v11, v61
    v_mul_f32 v62, v11, v62
    v_mul_f32 v63, v11, v63
    v_mul_f32 v64, v11, v64
    v_mul_f32 v65, v11, v65
    v_mul_f32 v66, v11, v66
    v_mul_f32 v67, v11, v67
    v_mul_f32 v68, v11, v68
    v_mul_f32 v69, v11, v69
    v_mul_f32 v70, v11, v70
    v_mul_f32 v71, v11, v71
    v_mul_f32 v72, v11, v72
    v_mul_f32 v73, v11, v73
    v_mul_f32 v74, v11, v74
    v_mul_f32 v75, v11, v75
    v_mul_f32 v76, v11, v76
    v_mul_f32 v77, v11, v77
    v_mul_f32 v78, v11, v78
    v_mul_f32 v79, v11, v79
    v_mul_f32 v80, v11, v80
    v_mul_f32 v81, v11, v81
    v_mul_f32 v82, v11, v82
    v_mul_f32 v83, v11, v83
    v_mul_f32 v84, v11, v84
    v_mul_f32 v85, v11, v85
    v_mul_f32 v86, v11, v86
    v_mul_f32 v87, v11, v87
    v_mul_f32 v88, v11, v88
    v_mul_f32 v89, v11, v89
    v_mul_f32 v90, v11, v90
    v_mul_f32 v91, v11, v91
    v_mul_f32 v92, v11, v92
    v_mul_f32 v93, v11, v93
    v_mul_f32 v94, v11, v94
    v_mul_f32 v95, v11, v95
    v_mul_f32 v96, v11, v96
    v_mul_f32 v97, v11, v97
    v_mul_f32 v98, v11, v98
    v_mul_f32 v99, v11, v99
    v_mul_f32 v100, v11, v100
    v_mul_f32 v101, v11, v101
    v_mul_f32 v102, v11, v102
    v_mul_f32 v103, v11, v103
    v_mul_f32 v104, v11, v104
    v_mul_f32 v105, v11, v105
    v_mul_f32 v106, v11, v106
    v_mul_f32 v107, v11, v107
    v_mul_f32 v108, v11, v108
    v_mul_f32 v109, v11, v109
    v_mul_f32 v110, v11, v110
    v_mul_f32 v111, v11, v111
    v_mul_f32 v7, v11, v7
    v_mul_f32 v8, v11, v8
    s_nop 3
    s_branch L_back_7
    s_endpgm
L_code_end:

.section .rodata,"a"
.p2align 6
.amdhsa_kernel concat_heads__gqa_block_cached__gqa_block_cached__near_ridge_kernel
  .amdhsa_next_free_vgpr 512
  .amdhsa_next_free_sgpr 102
  .amdhsa_accum_offset 256
  .amdhsa_group_segment_fixed_size 0
  .amdhsa_kernarg_size 104
  .amdhsa_user_sgpr_count 2
  .amdhsa_user_sgpr_kernarg_segment_ptr 1
  .amdhsa_system_sgpr_workgroup_id_x 1
.end_amdhsa_kernel
```
